```python
import torch

def _softmax(x, axis=-1):
    return torch.softmax(x, dim=axis)
def _gelu(x):
    return torch.nn.functional.gelu(x, approximate="tanh")
def _silu(x):
    return torch.nn.functional.silu(x)
def _sigmoid(x):
    return torch.sigmoid(x)
def _layernorm(x, axis=-1, eps=1e-5):
    m = x.mean(dim=axis, keepdim=True)
    v = x.var(dim=axis, keepdim=True, unbiased=False)
    return (x - m) / torch.sqrt(v + eps)
def _scatter_add(tgt, idx, src, axis=0):
    return tgt.clone().index_add_(axis, idx, src)
def _segment_sum(src, seg, n):
    out = torch.zeros((n,) + src.shape[1:], dtype=src.dtype)
    return out.index_add_(0, seg, src)
def _pad(x, pw):
    flat = tuple(v for pair in reversed(pw) for v in pair)
    return torch.nn.functional.pad(x, flat)

kernel_name = 'interleave_layers__spectral_gfnet__dense_activation_gelu__prompt'

def setup_inputs():

    _w = (lambda a: (lambda t: t.to(torch.bfloat16) if t.is_floating_point() else t)(torch.as_tensor(a)))
    def _A_setup():
        B, S, D = 1, 2048, 1024
        Df = D // 2 + 1
        return {
            "x": _w((lambda *s: torch.randn(*s, dtype=torch.bfloat16) * 0.05)(B, S, D)),
            "w_r": _w((lambda *s: torch.randn(*s, dtype=torch.bfloat16) * 0.4)(S, Df) * 0.02),
            "w_i": _w((lambda *s: torch.randn(*s, dtype=torch.bfloat16) * 0.4)(S, Df) * 0.02),
        }
    _A_in = _A_setup()

    def _B_setup():
        B, S, D, F = 1, 2048, 1024, 3584
        return {
            "x": _w((lambda *s: torch.randn(*s, dtype=torch.bfloat16) * 0.05)(B, S, D)),
            "w1": _w((lambda *s: torch.randn(*s, dtype=torch.bfloat16) * 0.4)(D, F) * (D ** -0.5)),
            "b1": _w((lambda *s: torch.randn(*s, dtype=torch.bfloat16) * 12.8)(F) * 0.01),
            "w2": _w((lambda *s: torch.randn(*s, dtype=torch.bfloat16) * 0.1)(F, D) * (F ** -0.5)),
            "b2": _w((lambda *s: torch.randn(*s, dtype=torch.bfloat16) * 0.8)(D) * 0.01),
        }
    _B_in = _B_setup()

    return {
        "A_x": _A_in["x"],
        "A_w_r": _A_in["w_r"],
        "A_w_i": _A_in["w_i"],
        "B_x": _B_in["x"],
        "B_w1": _B_in["w1"],
        "B_b1": _B_in["b1"],
        "B_w2": _B_in["w2"],
        "B_b2": _B_in["b2"],
    }

def reference(A_x, A_w_r, A_w_i, B_x, B_w1, B_b1, B_w2, B_b2):
    def _A_ref(x, w_r, w_i):
        B, S, D = x.shape
        X = (lambda x, axes=(-2,-1): torch.fft.rfft2(x.float(), dim=axes))(x, axes=(-2, -1))
        W = w_r + 1j * w_i
        X = X * W
        y = (lambda x, s, axes=(-2,-1): torch.fft.irfft2(x, s=s, dim=axes).to(torch.bfloat16))(X, (S, D), axes=(-2, -1))
        return y

    def _B_ref(x, w1, b1, w2, b2):
        h = torch.einsum("bsd,df->bsf", x, w1) + b1
        h = _gelu(h)
        return torch.einsum("bsf,fd->bsd", h, w2) + b2

    x = A_x
    x = x + _A_ref(_layernorm(x, axis=-1), A_w_r, A_w_i)
    x = x + _B_ref(_layernorm(x, axis=-1), B_w1, B_b1, B_w2, B_b2)
    x = x + _A_ref(_layernorm(x, axis=-1), A_w_r, A_w_i)
    x = x + _B_ref(_layernorm(x, axis=-1), B_w1, B_b1, B_w2, B_b2)
    return x
```

```asm
; @launch kernel=prep_kernel grid=(800,1,1) block=(256,1,1) lds=49152
; @launch kernel=col_kernel grid=(504,1,1) block=(256,1,1) lds=50176
; @launch kernel=mlp_kernel grid=(256,1,1) block=(512,1,1) lds=157696
; @launch kernel=colb_kernel grid=(280,1,1) block=(256,1,1) lds=50176
; @launch kernel=mlpi_kernel grid=(256,1,1) block=(512,1,1) lds=157696
.amdgcn_target "amdgcn-amd-amdhsa--gfx950"
.text
.globl prep_kernel
.p2align 8
.type prep_kernel,@function
prep_kernel:
  s_cmp_ge_u32 s2, 32
  s_cbranch_scc1 L_prep_kernel_r1
  s_sub_u32 s3, s2, 0
  v_readfirstlane_b32 s22, v0
  v_and_b32 v1, 63, v0
  s_lshr_b32 s20, s3, 3
  s_lshr_b32 s22, s22, 6
  s_lshl2_add_u32 s20, s20, s22
  s_cmp_ge_u32 s20, 12
  s_cbranch_scc1 L_prep_kernel_pfx_1
  s_getpc_b64 s[50:51]
L_prep_kernel_pc_2:
  s_sub_u32 s50, s50, L_prep_kernel_pc_2-prep_kernel
  s_subb_u32 s51, s51, 0
  s_lshl_b32 s52, s20, 13
  v_lshl_add_u32 v2, v1, 7, s52
  v_min_u32 v2, 90620, v2
  global_load_dword v3, v2, s[50:51]
L_prep_kernel_pfx_1:
  s_endpgm
L_prep_kernel_r1:
  s_cmp_ge_u32 s2, 288
  s_cbranch_scc1 L_prep_kernel_r2
  s_sub_u32 s3, s2, 32
  s_load_dwordx2 s[4:5], s[0:1], 80
  s_load_dwordx2 s[6:7], s[0:1], 0
  v_readfirstlane_b32 s22, v0
  v_and_b32 v1, 63, v0
  s_and_b32 s20, s3, 7
  s_lshr_b32 s21, s3, 3
  s_lshl_b32 s20, s20, 5
  s_add_u32 s20, s20, s21
  s_lshl_b32 s21, s20, 6
  s_lshr_b32 s22, s22, 6
  s_lshl_b32 s20, s20, 3
  s_lshl1_add_u32 s20, s22, s20
  s_mul_i32 s24, s22, 4096
  s_and_b32 s23, s20, 0x700
  s_bfe_u32 s25, s20, 0x50001
  s_or_b32 s23, s23, s25
  s_and_b32 s25, s20, 64
  s_lshl1_add_u32 s23, s25, s23
  s_and_b32 s25, s20, 128
  s_lshr_b32 s25, s25, 1
  s_or_b32 s23, s23, s25
  v_lshrrev_b32 v3, 5, v1
  v_and_b32 v2, 31, v1
  v_lshlrev_b32 v2, 4, v2
  v_lshl_add_u32 v2, v3, 16, v2
  s_lshl_b32 s23, s23, 11
  v_add_u32 v2, s23, v2
  s_waitcnt lgkmcnt(0)
  s_mov_b32 s8, s6
  s_mov_b32 s9, s7
  s_mov_b32 s10, 0x400000
  s_mov_b32 s11, 0x20000
  s_add_u32 m0, s24, 0
  s_nop 0
  buffer_load_dwordx4 v2, s[8:11], 0 offen offset:0 nt lds
  s_add_u32 m0, s24, 512
  s_nop 0
  buffer_load_dwordx4 v2, s[8:11], 0 offen offset:512 nt lds
  s_add_u32 m0, s24, 1024
  s_nop 0
  buffer_load_dwordx4 v2, s[8:11], 0 offen offset:1024 nt lds
  s_add_u32 m0, s24, 1536
  s_nop 0
  buffer_load_dwordx4 v2, s[8:11], 0 offen offset:1536 nt lds
  v_bfe_u32 v3, v0, 4, 3
  v_xor_b32 v3, v3, v0
  v_lshrrev_b32 v4, 2, v3
  v_and_b32 v3, 3, v3
  v_lshl_add_u32 v156, v3, 4, s21
  v_lshl_add_u32 v156, v4, 14, v156
  s_mov_b32 s12, s4
  s_mov_b32 s13, s5
  s_mov_b32 s14, 0x400000
  s_mov_b32 s15, 0x20000
  s_add_u32 s16, s4, 0x400000
  s_addc_u32 s17, s5, 0
  s_mov_b32 s18, 0x4000
  s_mov_b32 s19, 0x20000
  s_lshl_b32 s23, s20, 2
  v_mov_b32 v161, s23
  s_movk_i32 s30, 0x2000
  v_lshrrev_b32 v2, 5, v1
  v_lshlrev_b32 v160, 10, v2
  v_bfe_u32 v2, v1, 2, 2
  v_lshl_add_u32 v160, v2, 6, v160
  v_bfe_u32 v2, v1, 4, 1
  v_lshl_add_u32 v160, v2, 5, v160
  v_and_b32 v2, 3, v1
  v_lshl_add_u32 v160, v2, 3, v160
  v_add_u32 v160, s24, v160
  v_lshlrev_b32 v157, 4, v0
  s_mov_b64 s[32:33], 1
  v_bfe_u32 v2, v1, 1, 3
  v_xor_b32 v2, s22, v2
  v_lshlrev_b32 v2, 4, v2
  v_lshl_add_u32 v158, v1, 7, v2
  v_add_u32 v158, 16384, v158
  v_xor_b32 v159, 64, v158
  v_and_b32 v2, 31, v1
  v_lshrrev_b32 v3, 5, v1
  v_lshrrev_b32 v8, 1, v2
  v_and_b32 v8, 9, v8
  v_lshrrev_b32 v9, 2, v2
  v_and_b32 v9, 2, v9
  v_and_or_b32 v8, v2, 4, v8
  v_or_b32 v8, v8, v9
  v_and_b32 v9, 1, v2
  v_cvt_f32_u32 v2, v2
  v_cvt_f32_u32 v3, v3
  v_cvt_f32_u32 v8, v8
  v_cvt_f32_u32 v9, v9
  v_mul_f32 v4, 0x3d000000, v2
  v_mul_f32 v6, 0x3a800000, v2
  v_mul_f32 v8, 0x3d000000, v8
  v_mul_f32 v3, 4.0, v3
  v_mul_f32 v9, 0x3e800000, v9
  v_mul_f32 v7, v6, v3
  v_mul_f32 v5, v4, v3
  v_fmac_f32 v9, v8, v3
  v_add_f32 v5, v5, v5
  v_mov_b32 v10, v5
  v_fmamk_f32 v11, v4, 0x3f800000, v5
  v_cos_f32 v28, v10
  v_sin_f32 v44, v10
  v_fmamk_f32 v10, v4, 0x40000000, v5
  v_cos_f32 v29, v11
  v_sin_f32 v45, v11
  v_fmamk_f32 v11, v4, 0x40400000, v5
  v_cos_f32 v30, v10
  v_sin_f32 v46, v10
  v_fmamk_f32 v10, v4, 0x40800000, v5
  v_cos_f32 v31, v11
  v_sin_f32 v47, v11
  v_fmamk_f32 v11, v4, 0x40a00000, v5
  v_cos_f32 v32, v10
  v_sin_f32 v48, v10
  v_fmamk_f32 v10, v4, 0x40c00000, v5
  v_cos_f32 v33, v11
  v_sin_f32 v49, v11
  v_fmamk_f32 v11, v4, 0x40e00000, v5
  v_cos_f32 v34, v10
  v_sin_f32 v50, v10
  v_fmamk_f32 v10, v4, 0x41800000, v5
  v_cos_f32 v35, v11
  v_sin_f32 v51, v11
  v_fmamk_f32 v11, v4, 0x41880000, v5
  v_cos_f32 v36, v10
  v_sin_f32 v52, v10
  v_fmamk_f32 v10, v4, 0x41900000, v5
  v_cos_f32 v37, v11
  v_sin_f32 v53, v11
  v_fmamk_f32 v11, v4, 0x41980000, v5
  v_cos_f32 v38, v10
  v_sin_f32 v54, v10
  v_fmamk_f32 v10, v4, 0x41a00000, v5
  v_cos_f32 v39, v11
  v_sin_f32 v55, v11
  v_fmamk_f32 v11, v4, 0x41a80000, v5
  v_cos_f32 v40, v10
  v_sin_f32 v56, v10
  v_fmamk_f32 v10, v4, 0x41b00000, v5
  v_cos_f32 v41, v11
  v_sin_f32 v57, v11
  v_fmamk_f32 v11, v4, 0x41b80000, v5
  v_cos_f32 v42, v10
  v_sin_f32 v58, v10
  v_cos_f32 v43, v11
  v_sin_f32 v59, v11
  v_cvt_pk_bf16_f32 v12, v28, v29
  v_cvt_pk_bf16_f32 v20, -v44, -v45
  v_cvt_pk_bf16_f32 v13, v30, v31
  v_cvt_pk_bf16_f32 v21, -v46, -v47
  v_cvt_pk_bf16_f32 v14, v32, v33
  v_cvt_pk_bf16_f32 v22, -v48, -v49
  v_cvt_pk_bf16_f32 v15, v34, v35
  v_cvt_pk_bf16_f32 v23, -v50, -v51
  v_cvt_pk_bf16_f32 v16, v36, v37
  v_cvt_pk_bf16_f32 v24, -v52, -v53
  v_cvt_pk_bf16_f32 v17, v38, v39
  v_cvt_pk_bf16_f32 v25, -v54, -v55
  v_cvt_pk_bf16_f32 v18, v40, v41
  v_cvt_pk_bf16_f32 v26, -v56, -v57
  v_cvt_pk_bf16_f32 v19, v42, v43
  v_cvt_pk_bf16_f32 v27, -v58, -v59
  v_mov_b32 v10, v9
  v_fmamk_f32 v11, v8, 0x3f800000, v9
  v_cos_f32 v28, v10
  v_sin_f32 v44, v10
  v_fmamk_f32 v10, v8, 0x40000000, v9
  v_cos_f32 v29, v11
  v_sin_f32 v45, v11
  v_fmamk_f32 v11, v8, 0x40400000, v9
  v_cos_f32 v30, v10
  v_sin_f32 v46, v10
  v_fmamk_f32 v10, v8, 0x41000000, v9
  v_cos_f32 v31, v11
  v_sin_f32 v47, v11
  v_fmamk_f32 v11, v8, 0x41100000, v9
  v_cos_f32 v32, v10
  v_sin_f32 v48, v10
  v_fmamk_f32 v10, v8, 0x41200000, v9
  v_cos_f32 v33, v11
  v_sin_f32 v49, v11
  v_fmamk_f32 v11, v8, 0x41300000, v9
  v_cos_f32 v34, v10
  v_sin_f32 v50, v10
  v_fmamk_f32 v10, v8, 0x41800000, v9
  v_cos_f32 v35, v11
  v_sin_f32 v51, v11
  v_fmamk_f32 v11, v8, 0x41880000, v9
  v_cos_f32 v36, v10
  v_sin_f32 v52, v10
  v_fmamk_f32 v10, v8, 0x41900000, v9
  v_cos_f32 v37, v11
  v_sin_f32 v53, v11
  v_fmamk_f32 v11, v8, 0x41980000, v9
  v_cos_f32 v38, v10
  v_sin_f32 v54, v10
  v_fmamk_f32 v10, v8, 0x41c00000, v9
  v_cos_f32 v39, v11
  v_sin_f32 v55, v11
  v_fmamk_f32 v11, v8, 0x41c80000, v9
  v_cos_f32 v40, v10
  v_sin_f32 v56, v10
  v_fmamk_f32 v10, v8, 0x41d00000, v9
  v_cos_f32 v41, v11
  v_sin_f32 v57, v11
  v_fmamk_f32 v11, v8, 0x41d80000, v9
  v_cos_f32 v42, v10
  v_sin_f32 v58, v10
  v_cos_f32 v43, v11
  v_sin_f32 v59, v11
  v_cvt_pk_bf16_f32 v60, v28, v44
  v_cvt_pk_bf16_f32 v61, v29, v45
  v_cvt_pk_bf16_f32 v62, v30, v46
  v_cvt_pk_bf16_f32 v63, v31, v47
  v_cvt_pk_bf16_f32 v64, v32, v48
  v_cvt_pk_bf16_f32 v65, v33, v49
  v_cvt_pk_bf16_f32 v66, v34, v50
  v_cvt_pk_bf16_f32 v67, v35, v51
  v_cvt_pk_bf16_f32 v68, v36, v52
  v_cvt_pk_bf16_f32 v69, v37, v53
  v_cvt_pk_bf16_f32 v70, v38, v54
  v_cvt_pk_bf16_f32 v71, v39, v55
  v_cvt_pk_bf16_f32 v72, v40, v56
  v_cvt_pk_bf16_f32 v73, v41, v57
  v_cvt_pk_bf16_f32 v74, v42, v58
  v_cvt_pk_bf16_f32 v75, v43, v59
  v_mov_b32 v10, v7
  v_fmamk_f32 v11, v6, 0x3f800000, v7
  v_cos_f32 v28, v10
  v_sin_f32 v44, v10
  v_fmamk_f32 v10, v6, 0x40000000, v7
  v_cos_f32 v29, v11
  v_sin_f32 v45, v11
  v_fmamk_f32 v11, v6, 0x40400000, v7
  v_cos_f32 v30, v10
  v_sin_f32 v46, v10
  v_fmamk_f32 v10, v6, 0x41000000, v7
  v_cos_f32 v31, v11
  v_sin_f32 v47, v11
  v_fmamk_f32 v11, v6, 0x41100000, v7
  v_cos_f32 v32, v10
  v_sin_f32 v48, v10
  v_fmamk_f32 v10, v6, 0x41200000, v7
  v_cos_f32 v33, v11
  v_sin_f32 v49, v11
  v_fmamk_f32 v11, v6, 0x41300000, v7
  v_cos_f32 v34, v10
  v_sin_f32 v50, v10
  v_fmamk_f32 v10, v6, 0x41800000, v7
  v_cos_f32 v35, v11
  v_sin_f32 v51, v11
  v_fmamk_f32 v11, v6, 0x41880000, v7
  v_cos_f32 v36, v10
  v_sin_f32 v52, v10
  v_fmamk_f32 v10, v6, 0x41900000, v7
  v_cos_f32 v37, v11
  v_sin_f32 v53, v11
  v_fmamk_f32 v11, v6, 0x41980000, v7
  v_cos_f32 v38, v10
  v_sin_f32 v54, v10
  v_fmamk_f32 v10, v6, 0x41c00000, v7
  v_cos_f32 v39, v11
  v_sin_f32 v55, v11
  v_fmamk_f32 v11, v6, 0x41c80000, v7
  v_cos_f32 v40, v10
  v_sin_f32 v56, v10
  v_fmamk_f32 v10, v6, 0x41d00000, v7
  v_cos_f32 v41, v11
  v_sin_f32 v57, v11
  v_fmamk_f32 v11, v6, 0x41d80000, v7
  v_cos_f32 v42, v10
  v_sin_f32 v58, v10
  v_cos_f32 v43, v11
  v_sin_f32 v59, v11
  s_waitcnt vmcnt(0) lgkmcnt(0)
  ds_read_b64_tr_b16 v[76:77], v160 offset:0
  ds_read_b64_tr_b16 v[78:79], v160 offset:256
  ds_read_b64_tr_b16 v[80:81], v160 offset:2048
  ds_read_b64_tr_b16 v[82:83], v160 offset:2304
  ds_read_b64_tr_b16 v[84:85], v160 offset:512
  ds_read_b64_tr_b16 v[86:87], v160 offset:768
  ds_read_b64_tr_b16 v[88:89], v160 offset:2560
  ds_read_b64_tr_b16 v[90:91], v160 offset:2816
  s_waitcnt lgkmcnt(6)
  v_mfma_f32_32x32x16_bf16 v[108:123], v[76:79], v[12:15], 0
  v_mfma_f32_32x32x16_bf16 v[92:107], v[76:79], v[20:23], 0
  s_waitcnt lgkmcnt(4)
  v_mfma_f32_32x32x16_bf16 v[108:123], v[80:83], v[16:19], v[108:123]
  v_mfma_f32_32x32x16_bf16 v[92:107], v[80:83], v[24:27], v[92:107]
  s_waitcnt lgkmcnt(2)
  v_mfma_f32_32x32x16_bf16 v[140:155], v[84:87], v[12:15], 0
  v_mfma_f32_32x32x16_bf16 v[124:139], v[84:87], v[20:23], 0
  s_waitcnt lgkmcnt(0)
  v_mfma_f32_32x32x16_bf16 v[140:155], v[88:91], v[16:19], v[140:155]
  v_mfma_f32_32x32x16_bf16 v[124:139], v[88:91], v[24:27], v[124:139]
  s_nop 4
  v_pk_add_f32 v[10:11], v[108:109], v[110:111]
  v_pk_add_f32 v[10:11], v[10:11], v[112:113]
  v_pk_add_f32 v[10:11], v[10:11], v[114:115]
  v_pk_add_f32 v[10:11], v[10:11], v[116:117]
  v_pk_add_f32 v[10:11], v[10:11], v[118:119]
  v_pk_add_f32 v[10:11], v[10:11], v[120:121]
  v_pk_add_f32 v[10:11], v[10:11], v[122:123]
  v_sub_f32 v10, v10, v11
  v_pk_mul_f32 v[2:3], v[108:109], v[28:29]
  v_pk_mul_f32 v[4:5], v[92:93], v[28:29]
  v_pk_mul_f32 v[6:7], v[110:111], v[30:31]
  v_pk_mul_f32 v[8:9], v[94:95], v[30:31]
  v_pk_fma_f32 v[2:3], v[92:93], v[44:45], v[2:3]
  v_pk_fma_f32 v[4:5], v[108:109], v[44:45], v[4:5] neg_lo:[1,0,0] neg_hi:[1,0,0]
  v_pk_fma_f32 v[6:7], v[94:95], v[46:47], v[6:7]
  v_pk_fma_f32 v[8:9], v[110:111], v[46:47], v[8:9] neg_lo:[1,0,0] neg_hi:[1,0,0]
  v_cvt_pk_bf16_f32 v76, v2, v4
  v_cvt_pk_bf16_f32 v77, v3, v5
  v_cvt_pk_bf16_f32 v78, v6, v8
  v_cvt_pk_bf16_f32 v79, v7, v9
  v_readlane_b32 s34, v10, 0
  v_readlane_b32 s35, v10, 32
  v_pk_mul_f32 v[2:3], v[112:113], v[32:33]
  v_pk_mul_f32 v[4:5], v[96:97], v[32:33]
  v_pk_mul_f32 v[6:7], v[114:115], v[34:35]
  v_pk_mul_f32 v[8:9], v[98:99], v[34:35]
  v_pk_fma_f32 v[2:3], v[96:97], v[48:49], v[2:3]
  v_pk_fma_f32 v[4:5], v[112:113], v[48:49], v[4:5] neg_lo:[1,0,0] neg_hi:[1,0,0]
  v_pk_fma_f32 v[6:7], v[98:99], v[50:51], v[6:7]
  v_pk_fma_f32 v[8:9], v[114:115], v[50:51], v[8:9] neg_lo:[1,0,0] neg_hi:[1,0,0]
  v_cvt_pk_bf16_f32 v80, v2, v4
  v_cvt_pk_bf16_f32 v81, v3, v5
  v_cvt_pk_bf16_f32 v82, v6, v8
  v_cvt_pk_bf16_f32 v83, v7, v9
  v_pk_mul_f32 v[2:3], v[116:117], v[36:37]
  v_pk_mul_f32 v[4:5], v[100:101], v[36:37]
  v_pk_mul_f32 v[6:7], v[118:119], v[38:39]
  v_pk_mul_f32 v[8:9], v[102:103], v[38:39]
  v_pk_fma_f32 v[2:3], v[100:101], v[52:53], v[2:3]
  v_pk_fma_f32 v[4:5], v[116:117], v[52:53], v[4:5] neg_lo:[1,0,0] neg_hi:[1,0,0]
  v_pk_fma_f32 v[6:7], v[102:103], v[54:55], v[6:7]
  v_pk_fma_f32 v[8:9], v[118:119], v[54:55], v[8:9] neg_lo:[1,0,0] neg_hi:[1,0,0]
  v_cvt_pk_bf16_f32 v84, v2, v4
  v_cvt_pk_bf16_f32 v85, v3, v5
  v_cvt_pk_bf16_f32 v86, v6, v8
  v_cvt_pk_bf16_f32 v87, v7, v9
  v_pk_mul_f32 v[2:3], v[120:121], v[40:41]
  v_pk_mul_f32 v[4:5], v[104:105], v[40:41]
  v_pk_mul_f32 v[6:7], v[122:123], v[42:43]
  v_pk_mul_f32 v[8:9], v[106:107], v[42:43]
  v_pk_fma_f32 v[2:3], v[104:105], v[56:57], v[2:3]
  v_pk_fma_f32 v[4:5], v[120:121], v[56:57], v[4:5] neg_lo:[1,0,0] neg_hi:[1,0,0]
  v_pk_fma_f32 v[6:7], v[106:107], v[58:59], v[6:7]
  v_pk_fma_f32 v[8:9], v[122:123], v[58:59], v[8:9] neg_lo:[1,0,0] neg_hi:[1,0,0]
  v_cvt_pk_bf16_f32 v88, v2, v4
  v_cvt_pk_bf16_f32 v89, v3, v5
  v_cvt_pk_bf16_f32 v90, v6, v8
  v_cvt_pk_bf16_f32 v91, v7, v9
  v_mfma_f32_32x32x16_bf16 v[108:123], v[60:63], v[76:79], 0
  v_mfma_f32_32x32x16_bf16 v[108:123], v[64:67], v[80:83], v[108:123]
  v_mfma_f32_32x32x16_bf16 v[108:123], v[68:71], v[84:87], v[108:123]
  v_mfma_f32_32x32x16_bf16 v[108:123], v[72:75], v[88:91], v[108:123]
  v_pk_add_f32 v[10:11], v[140:141], v[142:143]
  v_pk_add_f32 v[10:11], v[10:11], v[144:145]
  v_pk_add_f32 v[10:11], v[10:11], v[146:147]
  v_pk_add_f32 v[10:11], v[10:11], v[148:149]
  v_pk_add_f32 v[10:11], v[10:11], v[150:151]
  v_pk_add_f32 v[10:11], v[10:11], v[152:153]
  v_pk_add_f32 v[10:11], v[10:11], v[154:155]
  v_sub_f32 v10, v10, v11
  v_pk_mul_f32 v[2:3], v[140:141], v[28:29]
  v_pk_mul_f32 v[4:5], v[124:125], v[28:29]
  v_pk_mul_f32 v[6:7], v[142:143], v[30:31]
  v_pk_mul_f32 v[8:9], v[126:127], v[30:31]
  v_pk_fma_f32 v[2:3], v[124:125], v[44:45], v[2:3]
  v_pk_fma_f32 v[4:5], v[140:141], v[44:45], v[4:5] neg_lo:[1,0,0] neg_hi:[1,0,0]
  v_pk_fma_f32 v[6:7], v[126:127], v[46:47], v[6:7]
  v_pk_fma_f32 v[8:9], v[142:143], v[46:47], v[8:9] neg_lo:[1,0,0] neg_hi:[1,0,0]
  v_cvt_pk_bf16_f32 v12, v2, v4
  v_cvt_pk_bf16_f32 v13, v3, v5
  v_cvt_pk_bf16_f32 v14, v6, v8
  v_cvt_pk_bf16_f32 v15, v7, v9
  v_readlane_b32 s36, v10, 0
  v_readlane_b32 s37, v10, 32
  v_pk_mul_f32 v[2:3], v[144:145], v[32:33]
  v_pk_mul_f32 v[4:5], v[128:129], v[32:33]
  v_pk_mul_f32 v[6:7], v[146:147], v[34:35]
  v_pk_mul_f32 v[8:9], v[130:131], v[34:35]
  v_pk_fma_f32 v[2:3], v[128:129], v[48:49], v[2:3]
  v_pk_fma_f32 v[4:5], v[144:145], v[48:49], v[4:5] neg_lo:[1,0,0] neg_hi:[1,0,0]
  v_pk_fma_f32 v[6:7], v[130:131], v[50:51], v[6:7]
  v_pk_fma_f32 v[8:9], v[146:147], v[50:51], v[8:9] neg_lo:[1,0,0] neg_hi:[1,0,0]
  v_cvt_pk_bf16_f32 v16, v2, v4
  v_cvt_pk_bf16_f32 v17, v3, v5
  v_cvt_pk_bf16_f32 v18, v6, v8
  v_cvt_pk_bf16_f32 v19, v7, v9
  v_pk_mul_f32 v[2:3], v[148:149], v[36:37]
  v_pk_mul_f32 v[4:5], v[132:133], v[36:37]
  v_pk_mul_f32 v[6:7], v[150:151], v[38:39]
  v_pk_mul_f32 v[8:9], v[134:135], v[38:39]
  v_pk_fma_f32 v[2:3], v[132:133], v[52:53], v[2:3]
  v_pk_fma_f32 v[4:5], v[148:149], v[52:53], v[4:5] neg_lo:[1,0,0] neg_hi:[1,0,0]
  v_pk_fma_f32 v[6:7], v[134:135], v[54:55], v[6:7]
  v_pk_fma_f32 v[8:9], v[150:151], v[54:55], v[8:9] neg_lo:[1,0,0] neg_hi:[1,0,0]
  v_cvt_pk_bf16_f32 v20, v2, v4
  v_cvt_pk_bf16_f32 v21, v3, v5
  v_cvt_pk_bf16_f32 v22, v6, v8
  v_cvt_pk_bf16_f32 v23, v7, v9
  v_pk_mul_f32 v[2:3], v[152:153], v[40:41]
  v_pk_mul_f32 v[4:5], v[136:137], v[40:41]
  v_pk_mul_f32 v[6:7], v[154:155], v[42:43]
  v_pk_mul_f32 v[8:9], v[138:139], v[42:43]
  v_pk_fma_f32 v[2:3], v[136:137], v[56:57], v[2:3]
  v_pk_fma_f32 v[4:5], v[152:153], v[56:57], v[4:5] neg_lo:[1,0,0] neg_hi:[1,0,0]
  v_pk_fma_f32 v[6:7], v[138:139], v[58:59], v[6:7]
  v_pk_fma_f32 v[8:9], v[154:155], v[58:59], v[8:9] neg_lo:[1,0,0] neg_hi:[1,0,0]
  v_cvt_pk_bf16_f32 v24, v2, v4
  v_cvt_pk_bf16_f32 v25, v3, v5
  v_cvt_pk_bf16_f32 v26, v6, v8
  v_cvt_pk_bf16_f32 v27, v7, v9
  v_mfma_f32_32x32x16_bf16 v[140:155], v[60:63], v[12:15], 0
  v_mfma_f32_32x32x16_bf16 v[140:155], v[64:67], v[16:19], v[140:155]
  v_mfma_f32_32x32x16_bf16 v[140:155], v[68:71], v[20:23], v[140:155]
  v_mfma_f32_32x32x16_bf16 v[140:155], v[72:75], v[24:27], v[140:155]
  v_mov_b32 v2, s34
  v_add_f32 v2, s35, v2
  v_mul_f32 v2, 0x3f3504f3, v2
  v_readlane_b32 s38, v108, 0
  v_cndmask_b32 v108, v108, v2, s[32:33]
  v_cndmask_b32 v109, v109, 0, s[32:33]
  v_cvt_pk_bf16_f32 v92, v108, v109
  v_cvt_pk_bf16_f32 v93, v110, v111
  v_cvt_pk_bf16_f32 v96, v112, v113
  v_cvt_pk_bf16_f32 v97, v114, v115
  v_cvt_pk_bf16_f32 v100, v116, v117
  v_cvt_pk_bf16_f32 v101, v118, v119
  v_cvt_pk_bf16_f32 v104, v120, v121
  v_cvt_pk_bf16_f32 v105, v122, v123
  v_mov_b32 v2, s36
  v_add_f32 v2, s37, v2
  v_mul_f32 v2, 0x3f3504f3, v2
  v_readlane_b32 s39, v140, 0
  v_cndmask_b32 v140, v140, v2, s[32:33]
  v_cndmask_b32 v141, v141, 0, s[32:33]
  v_cvt_pk_bf16_f32 v94, v140, v141
  v_cvt_pk_bf16_f32 v95, v142, v143
  v_cvt_pk_bf16_f32 v98, v144, v145
  v_cvt_pk_bf16_f32 v99, v146, v147
  v_cvt_pk_bf16_f32 v102, v148, v149
  v_cvt_pk_bf16_f32 v103, v150, v151
  v_cvt_pk_bf16_f32 v106, v152, v153
  v_cvt_pk_bf16_f32 v107, v154, v155
  ds_write_b128 v158, v[92:95] offset:0
  ds_write_b128 v159, v[96:99] offset:0
  ds_write_b128 v158, v[100:103] offset:8192
  ds_write_b128 v159, v[104:107] offset:8192
  v_dot2_f32_bf16 v10, v92, v92, 0
  v_dot2_f32_bf16 v11, v94, v94, 0
  v_dot2_f32_bf16 v10, v93, v93, v10
  v_dot2_f32_bf16 v11, v95, v95, v11
  v_dot2_f32_bf16 v10, v96, v96, v10
  v_dot2_f32_bf16 v11, v98, v98, v11
  v_dot2_f32_bf16 v10, v97, v97, v10
  v_dot2_f32_bf16 v11, v99, v99, v11
  v_dot2_f32_bf16 v10, v100, v100, v10
  v_dot2_f32_bf16 v11, v102, v102, v11
  v_dot2_f32_bf16 v10, v101, v101, v10
  v_dot2_f32_bf16 v11, v103, v103, v11
  v_dot2_f32_bf16 v10, v104, v104, v10
  v_dot2_f32_bf16 v11, v106, v106, v11
  v_dot2_f32_bf16 v10, v105, v105, v10
  v_dot2_f32_bf16 v11, v107, v107, v11
  s_waitcnt lgkmcnt(0)
  s_barrier
  ds_read_b128 v[108:111], v157 offset:16384
  ds_read_b128 v[112:115], v157 offset:20480
  ds_read_b128 v[116:119], v157 offset:24576
  ds_read_b128 v[120:123], v157 offset:28672
  v_add_f32_dpp v10, v10, v10 row_shr:1 row_mask:0xf bank_mask:0xf
  v_add_f32_dpp v11, v11, v11 row_shr:1 row_mask:0xf bank_mask:0xf
  s_nop 0
  v_add_f32_dpp v10, v10, v10 row_shr:2 row_mask:0xf bank_mask:0xf
  v_add_f32_dpp v11, v11, v11 row_shr:2 row_mask:0xf bank_mask:0xf
  s_nop 0
  v_add_f32_dpp v10, v10, v10 row_shr:4 row_mask:0xf bank_mask:0xf
  v_add_f32_dpp v11, v11, v11 row_shr:4 row_mask:0xf bank_mask:0xf
  s_nop 0
  v_add_f32_dpp v10, v10, v10 row_shr:8 row_mask:0xf bank_mask:0xf
  v_add_f32_dpp v11, v11, v11 row_shr:8 row_mask:0xf bank_mask:0xf
  s_nop 0
  v_add_f32_dpp v10, v10, v10 row_bcast:15 row_mask:0xa bank_mask:0xf
  v_add_f32_dpp v11, v11, v11 row_bcast:15 row_mask:0xa bank_mask:0xf
  s_nop 0
  v_add_f32_dpp v10, v10, v10 row_bcast:31 row_mask:0xc bank_mask:0xf
  v_add_f32_dpp v11, v11, v11 row_bcast:31 row_mask:0xc bank_mask:0xf
  s_mov_b32 s25, 0
  s_waitcnt lgkmcnt(3)
  buffer_store_dwordx4 v[108:111], v156, s[12:15], s25 offen sc0 sc1
  s_mov_b32 s25, 1048576
  s_waitcnt lgkmcnt(2)
  buffer_store_dwordx4 v[112:115], v156, s[12:15], s25 offen sc0 sc1
  s_mov_b32 s25, 2097152
  s_waitcnt lgkmcnt(1)
  buffer_store_dwordx4 v[116:119], v156, s[12:15], s25 offen sc0 sc1
  s_mov_b32 s25, 3145728
  s_waitcnt lgkmcnt(0)
  buffer_store_dwordx4 v[120:123], v156, s[12:15], s25 offen sc0 sc1
  v_mov_b32 v4, 0x3727c5ac
  v_fmamk_f32 v2, v10, 0x36000000, v4
  v_fmamk_f32 v3, v11, 0x36000000, v4
  v_rsq_f32 v2, v2
  v_rsq_f32 v3, v3
  v_mov_b32 v162, s38
  v_mov_b32 v163, s39
  s_mov_b32 exec_lo, 0
  s_mov_b32 exec_hi, 0x80000000
  buffer_store_dwordx2 v[2:3], v161, s[16:19], 0 offen sc0 sc1
  buffer_store_dwordx2 v[162:163], v161, s[16:19], s30 offen sc0 sc1
  s_endpgm
L_prep_kernel_r2:
  s_cmp_ge_u32 s2, 544
  s_cbranch_scc1 L_prep_kernel_r3
  s_sub_u32 s3, s2, 288
  s_load_dwordx2 s[4:5], s[0:1], 80
  s_load_dwordx4 s[20:23], s[0:1], 8
  s_load_dwordx2 s[6:7], s[0:1], 32
  s_bfe_u32 s24, s3, 0x20003
  s_bfe_u32 s25, s3, 0x20005
  s_and_b32 s26, s3, 7
  s_lshr_b32 s27, s3, 7
  v_and_b32 v1, 31, v0
  v_lshrrev_b32 v2, 5, v0
  s_lshl_b32 s28, s26, 8
  s_lshl_b32 s29, s25, 4
  s_add_u32 s28, s28, s29
  s_add_u32 s28, s28, s27
  s_mul_i32 s28, s28, 1026
  s_lshl_b32 s29, s24, 8
  s_add_u32 s28, s28, s29
  s_add_u32 s28, s28, 2
  v_mul_u32_u24 v5, 2052, v2
  v_lshl_add_u32 v5, v1, 3, v5
  v_add_u32 v5, s28, v5
  s_waitcnt lgkmcnt(0)
  s_mov_b32 s8, s20
  s_mov_b32 s9, s21
  s_mov_b32 s10, 0x201000
  s_mov_b32 s11, 0x20000
  s_mov_b32 s12, s22
  s_mov_b32 s13, s23
  s_mov_b32 s14, 0x201000
  s_mov_b32 s15, 0x20000
  s_mov_b32 s30, 0
  buffer_load_dwordx2 v[8:9], v5, s[8:11], s30 offen nt
  buffer_load_dwordx2 v[10:11], v5, s[12:15], s30 offen nt
  s_mov_b32 s30, 65664
  buffer_load_dwordx2 v[12:13], v5, s[8:11], s30 offen nt
  buffer_load_dwordx2 v[14:15], v5, s[12:15], s30 offen nt
  s_mov_b32 s30, 131328
  buffer_load_dwordx2 v[16:17], v5, s[8:11], s30 offen nt
  buffer_load_dwordx2 v[18:19], v5, s[12:15], s30 offen nt
  s_mov_b32 s30, 196992
  buffer_load_dwordx2 v[20:21], v5, s[8:11], s30 offen nt
  buffer_load_dwordx2 v[22:23], v5, s[12:15], s30 offen nt
  s_mov_b32 s36, s6
  s_mov_b32 s37, s7
  s_mov_b32 s38, 0x700000
  s_mov_b32 s39, 0x20000
  s_lshr_b32 s34, s3, 3
  s_mul_i32 s34, s34, 229376
  s_mul_i32 s29, s26, 896
  s_add_u32 s34, s34, s29
  v_lshrrev_b32 v47, 3, v0
  v_mul_u32_u24 v47, 7168, v47
  v_and_b32 v4, 7, v0
  v_min_u32 v4, 6, v4
  v_lshl_add_u32 v47, v4, 7, v47
  s_add_u32 s16, s4, 0x500000
  s_addc_u32 s17, s5, 0
  s_mov_b32 s18, 0x400000
  s_mov_b32 s19, 0x20000
  v_and_b32 v3, 7, v1
  v_xor_b32 v3, v3, v2
  v_lshlrev_b32 v3, 4, v3
  v_lshl_add_u32 v3, v1, 9, v3
  s_mov_b32 s30, 0x05040100
  s_mov_b32 s31, 0x07060302
  v_xor_b32 v41, v2, v0
  v_and_b32 v41, 7, v41
  s_lshl_b32 s28, s27, 12
  s_lshl_b32 s29, s26, 9
  s_add_u32 s28, s28, s29
  s_lshl_b32 s29, s25, 7
  s_add_u32 s28, s28, s29
  v_lshl_add_u32 v41, v41, 4, s28
  v_lshrrev_b32 v40, 3, v0
  s_lshl_b32 s28, s24, 7
  s_add_u32 s28, s28, 1
  v_add_u32 v40, s28, v40
  v_and_b32 v4, 31, v40
  v_lshl_add_u32 v41, v4, 15, v41
  v_add_u32 v4, 0, v40
  v_bfe_u32 v6, v4, 5, 2
  v_lshl_add_u32 v42, v6, 13, v41
  v_bfe_u32 v6, v4, 7, 2
  v_lshl_add_u32 v42, v6, 20, v42
  v_add_u32 v4, 32, v40
  v_bfe_u32 v6, v4, 5, 2
  v_lshl_add_u32 v43, v6, 13, v41
  v_bfe_u32 v6, v4, 7, 2
  v_lshl_add_u32 v43, v6, 20, v43
  v_add_u32 v4, 64, v40
  v_bfe_u32 v6, v4, 5, 2
  v_lshl_add_u32 v44, v6, 13, v41
  v_bfe_u32 v6, v4, 7, 2
  v_lshl_add_u32 v44, v6, 20, v44
  v_add_u32 v4, 96, v40
  v_bfe_u32 v6, v4, 5, 2
  v_lshl_add_u32 v45, v6, 13, v41
  v_bfe_u32 v6, v4, 7, 2
  v_lshl_add_u32 v45, v6, 20, v45
  v_lshlrev_b32 v40, 4, v0
  s_waitcnt vmcnt(6)
  v_perm_b32 v24, v10, v8, s30
  v_perm_b32 v28, v10, v8, s31
  v_perm_b32 v32, v11, v9, s30
  v_perm_b32 v36, v11, v9, s31
  s_waitcnt vmcnt(4)
  v_perm_b32 v25, v14, v12, s30
  v_perm_b32 v29, v14, v12, s31
  v_perm_b32 v33, v15, v13, s30
  v_perm_b32 v37, v15, v13, s31
  s_waitcnt vmcnt(2)
  v_perm_b32 v26, v18, v16, s30
  v_perm_b32 v30, v18, v16, s31
  v_perm_b32 v34, v19, v17, s30
  v_perm_b32 v38, v19, v17, s31
  s_waitcnt vmcnt(0)
  v_perm_b32 v27, v22, v20, s30
  v_perm_b32 v31, v22, v20, s31
  v_perm_b32 v35, v23, v21, s30
  v_perm_b32 v39, v23, v21, s31
  ds_write_b128 v3, v[24:27] offset:0
  ds_write_b128 v3, v[28:31] offset:128
  ds_write_b128 v3, v[32:35] offset:256
  ds_write_b128 v3, v[36:39] offset:384
  s_waitcnt lgkmcnt(0)
  s_barrier
  ds_read_b128 v[8:11], v40 offset:0
  ds_read_b128 v[12:15], v40 offset:4096
  ds_read_b128 v[16:19], v40 offset:8192
  ds_read_b128 v[20:23], v40 offset:12288
  s_waitcnt lgkmcnt(3)
  buffer_store_dwordx4 v[8:11], v42, s[16:19], 0 offen sc0 sc1
  s_waitcnt lgkmcnt(2)
  buffer_store_dwordx4 v[12:15], v43, s[16:19], 0 offen sc0 sc1
  s_waitcnt lgkmcnt(1)
  buffer_store_dwordx4 v[16:19], v44, s[16:19], 0 offen sc0 sc1
  s_waitcnt lgkmcnt(0)
  buffer_store_dwordx4 v[20:23], v45, s[16:19], 0 offen sc0 sc1
  s_endpgm
L_prep_kernel_r3:
  s_cmp_ge_u32 s2, 800
  s_cbranch_scc1 L_prep_kernel_end
  s_sub_u32 s3, s2, 544
  s_load_dwordx2 s[6:7], s[0:1], 32
  s_lshr_b32 s34, s3, 3
  s_mul_i32 s34, s34, 229376
  s_and_b32 s26, s3, 7
  s_mul_i32 s29, s26, 896
  s_add_u32 s34, s34, s29
  v_lshrrev_b32 v1, 3, v0
  v_mul_u32_u24 v1, 7168, v1
  v_and_b32 v4, 7, v0
  v_min_u32 v4, 6, v4
  v_lshl_add_u32 v1, v4, 7, v1
  s_waitcnt lgkmcnt(0)
  s_mov_b32 s8, s6
  s_mov_b32 s9, s7
  s_mov_b32 s10, 0x700000
  s_mov_b32 s11, 0x20000
  buffer_load_dword v2, v1, s[8:11], s34 offen
  s_endpgm
L_prep_kernel_end:
  s_endpgm
.globl mlpi_kernel
.p2align 8
.type mlpi_kernel,@function
mlpi_kernel:
  s_mov_b32 s3, 1
  s_branch L_mlp_body
.globl mlp_kernel
.p2align 8
.type mlp_kernel,@function
mlp_kernel:
  s_mov_b32 s3, 0
L_mlp_body:
  s_cmp_ge_u32 s2, 256
  s_cbranch_scc1 L_mlp_end
  s_load_dwordx2 s[4:5], s[0:1], 80
  s_load_dwordx2 s[6:7], s[0:1], 40
  s_load_dwordx4 s[32:35], s[0:1], 48
  v_readfirstlane_b32 s22, v0
  s_and_b32 s20, s2, 1
  s_bfe_u32 s21, s2, 0x30003
  s_lshl3_add_u32 s20, s20, s21
  s_bfe_u32 s21, s2, 0x20001
  s_lshr_b32 s23, s2, 6
  s_lshl2_add_u32 s21, s21, s23
  s_lshr_b32 s22, s22, 6
  s_cmp_lt_u32 s22, 4
  s_cbranch_scc1 L_mlp_mma
  s_sub_u32 s22, s22, 4
  v_and_b32 v1, 63, v0
  s_mul_i32 s25, s21, 458752
  s_mul_i32 s26, s22, 7168
  s_add_u32 s25, s25, s26
  v_lshl_add_u32 v2, v1, 4, s25
  s_lshl_b32 s25, s22, 16
  s_lshl_b32 s27, s20, 10
  s_add_u32 s25, s25, s27
  v_lshl_add_u32 v4, v1, 4, s25
  v_add_u32 v3, 4096, v2
  v_add_u32 v5, 0x4000, v4
  v_add_u32 v6, 0x8000, v4
  v_add_u32 v7, 0xc000, v4
  s_mul_i32 s27, s22, 4352
  s_add_u32 s27, s27, 28672
  s_mov_b32 s10, 7340032
  s_mov_b32 s11, 0x20000
  s_mov_b32 s14, 4194304
  s_mov_b32 s15, 0x20000
  v_subrev_u32 v0, 256, v0
  s_lshl4_add_u32 s24, s20, s21
  s_lshl_b32 s29, s24, 6
  s_lshl_b32 s23, s22, 10
  v_bfe_u32 v8, v0, 4, 3
  v_xor_b32 v8, v8, v0
  v_lshrrev_b32 v9, 2, v8
  v_and_b32 v8, 3, v8
  v_lshl_add_u32 v251, v8, 4, s29
  v_lshl_add_u32 v251, v9, 14, v251
  v_bfe_u32 v8, v1, 1, 3
  v_xor_b32 v8, s22, v8
  v_lshlrev_b32 v8, 4, v8
  v_lshl_add_u32 v252, v1, 7, v8
  v_add_u32 v252, 141312, v252
  v_xor_b32 v253, 64, v252
  s_mul_i32 s29, s2, 28672
  s_add_u32 s29, s29, s26
  v_min_u32 v34, 55, v1
  v_lshl_add_u32 v34, v34, 7, s29
  v_lshlrev_b32 v35, 4, v1
  v_lshrrev_b32 v36, 3, v1
  v_mul_u32_u24 v36, 384, v36
  v_add_u32 v36, v36, v35
  v_mov_b32 v60, 138240
  v_mov_b32 v62, 0
  ds_write_b32 v60, v62
  s_waitcnt lgkmcnt(0)
  s_add_u32 s8, s4, 9437184
  s_addc_u32 s9, s5, 0
  s_mov_b32 s12, s4
  s_mov_b32 s13, s5
  s_mov_b32 s30, 0
  s_mov_b32 s31, 0
  s_add_u32 m0, s27, 0
  s_nop 0
  buffer_load_dwordx4 v4, s[12:15], s31 offen  lds
  s_add_u32 m0, s27, 1088
  s_nop 0
  buffer_load_dwordx4 v5, s[12:15], s31 offen  lds
  s_add_u32 m0, s27, 2176
  s_nop 0
  buffer_load_dwordx4 v6, s[12:15], s31 offen  lds
  s_add_u32 m0, s27, 3264
  s_nop 0
  buffer_load_dwordx4 v7, s[12:15], s31 offen  lds
  s_add_u32 m0, s26, 0
  s_nop 0
  buffer_load_dwordx4 v2, s[8:11], s30 offen offset:0  lds
  buffer_load_dwordx4 v2, s[8:11], s30 offen offset:1024  lds
  buffer_load_dwordx4 v2, s[8:11], s30 offen offset:2048  lds
  buffer_load_dwordx4 v2, s[8:11], s30 offen offset:3072  lds
  s_add_u32 m0, s26, 4096
  s_nop 0
  buffer_load_dwordx4 v3, s[8:11], s30 offen offset:0  lds
  buffer_load_dwordx4 v3, s[8:11], s30 offen offset:1024  lds
  buffer_load_dwordx4 v3, s[8:11], s30 offen offset:2048  lds
  s_mov_b32 s30, 28672
  s_mov_b32 s31, 262144
  s_add_u32 m0, s27, 46080
  s_nop 0
  buffer_load_dwordx4 v4, s[12:15], s31 offen  lds
  s_add_u32 m0, s27, 47168
  s_nop 0
  buffer_load_dwordx4 v5, s[12:15], s31 offen  lds
  s_add_u32 m0, s27, 48256
  s_nop 0
  buffer_load_dwordx4 v6, s[12:15], s31 offen  lds
  s_add_u32 m0, s27, 49344
  s_nop 0
  buffer_load_dwordx4 v7, s[12:15], s31 offen  lds
  s_add_u32 m0, s26, 46080
  s_nop 0
  buffer_load_dwordx4 v2, s[8:11], s30 offen offset:0  lds
  buffer_load_dwordx4 v2, s[8:11], s30 offen offset:1024  lds
  buffer_load_dwordx4 v2, s[8:11], s30 offen offset:2048  lds
  buffer_load_dwordx4 v2, s[8:11], s30 offen offset:3072  lds
  s_add_u32 m0, s26, 50176
  s_nop 0
  buffer_load_dwordx4 v3, s[8:11], s30 offen offset:0  lds
  buffer_load_dwordx4 v3, s[8:11], s30 offen offset:1024  lds
  buffer_load_dwordx4 v3, s[8:11], s30 offen offset:2048  lds
  s_lshl_b32 s24, s24, 5
  s_lshl3_add_u32 s24, s22, s24
  s_add_u32 s24, s24, 0x8000
  s_getpc_b64 s[64:65]
L_mlp_kernel_pc_1:
  s_sub_u32 s64, s64, L_mlp_kernel_pc_1-mlp_kernel
  s_subb_u32 s65, s65, 0
  s_lshr_b32 s29, s2, 3
  s_sub_u32 s30, 3, s22
  s_lshl_b32 s30, s30, 5
  s_add_u32 s29, s29, s30
  s_cmp_lt_u32 s29, 8
  s_cselect_b32 s63, 1, 0
  s_lshl_b32 s29, s29, 13
  v_lshl_add_u32 v38, v1, 7, s29
  v_min_u32 v38, 61180, v38
  s_mov_b32 s16, s32
  s_mov_b32 s17, s33
  s_mov_b32 s18, 0x700000
  s_mov_b32 s19, 0x20000
  s_add_u32 s44, s4, 0x410000
  s_addc_u32 s45, s5, 0
  s_mov_b32 s46, 0xa000
  s_mov_b32 s47, 0x20000
  s_waitcnt vmcnt(11)
  s_barrier
  s_mov_b32 s30, 57344
  s_mov_b32 s31, 524288
  s_add_u32 m0, s27, 92160
  s_nop 0
  buffer_load_dwordx4 v4, s[12:15], s31 offen  lds
  s_add_u32 m0, s27, 93248
  s_nop 0
  buffer_load_dwordx4 v5, s[12:15], s31 offen  lds
  s_add_u32 m0, s27, 94336
  s_nop 0
  buffer_load_dwordx4 v6, s[12:15], s31 offen  lds
  s_add_u32 m0, s27, 95424
  s_nop 0
  buffer_load_dwordx4 v7, s[12:15], s31 offen  lds
  s_add_u32 m0, s26, 92160
  s_nop 0
  buffer_load_dwordx4 v2, s[8:11], s30 offen offset:0  lds
  buffer_load_dwordx4 v2, s[8:11], s30 offen offset:1024  lds
  buffer_load_dwordx4 v2, s[8:11], s30 offen offset:2048  lds
  buffer_load_dwordx4 v2, s[8:11], s30 offen offset:3072  lds
  s_add_u32 m0, s26, 96256
  s_nop 0
  buffer_load_dwordx4 v3, s[8:11], s30 offen offset:0  lds
  buffer_load_dwordx4 v3, s[8:11], s30 offen offset:1024  lds
  buffer_load_dwordx4 v3, s[8:11], s30 offen offset:2048  lds
  s_waitcnt vmcnt(11)
  s_barrier
  s_mov_b32 s30, 86016
  s_mov_b32 s31, 786432
  s_add_u32 m0, s27, 0
  s_nop 0
  buffer_load_dwordx4 v4, s[12:15], s31 offen  lds
  s_add_u32 m0, s27, 1088
  s_nop 0
  buffer_load_dwordx4 v5, s[12:15], s31 offen  lds
  s_add_u32 m0, s27, 2176
  s_nop 0
  buffer_load_dwordx4 v6, s[12:15], s31 offen  lds
  s_add_u32 m0, s27, 3264
  s_nop 0
  buffer_load_dwordx4 v7, s[12:15], s31 offen  lds
  s_add_u32 m0, s26, 0
  s_nop 0
  buffer_load_dwordx4 v2, s[8:11], s30 offen offset:0  lds
  buffer_load_dwordx4 v2, s[8:11], s30 offen offset:1024  lds
  buffer_load_dwordx4 v2, s[8:11], s30 offen offset:2048  lds
  buffer_load_dwordx4 v2, s[8:11], s30 offen offset:3072  lds
  s_add_u32 m0, s26, 4096
  s_nop 0
  buffer_load_dwordx4 v3, s[8:11], s30 offen offset:0  lds
  buffer_load_dwordx4 v3, s[8:11], s30 offen offset:1024  lds
  buffer_load_dwordx4 v3, s[8:11], s30 offen offset:2048  lds
  s_waitcnt vmcnt(11)
  s_barrier
  s_mov_b32 s30, 114688
  s_mov_b32 s31, 1048576
  s_add_u32 m0, s27, 46080
  s_nop 0
  buffer_load_dwordx4 v4, s[12:15], s31 offen  lds
  s_add_u32 m0, s27, 47168
  s_nop 0
  buffer_load_dwordx4 v5, s[12:15], s31 offen  lds
  s_add_u32 m0, s27, 48256
  s_nop 0
  buffer_load_dwordx4 v6, s[12:15], s31 offen  lds
  s_add_u32 m0, s27, 49344
  s_nop 0
  buffer_load_dwordx4 v7, s[12:15], s31 offen  lds
  s_add_u32 m0, s26, 46080
  s_nop 0
  buffer_load_dwordx4 v2, s[8:11], s30 offen offset:0  lds
  buffer_load_dwordx4 v2, s[8:11], s30 offen offset:1024  lds
  buffer_load_dwordx4 v2, s[8:11], s30 offen offset:2048  lds
  buffer_load_dwordx4 v2, s[8:11], s30 offen offset:3072  lds
  s_add_u32 m0, s26, 50176
  s_nop 0
  buffer_load_dwordx4 v3, s[8:11], s30 offen offset:0  lds
  buffer_load_dwordx4 v3, s[8:11], s30 offen offset:1024  lds
  buffer_load_dwordx4 v3, s[8:11], s30 offen offset:2048  lds
  s_waitcnt vmcnt(11)
  s_barrier
  s_mov_b32 s30, 143360
  s_mov_b32 s31, 1310720
  s_add_u32 m0, s27, 92160
  s_nop 0
  buffer_load_dwordx4 v4, s[12:15], s31 offen  lds
  s_add_u32 m0, s27, 93248
  s_nop 0
  buffer_load_dwordx4 v5, s[12:15], s31 offen  lds
  s_add_u32 m0, s27, 94336
  s_nop 0
  buffer_load_dwordx4 v6, s[12:15], s31 offen  lds
  s_add_u32 m0, s27, 95424
  s_nop 0
  buffer_load_dwordx4 v7, s[12:15], s31 offen  lds
  s_add_u32 m0, s26, 92160
  s_nop 0
  buffer_load_dwordx4 v2, s[8:11], s30 offen offset:0  lds
  buffer_load_dwordx4 v2, s[8:11], s30 offen offset:1024  lds
  buffer_load_dwordx4 v2, s[8:11], s30 offen offset:2048  lds
  buffer_load_dwordx4 v2, s[8:11], s30 offen offset:3072  lds
  s_add_u32 m0, s26, 96256
  s_nop 0
  buffer_load_dwordx4 v3, s[8:11], s30 offen offset:0  lds
  buffer_load_dwordx4 v3, s[8:11], s30 offen offset:1024  lds
  buffer_load_dwordx4 v3, s[8:11], s30 offen offset:2048  lds
  s_add_u32 m0, s23, 141312
  s_mov_b32 s25, 0
  buffer_load_dwordx4 v251, s[12:15], s25 offen lds
  s_waitcnt vmcnt(12)
  s_barrier
  s_mov_b32 s30, 172032
  s_mov_b32 s31, 1572864
  s_add_u32 m0, s27, 0
  s_nop 0
  buffer_load_dwordx4 v4, s[12:15], s31 offen  lds
  s_add_u32 m0, s27, 1088
  s_nop 0
  buffer_load_dwordx4 v5, s[12:15], s31 offen  lds
  s_add_u32 m0, s27, 2176
  s_nop 0
  buffer_load_dwordx4 v6, s[12:15], s31 offen  lds
  s_add_u32 m0, s27, 3264
  s_nop 0
  buffer_load_dwordx4 v7, s[12:15], s31 offen  lds
  s_add_u32 m0, s26, 0
  s_nop 0
  buffer_load_dwordx4 v2, s[8:11], s30 offen offset:0  lds
  buffer_load_dwordx4 v2, s[8:11], s30 offen offset:1024  lds
  buffer_load_dwordx4 v2, s[8:11], s30 offen offset:2048  lds
  buffer_load_dwordx4 v2, s[8:11], s30 offen offset:3072  lds
  s_add_u32 m0, s26, 4096
  s_nop 0
  buffer_load_dwordx4 v3, s[8:11], s30 offen offset:0  lds
  buffer_load_dwordx4 v3, s[8:11], s30 offen offset:1024  lds
  buffer_load_dwordx4 v3, s[8:11], s30 offen offset:2048  lds
  s_add_u32 m0, s23, 145408
  s_mov_b32 s25, 1048576
  buffer_load_dwordx4 v251, s[12:15], s25 offen lds
  s_waitcnt vmcnt(13)
  s_barrier
  s_mov_b32 s30, 200704
  s_mov_b32 s31, 1835008
  s_add_u32 m0, s27, 46080
  s_nop 0
  buffer_load_dwordx4 v4, s[12:15], s31 offen  lds
  s_add_u32 m0, s27, 47168
  s_nop 0
  buffer_load_dwordx4 v5, s[12:15], s31 offen  lds
  s_add_u32 m0, s27, 48256
  s_nop 0
  buffer_load_dwordx4 v6, s[12:15], s31 offen  lds
  s_add_u32 m0, s27, 49344
  s_nop 0
  buffer_load_dwordx4 v7, s[12:15], s31 offen  lds
  s_add_u32 m0, s26, 46080
  s_nop 0
  buffer_load_dwordx4 v2, s[8:11], s30 offen offset:0  lds
  buffer_load_dwordx4 v2, s[8:11], s30 offen offset:1024  lds
  buffer_load_dwordx4 v2, s[8:11], s30 offen offset:2048  lds
  buffer_load_dwordx4 v2, s[8:11], s30 offen offset:3072  lds
  s_add_u32 m0, s26, 50176
  s_nop 0
  buffer_load_dwordx4 v3, s[8:11], s30 offen offset:0  lds
  buffer_load_dwordx4 v3, s[8:11], s30 offen offset:1024  lds
  buffer_load_dwordx4 v3, s[8:11], s30 offen offset:2048  lds
  s_add_u32 m0, s23, 149504
  s_mov_b32 s25, 2097152
  buffer_load_dwordx4 v251, s[12:15], s25 offen lds
  s_waitcnt vmcnt(13)
  s_barrier
  s_mov_b32 s30, 229376
  s_mov_b32 s31, 2097152
  s_add_u32 m0, s27, 92160
  s_nop 0
  buffer_load_dwordx4 v4, s[12:15], s31 offen  lds
  s_add_u32 m0, s27, 93248
  s_nop 0
  buffer_load_dwordx4 v5, s[12:15], s31 offen  lds
  s_add_u32 m0, s27, 94336
  s_nop 0
  buffer_load_dwordx4 v6, s[12:15], s31 offen  lds
  s_add_u32 m0, s27, 95424
  s_nop 0
  buffer_load_dwordx4 v7, s[12:15], s31 offen  lds
  s_add_u32 m0, s26, 92160
  s_nop 0
  buffer_load_dwordx4 v2, s[8:11], s30 offen offset:0  lds
  buffer_load_dwordx4 v2, s[8:11], s30 offen offset:1024  lds
  buffer_load_dwordx4 v2, s[8:11], s30 offen offset:2048  lds
  buffer_load_dwordx4 v2, s[8:11], s30 offen offset:3072  lds
  s_add_u32 m0, s26, 96256
  s_nop 0
  buffer_load_dwordx4 v3, s[8:11], s30 offen offset:0  lds
  buffer_load_dwordx4 v3, s[8:11], s30 offen offset:1024  lds
  buffer_load_dwordx4 v3, s[8:11], s30 offen offset:2048  lds
  s_add_u32 m0, s23, 153600
  s_mov_b32 s25, 3145728
  buffer_load_dwordx4 v251, s[12:15], s25 offen lds
  s_waitcnt vmcnt(13)
  s_barrier
  s_mov_b32 s30, 258048
  s_mov_b32 s31, 2359296
  s_add_u32 m0, s27, 0
  s_nop 0
  buffer_load_dwordx4 v4, s[12:15], s31 offen  lds
  s_add_u32 m0, s27, 1088
  s_nop 0
  buffer_load_dwordx4 v5, s[12:15], s31 offen  lds
  s_add_u32 m0, s27, 2176
  s_nop 0
  buffer_load_dwordx4 v6, s[12:15], s31 offen  lds
  s_add_u32 m0, s27, 3264
  s_nop 0
  buffer_load_dwordx4 v7, s[12:15], s31 offen  lds
  s_add_u32 m0, s26, 0
  s_nop 0
  buffer_load_dwordx4 v2, s[8:11], s30 offen offset:0  lds
  buffer_load_dwordx4 v2, s[8:11], s30 offen offset:1024  lds
  buffer_load_dwordx4 v2, s[8:11], s30 offen offset:2048  lds
  buffer_load_dwordx4 v2, s[8:11], s30 offen offset:3072  lds
  s_add_u32 m0, s26, 4096
  s_nop 0
  buffer_load_dwordx4 v3, s[8:11], s30 offen offset:0  lds
  buffer_load_dwordx4 v3, s[8:11], s30 offen offset:1024  lds
  buffer_load_dwordx4 v3, s[8:11], s30 offen offset:2048  lds
  s_cmp_eq_u32 s63, 0
  s_cbranch_scc1 L_mlp_kernel_rf_2
  global_load_dword v39, v38, s[64:65]
L_mlp_kernel_rf_2:
  s_waitcnt vmcnt(12)
  s_barrier
  s_mov_b32 s30, 286720
  s_mov_b32 s31, 2621440
  s_add_u32 m0, s27, 46080
  s_nop 0
  buffer_load_dwordx4 v4, s[12:15], s31 offen  lds
  s_add_u32 m0, s27, 47168
  s_nop 0
  buffer_load_dwordx4 v5, s[12:15], s31 offen  lds
  s_add_u32 m0, s27, 48256
  s_nop 0
  buffer_load_dwordx4 v6, s[12:15], s31 offen  lds
  s_add_u32 m0, s27, 49344
  s_nop 0
  buffer_load_dwordx4 v7, s[12:15], s31 offen  lds
  s_add_u32 m0, s26, 46080
  s_nop 0
  buffer_load_dwordx4 v2, s[8:11], s30 offen offset:0  lds
  buffer_load_dwordx4 v2, s[8:11], s30 offen offset:1024  lds
  buffer_load_dwordx4 v2, s[8:11], s30 offen offset:2048  lds
  buffer_load_dwordx4 v2, s[8:11], s30 offen offset:3072  lds
  s_add_u32 m0, s26, 50176
  s_nop 0
  buffer_load_dwordx4 v3, s[8:11], s30 offen offset:0  lds
  buffer_load_dwordx4 v3, s[8:11], s30 offen offset:1024  lds
  buffer_load_dwordx4 v3, s[8:11], s30 offen offset:2048  lds
  s_waitcnt vmcnt(11)
  s_barrier
  ds_read_b128 v[12:15], v252 offset:0
  ds_read_b128 v[16:19], v253 offset:0
  ds_read_b128 v[20:23], v252 offset:8192
  ds_read_b128 v[24:27], v253 offset:8192
  s_mov_b32 s30, 315392
  s_mov_b32 s31, 2883584
  s_add_u32 m0, s27, 92160
  s_nop 0
  buffer_load_dwordx4 v4, s[12:15], s31 offen  lds
  s_add_u32 m0, s27, 93248
  s_nop 0
  buffer_load_dwordx4 v5, s[12:15], s31 offen  lds
  s_add_u32 m0, s27, 94336
  s_nop 0
  buffer_load_dwordx4 v6, s[12:15], s31 offen  lds
  s_add_u32 m0, s27, 95424
  s_nop 0
  buffer_load_dwordx4 v7, s[12:15], s31 offen  lds
  s_add_u32 m0, s26, 92160
  s_nop 0
  buffer_load_dwordx4 v2, s[8:11], s30 offen offset:0  lds
  buffer_load_dwordx4 v2, s[8:11], s30 offen offset:1024  lds
  buffer_load_dwordx4 v2, s[8:11], s30 offen offset:2048  lds
  buffer_load_dwordx4 v2, s[8:11], s30 offen offset:3072  lds
  s_add_u32 m0, s26, 96256
  s_nop 0
  buffer_load_dwordx4 v3, s[8:11], s30 offen offset:0  lds
  buffer_load_dwordx4 v3, s[8:11], s30 offen offset:1024  lds
  buffer_load_dwordx4 v3, s[8:11], s30 offen offset:2048  lds
  s_waitcnt lgkmcnt(0)
  s_setprio 3
  v_dot2_f32_bf16 v40, v12, v12, 0
  v_dot2_f32_bf16 v41, v14, v14, 0
  v_dot2_f32_bf16 v40, v13, v13, v40
  v_dot2_f32_bf16 v41, v15, v15, v41
  v_dot2_f32_bf16 v40, v16, v16, v40
  v_dot2_f32_bf16 v41, v18, v18, v41
  v_dot2_f32_bf16 v40, v17, v17, v40
  v_dot2_f32_bf16 v41, v19, v19, v41
  v_dot2_f32_bf16 v40, v20, v20, v40
  v_dot2_f32_bf16 v41, v22, v22, v41
  v_dot2_f32_bf16 v40, v21, v21, v40
  v_dot2_f32_bf16 v41, v23, v23, v41
  v_dot2_f32_bf16 v40, v24, v24, v40
  v_dot2_f32_bf16 v41, v26, v26, v41
  v_dot2_f32_bf16 v40, v25, v25, v40
  v_dot2_f32_bf16 v41, v27, v27, v41
  s_nop 1
  v_add_f32_dpp v40, v40, v40 row_shr:1 row_mask:0xf bank_mask:0xf
  v_add_f32_dpp v41, v41, v41 row_shr:1 row_mask:0xf bank_mask:0xf
  s_nop 0
  v_add_f32_dpp v40, v40, v40 row_shr:2 row_mask:0xf bank_mask:0xf
  v_add_f32_dpp v41, v41, v41 row_shr:2 row_mask:0xf bank_mask:0xf
  s_nop 0
  v_add_f32_dpp v40, v40, v40 row_shr:4 row_mask:0xf bank_mask:0xf
  v_add_f32_dpp v41, v41, v41 row_shr:4 row_mask:0xf bank_mask:0xf
  s_nop 0
  v_add_f32_dpp v40, v40, v40 row_shr:8 row_mask:0xf bank_mask:0xf
  v_add_f32_dpp v41, v41, v41 row_shr:8 row_mask:0xf bank_mask:0xf
  s_nop 0
  v_add_f32_dpp v40, v40, v40 row_bcast:15 row_mask:0xa bank_mask:0xf
  v_add_f32_dpp v41, v41, v41 row_bcast:15 row_mask:0xa bank_mask:0xf
  s_nop 0
  v_add_f32_dpp v40, v40, v40 row_bcast:31 row_mask:0xc bank_mask:0xf
  v_add_f32_dpp v41, v41, v41 row_bcast:31 row_mask:0xc bank_mask:0xf
  v_mov_b32 v42, 0x3727c5ac
  v_fmamk_f32 v40, v40, 0x36000000, v42
  v_fmamk_f32 v41, v41, 0x36000000, v42
  v_rsq_f32 v40, v40
  v_rsq_f32 v41, v41
  v_mul_f32 v40, 0x3a6ff558, v40
  v_mul_f32 v41, 0x3a6ff558, v41
  v_or_b32 v40, 1, v40
  v_or_b32 v41, 1, v41
  s_mov_b32 exec_lo, 0
  s_mov_b32 exec_hi, 0x80000000
  buffer_store_dwordx2 v[40:41], off, s[44:47], s24 sc0 sc1
  s_mov_b64 exec, -1
  s_setprio 0
  s_waitcnt vmcnt(12)
  s_barrier
  s_mov_b32 s30, 344064
  s_mov_b32 s31, 3145728
  s_add_u32 m0, s27, 0
  s_nop 0
  buffer_load_dwordx4 v4, s[12:15], s31 offen  lds
  s_add_u32 m0, s27, 1088
  s_nop 0
  buffer_load_dwordx4 v5, s[12:15], s31 offen  lds
  s_add_u32 m0, s27, 2176
  s_nop 0
  buffer_load_dwordx4 v6, s[12:15], s31 offen  lds
  s_add_u32 m0, s27, 3264
  s_nop 0
  buffer_load_dwordx4 v7, s[12:15], s31 offen  lds
  s_add_u32 m0, s26, 0
  s_nop 0
  buffer_load_dwordx4 v2, s[8:11], s30 offen offset:0  lds
  buffer_load_dwordx4 v2, s[8:11], s30 offen offset:1024  lds
  buffer_load_dwordx4 v2, s[8:11], s30 offen offset:2048  lds
  buffer_load_dwordx4 v2, s[8:11], s30 offen offset:3072  lds
  s_add_u32 m0, s26, 4096
  s_nop 0
  buffer_load_dwordx4 v3, s[8:11], s30 offen offset:0  lds
  buffer_load_dwordx4 v3, s[8:11], s30 offen offset:1024  lds
  buffer_load_dwordx4 v3, s[8:11], s30 offen offset:2048  lds
  s_waitcnt vmcnt(12)
  s_barrier
  s_mov_b32 s30, 372736
  s_mov_b32 s31, 3407872
  s_add_u32 m0, s27, 46080
  s_nop 0
  buffer_load_dwordx4 v4, s[12:15], s31 offen  lds
  s_add_u32 m0, s27, 47168
  s_nop 0
  buffer_load_dwordx4 v5, s[12:15], s31 offen  lds
  s_add_u32 m0, s27, 48256
  s_nop 0
  buffer_load_dwordx4 v6, s[12:15], s31 offen  lds
  s_add_u32 m0, s27, 49344
  s_nop 0
  buffer_load_dwordx4 v7, s[12:15], s31 offen  lds
  s_add_u32 m0, s26, 46080
  s_nop 0
  buffer_load_dwordx4 v2, s[8:11], s30 offen offset:0  lds
  buffer_load_dwordx4 v2, s[8:11], s30 offen offset:1024  lds
  buffer_load_dwordx4 v2, s[8:11], s30 offen offset:2048  lds
  buffer_load_dwordx4 v2, s[8:11], s30 offen offset:3072  lds
  s_add_u32 m0, s26, 50176
  s_nop 0
  buffer_load_dwordx4 v3, s[8:11], s30 offen offset:0  lds
  buffer_load_dwordx4 v3, s[8:11], s30 offen offset:1024  lds
  buffer_load_dwordx4 v3, s[8:11], s30 offen offset:2048  lds
  s_waitcnt vmcnt(11)
  s_barrier
  s_mov_b32 s30, 401408
  s_mov_b32 s31, 3670016
  s_add_u32 m0, s27, 92160
  s_nop 0
  buffer_load_dwordx4 v4, s[12:15], s31 offen  lds
  s_add_u32 m0, s27, 93248
  s_nop 0
  buffer_load_dwordx4 v5, s[12:15], s31 offen  lds
  s_add_u32 m0, s27, 94336
  s_nop 0
  buffer_load_dwordx4 v6, s[12:15], s31 offen  lds
  s_add_u32 m0, s27, 95424
  s_nop 0
  buffer_load_dwordx4 v7, s[12:15], s31 offen  lds
  s_add_u32 m0, s26, 92160
  s_nop 0
  buffer_load_dwordx4 v2, s[8:11], s30 offen offset:0  lds
  buffer_load_dwordx4 v2, s[8:11], s30 offen offset:1024  lds
  buffer_load_dwordx4 v2, s[8:11], s30 offen offset:2048  lds
  buffer_load_dwordx4 v2, s[8:11], s30 offen offset:3072  lds
  s_add_u32 m0, s26, 96256
  s_nop 0
  buffer_load_dwordx4 v3, s[8:11], s30 offen offset:0  lds
  buffer_load_dwordx4 v3, s[8:11], s30 offen offset:1024  lds
  buffer_load_dwordx4 v3, s[8:11], s30 offen offset:2048  lds
  s_mov_b32 s56, s20
  s_and_b32 s57, s21, 7
  s_lshr_b32 s58, s21, 3
  s_and_b32 s59, s57, 3
  s_lshl_b32 s59, s59, 7
  s_and_b32 s55, s57, 4
  s_lshl_b32 s55, s55, 8
  s_add_u32 s59, s59, s55
  s_cmp_lg_u32 s22, 0
  s_cbranch_scc1 L_mlp_kernel_sm_3
  s_add_u32 s36, s4, 0x408000
  s_addc_u32 s37, s5, 0
  s_mov_b32 s38, 0x3800
  s_mov_b32 s39, 0x20000
  s_mul_i32 s30, s21, 896
  s_mov_b32 m0, 139264
  s_nop 0
  buffer_load_dwordx4 v35, s[36:39], s30 offen lds
L_mlp_kernel_sm_3:
  s_mov_b32 exec_hi, 0
  s_cmp_lg_u32 s22, 1
  s_cbranch_scc1 L_mlp_kernel_sm_4
  s_lshl_b32 s30, s20, 9
  s_add_u32 s30, s30, 0x8000
  s_mov_b32 m0, 138752
  s_nop 0
  buffer_load_dwordx4 v35, s[44:47], s30 offen sc0 sc1 lds
L_mlp_kernel_sm_4:
  s_cmp_lg_u32 s22, 2
  s_cbranch_scc1 L_mlp_kernel_sm_5
  s_mov_b32 s36, s34
  s_mov_b32 s37, s35
  s_mov_b32 s38, 0x800
  s_mov_b32 s39, 0x20000
  s_cmp_eq_u32 s58, 0
  s_cselect_b32 s38, s38, 0
  s_mov_b64 exec, 0xffff
  s_mov_b32 m0, 140288
  s_nop 0
  buffer_load_dwordx4 v36, s[36:39], s59 offen lds
L_mlp_kernel_sm_5:
  s_mov_b64 exec, -1
  s_waitcnt vmcnt(11)
  s_barrier
  s_mov_b32 s30, 430080
  s_mov_b32 s31, 3932160
  s_add_u32 m0, s27, 0
  s_nop 0
  buffer_load_dwordx4 v4, s[12:15], s31 offen  lds
  s_add_u32 m0, s27, 1088
  s_nop 0
  buffer_load_dwordx4 v5, s[12:15], s31 offen  lds
  s_add_u32 m0, s27, 2176
  s_nop 0
  buffer_load_dwordx4 v6, s[12:15], s31 offen  lds
  s_add_u32 m0, s27, 3264
  s_nop 0
  buffer_load_dwordx4 v7, s[12:15], s31 offen  lds
  s_add_u32 m0, s26, 0
  s_nop 0
  buffer_load_dwordx4 v2, s[8:11], s30 offen offset:0  lds
  buffer_load_dwordx4 v2, s[8:11], s30 offen offset:1024  lds
  buffer_load_dwordx4 v2, s[8:11], s30 offen offset:2048  lds
  buffer_load_dwordx4 v2, s[8:11], s30 offen offset:3072  lds
  s_add_u32 m0, s26, 4096
  s_nop 0
  buffer_load_dwordx4 v3, s[8:11], s30 offen offset:0  lds
  buffer_load_dwordx4 v3, s[8:11], s30 offen offset:1024  lds
  buffer_load_dwordx4 v3, s[8:11], s30 offen offset:2048  lds
  s_cmp_lg_u32 s3, 0
  s_cbranch_scc1 L_mlp_kernel_nt_6
  buffer_load_dword v33, v34, s[16:19], 0 offen
L_mlp_kernel_nt_6:
  s_waitcnt vmcnt(12)
  s_cmp_eq_u32 s3, 0
  s_cbranch_scc1 L_mlp_kernel_w_7
  s_waitcnt vmcnt(11)
L_mlp_kernel_w_7:
  s_barrier
  s_waitcnt vmcnt(1)
  s_cmp_eq_u32 s3, 0
  s_cbranch_scc1 L_mlp_kernel_w_8
  s_waitcnt vmcnt(0)
L_mlp_kernel_w_8:
  s_barrier
  s_barrier
  s_setprio 3
  s_mov_b32 s56, s20
  s_and_b32 s57, s21, 7
  s_lshr_b32 s58, s21, 3
  s_and_b32 s59, s57, 3
  s_lshl_b32 s59, s59, 7
  s_and_b32 s55, s57, 4
  s_lshl_b32 s55, s55, 8
  s_add_u32 s59, s59, s55
  s_add_u32 s36, s4, 0x1000000
  s_addc_u32 s37, s5, 0
  s_mov_b32 s38, 0x1c0000
  s_mov_b32 s39, 0x20000
  s_lshr_b32 s30, s57, 2
  s_mul_i32 s30, s30, 917504
  s_and_b32 s29, s57, 3
  s_cmp_eq_u32 s29, 3
  s_cselect_b32 s36, s36, s16
  s_cselect_b32 s37, s37, s17
  s_cselect_b32 s38, s38, s18
  s_cselect_b32 s60, 0, 3
  s_cselect_b32 s61, s30, s59
  s_mul_i32 s29, s58, 458752
  s_and_b32 s30, s22, 1
  s_lshl_b32 s30, s30, 12
  s_add_u32 s29, s29, s30
  s_lshr_b32 s30, s22, 1
  s_lshl_b32 s31, s30, 15
  s_add_u32 s29, s29, s31
  s_mul_i32 s30, s30, 24576
  v_lshrrev_b32 v71, 3, v1
  v_lshl_add_u32 v71, v71, 8, s29
  v_lshrrev_b32 v70, 4, v1
  v_lshlrev_b32 v70, 1, v70
  v_xor_b32 v70, v70, v1
  v_and_b32 v70, 7, v70
  v_lshlrev_b32 v70, 4, v70
  v_lshlrev_b32 v64, s60, v71
  v_add3_u32 v64, v64, v70, s61
  s_add_u32 s31, s59, 512
  v_lshlrev_b32 v66, 3, v71
  v_add3_u32 v66, v66, v70, s31
  s_lshl_b32 s31, 0x800, s60
  s_sub_u32 s31, s31, 1024
  v_add_u32 v65, s31, v64
  v_add_u32 v67, 15360, v66
  s_lshl_b32 s31, s30, s60
  v_add_u32 v68, s31, v64
  v_add_u32 v69, s31, v65
  s_lshl_b32 s31, s30, 3
  v_add_u32 v70, s31, v66
  v_add_u32 v71, s31, v67
  s_add_u32 s40, s4, 0x1800000
  s_addc_u32 s41, s5, 0
  s_mov_b32 s42, 0x1c00000
  s_mov_b32 s43, 0x20000
  v_lshlrev_b32 v72, 4, v1
  v_add_u32 v73, 0x300, v72
  v_add_u32 v74, 0x80, v72
  v_cmp_lt_u32 vcc, 23, v1
  s_nop 1
  v_cndmask_b32 v72, v72, v74, vcc
  v_add_u32 v74, 0x80, v73
  v_cmp_lt_u32 vcc, 39, v1
  s_nop 1
  v_cndmask_b32 v73, v73, v74, vcc
  s_lshl_b32 s28, s22, 12
  s_lshr_b32 s62, s22, 1
  s_lshl_b32 s62, s62, 13
  s_and_b32 s31, s22, 1
  s_lshl_b32 s31, s31, 11
  s_add_u32 s62, s62, s31
  s_mul_i32 s31, s56, 917504
  s_add_u32 s31, s31, s29
  s_lshl_b32 s31, s31, 1
  s_lshl_b32 s30, s30, 1
  v_add_u32 v72, s31, v72
  s_add_u32 s31, s31, 1024
  v_add_u32 v73, s31, v73
  v_add_u32 v74, 0x800, v72
  v_add_u32 v75, 0x800, v73
  v_add_u32 v76, s30, v72
  v_add_u32 v77, s30, v73
  v_add_u32 v78, s30, v74
  v_add_u32 v79, s30, v75
  s_lshl1_add_u32 s31, s56, s58
  s_lshl3_add_u32 s31, s31, s57
  s_lshl_b32 s31, s31, 7
  v_and_b32 v37, 7, v1
  v_lshl_add_u32 v32, v37, 2, s31
  s_lshr_b32 s31, s21, 3
  s_lshl1_add_u32 s31, s20, s31
  s_lshl_b32 s31, s31, 10
  s_and_b32 s30, s21, 7
  s_lshl2_add_u32 s31, s30, s31
  v_lshl_add_u32 v37, v37, 7, s31
  v_mov_b32 v56, 1
  v_mov_b32 v57, 2
  v_mov_b32 v58, 3
  s_xor_b32 s48, s57, 0
  s_mul_i32 s48, s48, 57344
  s_xor_b32 s49, s57, 1
  s_mul_i32 s49, s49, 57344
  s_xor_b32 s50, s57, 2
  s_mul_i32 s50, s50, 57344
  s_xor_b32 s51, s57, 3
  s_mul_i32 s51, s51, 57344
  s_xor_b32 s52, s57, 4
  s_mul_i32 s52, s52, 57344
  s_xor_b32 s53, s57, 5
  s_mul_i32 s53, s53, 57344
  s_xor_b32 s54, s57, 6
  s_mul_i32 s54, s54, 57344
  s_xor_b32 s55, s57, 7
  s_mul_i32 s55, s55, 57344
  s_setprio 0
  s_add_u32 m0, s62, 0
  s_add_u32 s30, s48, 0
  s_lshl_b32 s31, s30, s60
  s_lshl_b32 s30, s30, 3
  buffer_load_dwordx4 v64, s[36:39], s31 offen offset:0 lds
  buffer_load_dwordx4 v65, s[36:39], s31 offen offset:1024 lds
  s_add_u32 m0, s62, 4096
  s_nop 0
  buffer_load_dwordx4 v66, s[16:19], s30 offen offset:0 lds
  buffer_load_dwordx4 v67, s[16:19], s30 offen offset:1024 lds
  s_add_u32 m0, s62, 32768
  s_add_u32 s30, s48, 8192
  s_lshl_b32 s31, s30, s60
  s_lshl_b32 s30, s30, 3
  buffer_load_dwordx4 v64, s[36:39], s31 offen offset:0 lds
  buffer_load_dwordx4 v65, s[36:39], s31 offen offset:1024 lds
  s_add_u32 m0, s62, 36864
  s_nop 0
  buffer_load_dwordx4 v66, s[16:19], s30 offen offset:0 lds
  buffer_load_dwordx4 v67, s[16:19], s30 offen offset:1024 lds
  s_add_u32 m0, s62, 65536
  s_add_u32 s30, s48, 16384
  s_lshl_b32 s31, s30, s60
  s_lshl_b32 s30, s30, 3
  buffer_load_dwordx4 v64, s[36:39], s31 offen offset:0 lds
  buffer_load_dwordx4 v65, s[36:39], s31 offen offset:1024 lds
  s_add_u32 m0, s62, 69632
  s_nop 0
  buffer_load_dwordx4 v66, s[16:19], s30 offen offset:0 lds
  buffer_load_dwordx4 v67, s[16:19], s30 offen offset:1024 lds
  s_add_u32 m0, s62, 98304
  s_add_u32 s30, s49, 0
  s_lshl_b32 s31, s30, s60
  s_lshl_b32 s30, s30, 3
  buffer_load_dwordx4 v64, s[36:39], s31 offen offset:0 lds
  buffer_load_dwordx4 v65, s[36:39], s31 offen offset:1024 lds
  s_add_u32 m0, s62, 102400
  s_nop 0
  buffer_load_dwordx4 v66, s[16:19], s30 offen offset:0 lds
  buffer_load_dwordx4 v67, s[16:19], s30 offen offset:1024 lds
  s_cmp_lg_u32 s22, 0
  s_cbranch_scc1 L_mlp_kernel_w0_9
  s_setprio 3
  s_mov_b32 s31, 6400000
L_mlp_kernel_lspin_10:
  ds_read_b32 v61, v60 offset:0
  s_waitcnt lgkmcnt(0)
  v_cmp_gt_u32 vcc, 4, v61
  s_nop 1
  s_cbranch_vccz L_mlp_kernel_lok_11
  s_sleep 2
  s_sub_u32 s31, s31, 1
  s_cmp_lg_u32 s31, 0
  s_cbranch_scc1 L_mlp_kernel_lspin_10
L_mlp_kernel_lok_11:
  s_mov_b64 exec, 0xff
  buffer_store_dword v56, v37, s[44:47], 0 offen sc0 sc1
  s_mov_b64 exec, -1
  s_setprio 0
L_mlp_kernel_w0_9:
  s_waitcnt vmcnt(12) lgkmcnt(0)
  s_barrier
  s_waitcnt vmcnt(8) lgkmcnt(0)
  s_cmp_lg_u32 s22, 0
  s_cbranch_scc1 L_mlp_kernel_w0_12
  buffer_load_dword v33, v32, s[44:47], 0 offen sc0 sc1
  s_waitcnt vmcnt(0)
  s_setprio 3
  s_mov_b32 s31, 400000
L_mlp_kernel_spin_13:
  v_cmp_gt_u32 vcc, 1, v33
  s_nop 1
  s_cbranch_vccz L_mlp_kernel_ok_14
  s_sleep 4
  buffer_load_dword v33, v32, s[44:47], 0 offen sc0 sc1
  s_sub_u32 s31, s31, 1
  s_cmp_lg_u32 s31, 0
  s_waitcnt vmcnt(0)
  s_cbranch_scc1 L_mlp_kernel_spin_13
L_mlp_kernel_ok_14:
  s_setprio 0
L_mlp_kernel_w0_12:
  s_barrier
  s_cmp_lg_u32 s22, 0
  s_cbranch_scc1 L_mlp_kernel_w0_15
  s_mov_b64 exec, 0xff
  buffer_store_dword v57, v37, s[44:47], 0 offen sc0 sc1
  s_mov_b64 exec, -1
L_mlp_kernel_w0_15:
  s_add_u32 m0, s28, 114688
  s_add_u32 s30, s49, 0
  s_lshl_b32 s30, s30, 1
  buffer_load_dwordx4 v72, s[40:43], s30 offen offset:0 sc0 sc1 lds
  buffer_load_dwordx4 v73, s[40:43], s30 offen offset:1024 sc0 sc1 lds
  buffer_load_dwordx4 v74, s[40:43], s30 offen offset:2048 sc0 sc1 lds
  buffer_load_dwordx4 v75, s[40:43], s30 offen offset:3072 sc0 sc1 lds
  s_add_u32 m0, s62, 0
  s_add_u32 s30, s50, 0
  s_lshl_b32 s31, s30, s60
  s_lshl_b32 s30, s30, 3
  buffer_load_dwordx4 v64, s[36:39], s31 offen offset:0 lds
  buffer_load_dwordx4 v65, s[36:39], s31 offen offset:1024 lds
  s_add_u32 m0, s62, 4096
  s_nop 0
  buffer_load_dwordx4 v66, s[16:19], s30 offen offset:0 lds
  buffer_load_dwordx4 v67, s[16:19], s30 offen offset:1024 lds
  s_add_u32 m0, s28, 16384
  s_add_u32 s30, s50, 0
  s_lshl_b32 s30, s30, 1
  buffer_load_dwordx4 v72, s[40:43], s30 offen offset:0 sc0 sc1 lds
  buffer_load_dwordx4 v73, s[40:43], s30 offen offset:1024 sc0 sc1 lds
  buffer_load_dwordx4 v74, s[40:43], s30 offen offset:2048 sc0 sc1 lds
  buffer_load_dwordx4 v75, s[40:43], s30 offen offset:3072 sc0 sc1 lds
  s_waitcnt vmcnt(16) lgkmcnt(0)
  s_barrier
  s_add_u32 m0, s62, 32768
  s_add_u32 s30, s51, 0
  s_lshl_b32 s31, s30, s60
  s_lshl_b32 s30, s30, 3
  buffer_load_dwordx4 v64, s[36:39], s31 offen offset:0 lds
  buffer_load_dwordx4 v65, s[36:39], s31 offen offset:1024 lds
  s_add_u32 m0, s62, 36864
  s_nop 0
  buffer_load_dwordx4 v66, s[16:19], s30 offen offset:0 lds
  buffer_load_dwordx4 v67, s[16:19], s30 offen offset:1024 lds
  s_add_u32 m0, s28, 49152
  s_add_u32 s30, s51, 0
  s_lshl_b32 s30, s30, 1
  buffer_load_dwordx4 v72, s[40:43], s30 offen offset:0 sc0 sc1 lds
  buffer_load_dwordx4 v73, s[40:43], s30 offen offset:1024 sc0 sc1 lds
  buffer_load_dwordx4 v74, s[40:43], s30 offen offset:2048 sc0 sc1 lds
  buffer_load_dwordx4 v75, s[40:43], s30 offen offset:3072 sc0 sc1 lds
  s_waitcnt vmcnt(16) lgkmcnt(0)
  s_barrier
  s_cmp_lg_u32 s22, 0
  s_cbranch_scc1 L_mlp_kernel_w0_16
  s_mov_b64 exec, 0xff
  buffer_store_dword v58, v37, s[44:47], 0 offen sc0 sc1
  s_mov_b64 exec, -1
L_mlp_kernel_w0_16:
  s_add_u32 m0, s62, 65536
  s_add_u32 s30, s52, 0
  s_lshl_b32 s31, s30, s60
  s_lshl_b32 s30, s30, 3
  buffer_load_dwordx4 v64, s[36:39], s31 offen offset:0 lds
  buffer_load_dwordx4 v65, s[36:39], s31 offen offset:1024 lds
  s_add_u32 m0, s62, 69632
  s_nop 0
  buffer_load_dwordx4 v66, s[16:19], s30 offen offset:0 lds
  buffer_load_dwordx4 v67, s[16:19], s30 offen offset:1024 lds
  s_add_u32 m0, s28, 81920
  s_add_u32 s30, s52, 0
  s_lshl_b32 s30, s30, 1
  buffer_load_dwordx4 v72, s[40:43], s30 offen offset:0 sc0 sc1 lds
  buffer_load_dwordx4 v73, s[40:43], s30 offen offset:1024 sc0 sc1 lds
  buffer_load_dwordx4 v74, s[40:43], s30 offen offset:2048 sc0 sc1 lds
  buffer_load_dwordx4 v75, s[40:43], s30 offen offset:3072 sc0 sc1 lds
  s_waitcnt vmcnt(16) lgkmcnt(0)
  s_barrier
  s_add_u32 m0, s62, 98304
  s_add_u32 s30, s53, 0
  s_lshl_b32 s31, s30, s60
  s_lshl_b32 s30, s30, 3
  buffer_load_dwordx4 v64, s[36:39], s31 offen offset:0 lds
  buffer_load_dwordx4 v65, s[36:39], s31 offen offset:1024 lds
  s_add_u32 m0, s62, 102400
  s_nop 0
  buffer_load_dwordx4 v66, s[16:19], s30 offen offset:0 lds
  buffer_load_dwordx4 v67, s[16:19], s30 offen offset:1024 lds
  s_add_u32 m0, s28, 114688
  s_add_u32 s30, s53, 0
  s_lshl_b32 s30, s30, 1
  buffer_load_dwordx4 v72, s[40:43], s30 offen offset:0 sc0 sc1 lds
  buffer_load_dwordx4 v73, s[40:43], s30 offen offset:1024 sc0 sc1 lds
  buffer_load_dwordx4 v74, s[40:43], s30 offen offset:2048 sc0 sc1 lds
  buffer_load_dwordx4 v75, s[40:43], s30 offen offset:3072 sc0 sc1 lds
  s_cmp_eq_u32 s63, 0
  s_cbranch_scc1 L_mlp_kernel_rf_17
  global_load_dword v39, v38, s[64:65]
L_mlp_kernel_rf_17:
  s_waitcnt vmcnt(16) lgkmcnt(0)
  s_barrier
  s_cmp_lg_u32 s22, 0
  s_cbranch_scc1 L_mlp_kernel_w0_18
  buffer_load_dword v33, v32, s[44:47], 0 offen sc0 sc1
L_mlp_kernel_w0_18:
  s_add_u32 m0, s62, 0
  s_add_u32 s30, s54, 0
  s_lshl_b32 s31, s30, s60
  s_lshl_b32 s30, s30, 3
  buffer_load_dwordx4 v64, s[36:39], s31 offen offset:0 lds
  buffer_load_dwordx4 v65, s[36:39], s31 offen offset:1024 lds
  s_add_u32 m0, s62, 4096
  s_nop 0
  buffer_load_dwordx4 v66, s[16:19], s30 offen offset:0 lds
  buffer_load_dwordx4 v67, s[16:19], s30 offen offset:1024 lds
  s_add_u32 m0, s28, 16384
  s_add_u32 s30, s54, 0
  s_lshl_b32 s30, s30, 1
  buffer_load_dwordx4 v72, s[40:43], s30 offen offset:0 sc0 sc1 lds
  buffer_load_dwordx4 v73, s[40:43], s30 offen offset:1024 sc0 sc1 lds
  buffer_load_dwordx4 v74, s[40:43], s30 offen offset:2048 sc0 sc1 lds
  buffer_load_dwordx4 v75, s[40:43], s30 offen offset:3072 sc0 sc1 lds
  s_waitcnt vmcnt(16) lgkmcnt(0)
  s_barrier
  s_add_u32 m0, s62, 32768
  s_add_u32 s30, s55, 0
  s_lshl_b32 s31, s30, s60
  s_lshl_b32 s30, s30, 3
  buffer_load_dwordx4 v64, s[36:39], s31 offen offset:0 lds
  buffer_load_dwordx4 v65, s[36:39], s31 offen offset:1024 lds
  s_add_u32 m0, s62, 36864
  s_nop 0
  buffer_load_dwordx4 v66, s[16:19], s30 offen offset:0 lds
  buffer_load_dwordx4 v67, s[16:19], s30 offen offset:1024 lds
  s_add_u32 m0, s28, 49152
  s_add_u32 s30, s55, 0
  s_lshl_b32 s30, s30, 1
  buffer_load_dwordx4 v72, s[40:43], s30 offen offset:0 sc0 sc1 lds
  buffer_load_dwordx4 v73, s[40:43], s30 offen offset:1024 sc0 sc1 lds
  buffer_load_dwordx4 v74, s[40:43], s30 offen offset:2048 sc0 sc1 lds
  buffer_load_dwordx4 v75, s[40:43], s30 offen offset:3072 sc0 sc1 lds
  s_waitcnt vmcnt(16) lgkmcnt(0)
  s_cmp_lg_u32 s22, 0
  s_cbranch_scc1 L_mlp_kernel_w0_19
  s_waitcnt vmcnt(16)
  s_setprio 3
  s_mov_b32 s31, 400000
L_mlp_kernel_spin_20:
  v_cmp_gt_u32 vcc, 2, v33
  s_nop 1
  s_cbranch_vccz L_mlp_kernel_ok_21
  s_sleep 4
  buffer_load_dword v33, v32, s[44:47], 0 offen sc0 sc1
  s_sub_u32 s31, s31, 1
  s_cmp_lg_u32 s31, 0
  s_waitcnt vmcnt(0)
  s_cbranch_scc1 L_mlp_kernel_spin_20
L_mlp_kernel_ok_21:
  s_setprio 0
L_mlp_kernel_w0_19:
  s_barrier
  s_add_u32 m0, s62, 65536
  s_add_u32 s30, s49, 8192
  s_lshl_b32 s31, s30, s60
  s_lshl_b32 s30, s30, 3
  buffer_load_dwordx4 v64, s[36:39], s31 offen offset:0 lds
  buffer_load_dwordx4 v65, s[36:39], s31 offen offset:1024 lds
  s_add_u32 m0, s62, 69632
  s_nop 0
  buffer_load_dwordx4 v66, s[16:19], s30 offen offset:0 lds
  buffer_load_dwordx4 v67, s[16:19], s30 offen offset:1024 lds
  s_add_u32 m0, s28, 81920
  s_add_u32 s30, s49, 8192
  s_lshl_b32 s30, s30, 1
  buffer_load_dwordx4 v72, s[40:43], s30 offen offset:0 sc0 sc1 lds
  buffer_load_dwordx4 v73, s[40:43], s30 offen offset:1024 sc0 sc1 lds
  buffer_load_dwordx4 v74, s[40:43], s30 offen offset:2048 sc0 sc1 lds
  buffer_load_dwordx4 v75, s[40:43], s30 offen offset:3072 sc0 sc1 lds
  s_waitcnt vmcnt(16) lgkmcnt(0)
  s_barrier
  s_add_u32 m0, s62, 98304
  s_add_u32 s30, s50, 8192
  s_lshl_b32 s31, s30, s60
  s_lshl_b32 s30, s30, 3
  buffer_load_dwordx4 v64, s[36:39], s31 offen offset:0 lds
  buffer_load_dwordx4 v65, s[36:39], s31 offen offset:1024 lds
  s_add_u32 m0, s62, 102400
  s_nop 0
  buffer_load_dwordx4 v66, s[16:19], s30 offen offset:0 lds
  buffer_load_dwordx4 v67, s[16:19], s30 offen offset:1024 lds
  s_add_u32 m0, s28, 114688
  s_add_u32 s30, s50, 8192
  s_lshl_b32 s30, s30, 1
  buffer_load_dwordx4 v72, s[40:43], s30 offen offset:0 sc0 sc1 lds
  buffer_load_dwordx4 v73, s[40:43], s30 offen offset:1024 sc0 sc1 lds
  buffer_load_dwordx4 v74, s[40:43], s30 offen offset:2048 sc0 sc1 lds
  buffer_load_dwordx4 v75, s[40:43], s30 offen offset:3072 sc0 sc1 lds
  s_waitcnt vmcnt(16) lgkmcnt(0)
  s_barrier
  s_add_u32 m0, s62, 0
  s_add_u32 s30, s51, 8192
  s_lshl_b32 s31, s30, s60
  s_lshl_b32 s30, s30, 3
  buffer_load_dwordx4 v64, s[36:39], s31 offen offset:0 lds
  buffer_load_dwordx4 v65, s[36:39], s31 offen offset:1024 lds
  s_add_u32 m0, s62, 4096
  s_nop 0
  buffer_load_dwordx4 v66, s[16:19], s30 offen offset:0 lds
  buffer_load_dwordx4 v67, s[16:19], s30 offen offset:1024 lds
  s_add_u32 m0, s28, 16384
  s_add_u32 s30, s51, 8192
  s_lshl_b32 s30, s30, 1
  buffer_load_dwordx4 v72, s[40:43], s30 offen offset:0 sc0 sc1 lds
  buffer_load_dwordx4 v73, s[40:43], s30 offen offset:1024 sc0 sc1 lds
  buffer_load_dwordx4 v74, s[40:43], s30 offen offset:2048 sc0 sc1 lds
  buffer_load_dwordx4 v75, s[40:43], s30 offen offset:3072 sc0 sc1 lds
  s_waitcnt vmcnt(16) lgkmcnt(0)
  s_barrier
  s_add_u32 m0, s62, 32768
  s_add_u32 s30, s52, 8192
  s_lshl_b32 s31, s30, s60
  s_lshl_b32 s30, s30, 3
  buffer_load_dwordx4 v64, s[36:39], s31 offen offset:0 lds
  buffer_load_dwordx4 v65, s[36:39], s31 offen offset:1024 lds
  s_add_u32 m0, s62, 36864
  s_nop 0
  buffer_load_dwordx4 v66, s[16:19], s30 offen offset:0 lds
  buffer_load_dwordx4 v67, s[16:19], s30 offen offset:1024 lds
  s_add_u32 m0, s28, 49152
  s_add_u32 s30, s52, 8192
  s_lshl_b32 s30, s30, 1
  buffer_load_dwordx4 v72, s[40:43], s30 offen offset:0 sc0 sc1 lds
  buffer_load_dwordx4 v73, s[40:43], s30 offen offset:1024 sc0 sc1 lds
  buffer_load_dwordx4 v74, s[40:43], s30 offen offset:2048 sc0 sc1 lds
  buffer_load_dwordx4 v75, s[40:43], s30 offen offset:3072 sc0 sc1 lds
  s_waitcnt vmcnt(16) lgkmcnt(0)
  s_barrier
  s_add_u32 m0, s62, 65536
  s_add_u32 s30, s53, 8192
  s_lshl_b32 s31, s30, s60
  s_lshl_b32 s30, s30, 3
  buffer_load_dwordx4 v64, s[36:39], s31 offen offset:0 lds
  buffer_load_dwordx4 v65, s[36:39], s31 offen offset:1024 lds
  s_add_u32 m0, s62, 69632
  s_nop 0
  buffer_load_dwordx4 v66, s[16:19], s30 offen offset:0 lds
  buffer_load_dwordx4 v67, s[16:19], s30 offen offset:1024 lds
  s_add_u32 m0, s28, 81920
  s_add_u32 s30, s53, 8192
  s_lshl_b32 s30, s30, 1
  buffer_load_dwordx4 v72, s[40:43], s30 offen offset:0 sc0 sc1 lds
  buffer_load_dwordx4 v73, s[40:43], s30 offen offset:1024 sc0 sc1 lds
  buffer_load_dwordx4 v74, s[40:43], s30 offen offset:2048 sc0 sc1 lds
  buffer_load_dwordx4 v75, s[40:43], s30 offen offset:3072 sc0 sc1 lds
  s_waitcnt vmcnt(16) lgkmcnt(0)
  s_barrier
  s_cmp_lg_u32 s22, 0
  s_cbranch_scc1 L_mlp_kernel_w0_22
  buffer_load_dword v33, v32, s[44:47], 0 offen sc0 sc1
L_mlp_kernel_w0_22:
  s_add_u32 m0, s62, 98304
  s_add_u32 s30, s54, 8192
  s_lshl_b32 s31, s30, s60
  s_lshl_b32 s30, s30, 3
  buffer_load_dwordx4 v64, s[36:39], s31 offen offset:0 lds
  buffer_load_dwordx4 v65, s[36:39], s31 offen offset:1024 lds
  s_add_u32 m0, s62, 102400
  s_nop 0
  buffer_load_dwordx4 v66, s[16:19], s30 offen offset:0 lds
  buffer_load_dwordx4 v67, s[16:19], s30 offen offset:1024 lds
  s_add_u32 m0, s28, 114688
  s_add_u32 s30, s54, 8192
  s_lshl_b32 s30, s30, 1
  buffer_load_dwordx4 v72, s[40:43], s30 offen offset:0 sc0 sc1 lds
  buffer_load_dwordx4 v73, s[40:43], s30 offen offset:1024 sc0 sc1 lds
  buffer_load_dwordx4 v74, s[40:43], s30 offen offset:2048 sc0 sc1 lds
  buffer_load_dwordx4 v75, s[40:43], s30 offen offset:3072 sc0 sc1 lds
  s_waitcnt vmcnt(16) lgkmcnt(0)
  s_barrier
  s_add_u32 m0, s62, 0
  s_add_u32 s30, s55, 8192
  s_lshl_b32 s31, s30, s60
  s_lshl_b32 s30, s30, 3
  buffer_load_dwordx4 v64, s[36:39], s31 offen offset:0 lds
  buffer_load_dwordx4 v65, s[36:39], s31 offen offset:1024 lds
  s_add_u32 m0, s62, 4096
  s_nop 0
  buffer_load_dwordx4 v66, s[16:19], s30 offen offset:0 lds
  buffer_load_dwordx4 v67, s[16:19], s30 offen offset:1024 lds
  s_add_u32 m0, s28, 16384
  s_add_u32 s30, s55, 8192
  s_lshl_b32 s30, s30, 1
  buffer_load_dwordx4 v72, s[40:43], s30 offen offset:0 sc0 sc1 lds
  buffer_load_dwordx4 v73, s[40:43], s30 offen offset:1024 sc0 sc1 lds
  buffer_load_dwordx4 v74, s[40:43], s30 offen offset:2048 sc0 sc1 lds
  buffer_load_dwordx4 v75, s[40:43], s30 offen offset:3072 sc0 sc1 lds
  s_waitcnt vmcnt(16) lgkmcnt(0)
  s_cmp_lg_u32 s22, 0
  s_cbranch_scc1 L_mlp_kernel_w0_23
  s_waitcnt vmcnt(16)
  s_setprio 3
  s_mov_b32 s31, 400000
L_mlp_kernel_spin_24:
  v_cmp_gt_u32 vcc, 3, v33
  s_nop 1
  s_cbranch_vccz L_mlp_kernel_ok_25
  s_sleep 4
  buffer_load_dword v33, v32, s[44:47], 0 offen sc0 sc1
  s_sub_u32 s31, s31, 1
  s_cmp_lg_u32 s31, 0
  s_waitcnt vmcnt(0)
  s_cbranch_scc1 L_mlp_kernel_spin_24
L_mlp_kernel_ok_25:
  s_setprio 0
L_mlp_kernel_w0_23:
  s_barrier
  s_add_u32 m0, s62, 32768
  s_add_u32 s30, s49, 16384
  s_lshl_b32 s31, s30, s60
  s_lshl_b32 s30, s30, 3
  buffer_load_dwordx4 v64, s[36:39], s31 offen offset:0 lds
  buffer_load_dwordx4 v65, s[36:39], s31 offen offset:1024 lds
  s_add_u32 m0, s62, 36864
  s_nop 0
  buffer_load_dwordx4 v66, s[16:19], s30 offen offset:0 lds
  buffer_load_dwordx4 v67, s[16:19], s30 offen offset:1024 lds
  s_add_u32 m0, s28, 49152
  s_add_u32 s30, s49, 16384
  s_lshl_b32 s30, s30, 1
  buffer_load_dwordx4 v72, s[40:43], s30 offen offset:0 sc0 sc1 lds
  buffer_load_dwordx4 v73, s[40:43], s30 offen offset:1024 sc0 sc1 lds
  buffer_load_dwordx4 v74, s[40:43], s30 offen offset:2048 sc0 sc1 lds
  buffer_load_dwordx4 v75, s[40:43], s30 offen offset:3072 sc0 sc1 lds
  s_waitcnt vmcnt(16) lgkmcnt(0)
  s_barrier
  s_add_u32 m0, s62, 65536
  s_add_u32 s30, s50, 16384
  s_lshl_b32 s31, s30, s60
  s_lshl_b32 s30, s30, 3
  buffer_load_dwordx4 v64, s[36:39], s31 offen offset:0 lds
  buffer_load_dwordx4 v65, s[36:39], s31 offen offset:1024 lds
  s_add_u32 m0, s62, 69632
  s_nop 0
  buffer_load_dwordx4 v66, s[16:19], s30 offen offset:0 lds
  buffer_load_dwordx4 v67, s[16:19], s30 offen offset:1024 lds
  s_add_u32 m0, s28, 81920
  s_add_u32 s30, s50, 16384
  s_lshl_b32 s30, s30, 1
  buffer_load_dwordx4 v72, s[40:43], s30 offen offset:0 sc0 sc1 lds
  buffer_load_dwordx4 v73, s[40:43], s30 offen offset:1024 sc0 sc1 lds
  buffer_load_dwordx4 v74, s[40:43], s30 offen offset:2048 sc0 sc1 lds
  buffer_load_dwordx4 v75, s[40:43], s30 offen offset:3072 sc0 sc1 lds
  s_waitcnt vmcnt(16) lgkmcnt(0)
  s_barrier
  s_add_u32 m0, s62, 98304
  s_add_u32 s30, s51, 16384
  s_lshl_b32 s31, s30, s60
  s_lshl_b32 s30, s30, 3
  buffer_load_dwordx4 v64, s[36:39], s31 offen offset:0 lds
  buffer_load_dwordx4 v65, s[36:39], s31 offen offset:1024 lds
  s_add_u32 m0, s62, 102400
  s_nop 0
  buffer_load_dwordx4 v66, s[16:19], s30 offen offset:0 lds
  buffer_load_dwordx4 v67, s[16:19], s30 offen offset:1024 lds
  s_add_u32 m0, s28, 114688
  s_add_u32 s30, s51, 16384
  s_lshl_b32 s30, s30, 1
  buffer_load_dwordx4 v72, s[40:43], s30 offen offset:0 sc0 sc1 lds
  buffer_load_dwordx4 v73, s[40:43], s30 offen offset:1024 sc0 sc1 lds
  buffer_load_dwordx4 v74, s[40:43], s30 offen offset:2048 sc0 sc1 lds
  buffer_load_dwordx4 v75, s[40:43], s30 offen offset:3072 sc0 sc1 lds
  s_waitcnt vmcnt(16) lgkmcnt(0)
  s_barrier
  s_add_u32 m0, s62, 0
  s_add_u32 s30, s52, 16384
  s_lshl_b32 s31, s30, s60
  s_lshl_b32 s30, s30, 3
  buffer_load_dwordx4 v64, s[36:39], s31 offen offset:0 lds
  buffer_load_dwordx4 v65, s[36:39], s31 offen offset:1024 lds
  s_add_u32 m0, s62, 4096
  s_nop 0
  buffer_load_dwordx4 v66, s[16:19], s30 offen offset:0 lds
  buffer_load_dwordx4 v67, s[16:19], s30 offen offset:1024 lds
  s_add_u32 m0, s28, 16384
  s_add_u32 s30, s52, 16384
  s_lshl_b32 s30, s30, 1
  buffer_load_dwordx4 v72, s[40:43], s30 offen offset:0 sc0 sc1 lds
  buffer_load_dwordx4 v73, s[40:43], s30 offen offset:1024 sc0 sc1 lds
  buffer_load_dwordx4 v74, s[40:43], s30 offen offset:2048 sc0 sc1 lds
  buffer_load_dwordx4 v75, s[40:43], s30 offen offset:3072 sc0 sc1 lds
  s_cmp_eq_u32 s63, 0
  s_cbranch_scc1 L_mlp_kernel_rf_26
  global_load_dword v39, v38, s[64:65]
L_mlp_kernel_rf_26:
  s_waitcnt vmcnt(16) lgkmcnt(0)
  s_barrier
  s_add_u32 m0, s62, 32768
  s_add_u32 s30, s53, 16384
  s_lshl_b32 s31, s30, s60
  s_lshl_b32 s30, s30, 3
  buffer_load_dwordx4 v64, s[36:39], s31 offen offset:0 lds
  buffer_load_dwordx4 v65, s[36:39], s31 offen offset:1024 lds
  s_add_u32 m0, s62, 36864
  s_nop 0
  buffer_load_dwordx4 v66, s[16:19], s30 offen offset:0 lds
  buffer_load_dwordx4 v67, s[16:19], s30 offen offset:1024 lds
  s_add_u32 m0, s28, 49152
  s_add_u32 s30, s53, 16384
  s_lshl_b32 s30, s30, 1
  buffer_load_dwordx4 v72, s[40:43], s30 offen offset:0 sc0 sc1 lds
  buffer_load_dwordx4 v73, s[40:43], s30 offen offset:1024 sc0 sc1 lds
  buffer_load_dwordx4 v74, s[40:43], s30 offen offset:2048 sc0 sc1 lds
  buffer_load_dwordx4 v75, s[40:43], s30 offen offset:3072 sc0 sc1 lds
  s_waitcnt vmcnt(16) lgkmcnt(0)
  s_barrier
  s_add_u32 m0, s62, 65536
  s_add_u32 s30, s54, 16384
  s_lshl_b32 s31, s30, s60
  s_lshl_b32 s30, s30, 3
  buffer_load_dwordx4 v64, s[36:39], s31 offen offset:0 lds
  buffer_load_dwordx4 v65, s[36:39], s31 offen offset:1024 lds
  s_add_u32 m0, s62, 69632
  s_nop 0
  buffer_load_dwordx4 v66, s[16:19], s30 offen offset:0 lds
  buffer_load_dwordx4 v67, s[16:19], s30 offen offset:1024 lds
  s_add_u32 m0, s28, 81920
  s_add_u32 s30, s54, 16384
  s_lshl_b32 s30, s30, 1
  buffer_load_dwordx4 v72, s[40:43], s30 offen offset:0 sc0 sc1 lds
  buffer_load_dwordx4 v73, s[40:43], s30 offen offset:1024 sc0 sc1 lds
  buffer_load_dwordx4 v74, s[40:43], s30 offen offset:2048 sc0 sc1 lds
  buffer_load_dwordx4 v75, s[40:43], s30 offen offset:3072 sc0 sc1 lds
  s_waitcnt vmcnt(16) lgkmcnt(0)
  s_barrier
  s_add_u32 m0, s62, 98304
  s_add_u32 s30, s55, 16384
  s_lshl_b32 s31, s30, s60
  s_lshl_b32 s30, s30, 3
  buffer_load_dwordx4 v64, s[36:39], s31 offen offset:0 lds
  buffer_load_dwordx4 v65, s[36:39], s31 offen offset:1024 lds
  s_add_u32 m0, s62, 102400
  s_nop 0
  buffer_load_dwordx4 v66, s[16:19], s30 offen offset:0 lds
  buffer_load_dwordx4 v67, s[16:19], s30 offen offset:1024 lds
  s_add_u32 m0, s28, 114688
  s_add_u32 s30, s55, 16384
  s_lshl_b32 s30, s30, 1
  buffer_load_dwordx4 v72, s[40:43], s30 offen offset:0 sc0 sc1 lds
  buffer_load_dwordx4 v73, s[40:43], s30 offen offset:1024 sc0 sc1 lds
  buffer_load_dwordx4 v74, s[40:43], s30 offen offset:2048 sc0 sc1 lds
  buffer_load_dwordx4 v75, s[40:43], s30 offen offset:3072 sc0 sc1 lds
  s_waitcnt vmcnt(16) lgkmcnt(0)
  s_barrier
  s_add_u32 m0, s62, 0
  s_mov_b32 s30, 24576
  s_lshl_b32 s31, s30, s60
  s_lshl_b32 s30, s30, 3
  buffer_load_dwordx4 v68, s[36:39], s31 offen offset:0 lds
  buffer_load_dwordx4 v69, s[36:39], s31 offen offset:1024 lds
  s_add_u32 m0, s62, 4096
  s_nop 0
  buffer_load_dwordx4 v70, s[16:19], s30 offen offset:0 lds
  buffer_load_dwordx4 v71, s[16:19], s30 offen offset:1024 lds
  s_add_u32 m0, s28, 16384
  s_mov_b32 s30, 24576
  s_lshl_b32 s30, s30, 1
  buffer_load_dwordx4 v76, s[40:43], s30 offen offset:0 sc0 sc1 lds
  buffer_load_dwordx4 v77, s[40:43], s30 offen offset:1024 sc0 sc1 lds
  buffer_load_dwordx4 v78, s[40:43], s30 offen offset:2048 sc0 sc1 lds
  buffer_load_dwordx4 v79, s[40:43], s30 offen offset:3072 sc0 sc1 lds
  s_waitcnt vmcnt(16) lgkmcnt(0)
  s_barrier
  s_add_u32 m0, s62, 32768
  s_mov_b32 s30, 139264
  s_lshl_b32 s31, s30, s60
  s_lshl_b32 s30, s30, 3
  buffer_load_dwordx4 v68, s[36:39], s31 offen offset:0 lds
  buffer_load_dwordx4 v69, s[36:39], s31 offen offset:1024 lds
  s_add_u32 m0, s62, 36864
  s_nop 0
  buffer_load_dwordx4 v70, s[16:19], s30 offen offset:0 lds
  buffer_load_dwordx4 v71, s[16:19], s30 offen offset:1024 lds
  s_add_u32 m0, s28, 49152
  s_mov_b32 s30, 139264
  s_lshl_b32 s30, s30, 1
  buffer_load_dwordx4 v76, s[40:43], s30 offen offset:0 sc0 sc1 lds
  buffer_load_dwordx4 v77, s[40:43], s30 offen offset:1024 sc0 sc1 lds
  buffer_load_dwordx4 v78, s[40:43], s30 offen offset:2048 sc0 sc1 lds
  buffer_load_dwordx4 v79, s[40:43], s30 offen offset:3072 sc0 sc1 lds
  s_waitcnt vmcnt(16) lgkmcnt(0)
  s_barrier
  s_add_u32 m0, s62, 65536
  s_mov_b32 s30, 253952
  s_lshl_b32 s31, s30, s60
  s_lshl_b32 s30, s30, 3
  buffer_load_dwordx4 v68, s[36:39], s31 offen offset:0 lds
  buffer_load_dwordx4 v69, s[36:39], s31 offen offset:1024 lds
  s_add_u32 m0, s62, 69632
  s_nop 0
  buffer_load_dwordx4 v70, s[16:19], s30 offen offset:0 lds
  buffer_load_dwordx4 v71, s[16:19], s30 offen offset:1024 lds
  s_add_u32 m0, s28, 81920
  s_mov_b32 s30, 253952
  s_lshl_b32 s30, s30, 1
  buffer_load_dwordx4 v76, s[40:43], s30 offen offset:0 sc0 sc1 lds
  buffer_load_dwordx4 v77, s[40:43], s30 offen offset:1024 sc0 sc1 lds
  buffer_load_dwordx4 v78, s[40:43], s30 offen offset:2048 sc0 sc1 lds
  buffer_load_dwordx4 v79, s[40:43], s30 offen offset:3072 sc0 sc1 lds
  s_waitcnt vmcnt(16) lgkmcnt(0)
  s_barrier
  s_add_u32 m0, s62, 98304
  s_mov_b32 s30, 368640
  s_lshl_b32 s31, s30, s60
  s_lshl_b32 s30, s30, 3
  buffer_load_dwordx4 v68, s[36:39], s31 offen offset:0 lds
  buffer_load_dwordx4 v69, s[36:39], s31 offen offset:1024 lds
  s_add_u32 m0, s62, 102400
  s_nop 0
  buffer_load_dwordx4 v70, s[16:19], s30 offen offset:0 lds
  buffer_load_dwordx4 v71, s[16:19], s30 offen offset:1024 lds
  s_add_u32 m0, s28, 114688
  s_mov_b32 s30, 368640
  s_lshl_b32 s30, s30, 1
  buffer_load_dwordx4 v76, s[40:43], s30 offen offset:0 sc0 sc1 lds
  buffer_load_dwordx4 v77, s[40:43], s30 offen offset:1024 sc0 sc1 lds
  buffer_load_dwordx4 v78, s[40:43], s30 offen offset:2048 sc0 sc1 lds
  buffer_load_dwordx4 v79, s[40:43], s30 offen offset:3072 sc0 sc1 lds
  s_waitcnt vmcnt(16) lgkmcnt(0)
  s_barrier
  s_waitcnt vmcnt(8) lgkmcnt(0)
  s_barrier
  s_waitcnt vmcnt(0) lgkmcnt(0)
  s_barrier
  s_cmp_lg_u32 s3, 0
  s_cbranch_scc1 L_mlp_inv
  s_lshl4_add_u32 s26, s20, s21
  s_getpc_b64 s[48:49]
L_mlp_kernel_pc_27:
  s_add_u32 s48, s48, tab_f2-L_mlp_kernel_pc_27
  s_addc_u32 s49, s49, 0
  s_lshl_b32 s50, s22, 12
  v_and_b32 v5, 63, v0
  v_lshl_add_u32 v5, v5, 4, s50
  s_add_u32 m0, s50, 49152
  s_nop 0
  global_load_lds_dwordx4 v5, s[48:49] offset:0
  global_load_lds_dwordx4 v5, s[48:49] offset:1024
  global_load_lds_dwordx4 v5, s[48:49] offset:2048
  global_load_lds_dwordx4 v5, s[48:49] offset:3072
  s_lshl_b32 s27, s20, 11
  s_lshl2_add_u32 s27, s21, s27
  s_add_u32 s27, s27, 32
  s_lshl_b32 s21, s26, 6
  s_lshl_b32 s20, s26, 3
  s_lshl1_add_u32 s20, s22, s20
  s_lshl_b32 s24, s22, 13
  s_lshl_b32 s23, s22, 10
  s_add_u32 s16, s4, 0x400000
  s_addc_u32 s17, s5, 0
  s_mov_b32 s18, 0x4000
  s_mov_b32 s19, 0x20000
  s_add_u32 s8, s4, 0x3800000
  s_addc_u32 s9, s5, 0
  s_mov_b32 s10, 0x800000
  s_mov_b32 s11, 0x20000
  s_lshl_b32 s23, s20, 2
  v_mov_b32 v177, s23
  s_movk_i32 s30, 0x2000
  buffer_load_dwordx2 v[178:179], v177, s[16:19], s30 offen
  v_lshrrev_b32 v3, 2, v1
  v_xor_b32 v3, v3, v1
  v_and_b32 v3, 4, v3
  v_lshrrev_b32 v2, 3, v1
  v_lshlrev_b32 v2, 17, v2
  v_and_or_b32 v3, v1, 3, v3
  v_lshl_add_u32 v2, v3, 4, v2
  s_lshl_b32 s23, s20, 6
  v_add_u32 v246, s23, v2
  v_and_b32 v2, 15, v1
  v_lshl_add_u32 v247, v2, 7, s27
  s_lshl_b32 s23, s26, 7
  s_add_u32 s23, s23, 32
  v_lshl_add_u32 v248, v2, 2, s23
  v_mov_b32 v249, 1
  v_lshlrev_b32 v5, 4, v1
  v_lshrrev_b32 v2, 5, v1
  v_lshlrev_b32 v176, 10, v2
  v_bfe_u32 v2, v1, 2, 2
  v_lshl_add_u32 v176, v2, 7, v176
  v_bfe_u32 v2, v1, 3, 1
  v_lshl_add_u32 v176, v2, 6, v176
  v_bfe_u32 v2, v1, 4, 1
  v_lshl_add_u32 v176, v2, 3, v176
  v_and_b32 v2, 3, v1
  v_lshl_add_u32 v176, v2, 4, v176
  v_add_u32 v176, s24, v176
  v_xor_b32 v172, 64, v176
  v_lshlrev_b32 v173, 4, v0
  v_add_u32 v173, 141312, v173
  s_mov_b64 s[32:33], 1
  s_waitcnt vmcnt(0)
  s_add_u32 s52, s4, 0x500000
  s_addc_u32 s53, s5, 0
  s_mov_b32 s54, 0x400000
  s_mov_b32 s55, 0x20000
  s_lshl_b32 s42, s2, 14
  s_sub_u32 s23, s22, 1
  s_mul_i32 s23, s23, 43
  v_add_u32 v174, s23, v1
  v_min_u32 v175, 42, v1
  v_add_u32 v174, s23, v175
  v_min_u32 v174, 127, v174
  v_lshlrev_b32 v174, 7, v174
  s_barrier
  ds_read_b128 v[180:183], v252 offset:0
  ds_read_b128 v[184:187], v253 offset:0
  ds_read_b128 v[188:191], v252 offset:8192
  ds_read_b128 v[192:195], v253 offset:8192
  ds_read_b128 v[12:15], v5 offset:49152
  ds_read_b128 v[16:19], v5 offset:50176
  ds_read_b128 v[20:23], v5 offset:51200
  ds_read_b128 v[24:27], v5 offset:52224
  ds_read_b128 v[28:31], v5 offset:53248
  ds_read_b128 v[32:35], v5 offset:54272
  ds_read_b128 v[36:39], v5 offset:55296
  ds_read_b128 v[40:43], v5 offset:56320
  ds_read_b128 v[44:47], v5 offset:57344
  ds_read_b128 v[48:51], v5 offset:58368
  ds_read_b128 v[52:55], v5 offset:59392
  s_waitcnt lgkmcnt(11)
  ds_read_b128 v[56:59], v5 offset:60416
  ds_read_b128 v[60:63], v5 offset:61440
  ds_read_b128 v[64:67], v5 offset:62464
  ds_read_b128 v[68:71], v5 offset:63488
  ds_read_b128 v[72:75], v5 offset:64512
  v_lshlrev_b32 v196, 16, v180
  v_and_b32 v197, 0xffff0000, v180
  v_lshlrev_b32 v198, 16, v181
  v_and_b32 v199, 0xffff0000, v181
  v_lshlrev_b32 v200, 16, v184
  v_and_b32 v201, 0xffff0000, v184
  v_lshlrev_b32 v202, 16, v185
  v_and_b32 v203, 0xffff0000, v185
  v_lshlrev_b32 v204, 16, v188
  v_and_b32 v205, 0xffff0000, v188
  v_lshlrev_b32 v206, 16, v189
  v_and_b32 v207, 0xffff0000, v189
  v_lshlrev_b32 v208, 16, v192
  v_and_b32 v209, 0xffff0000, v192
  v_lshlrev_b32 v210, 16, v193
  v_and_b32 v211, 0xffff0000, v193
  v_readlane_b32 s40, v196, 0
  v_lshlrev_b32 v212, 16, v182
  v_and_b32 v213, 0xffff0000, v182
  v_lshlrev_b32 v214, 16, v183
  v_and_b32 v215, 0xffff0000, v183
  v_lshlrev_b32 v216, 16, v186
  v_and_b32 v217, 0xffff0000, v186
  v_lshlrev_b32 v218, 16, v187
  v_and_b32 v219, 0xffff0000, v187
  v_lshlrev_b32 v220, 16, v190
  v_and_b32 v221, 0xffff0000, v190
  v_lshlrev_b32 v222, 16, v191
  v_and_b32 v223, 0xffff0000, v191
  v_lshlrev_b32 v224, 16, v194
  v_and_b32 v225, 0xffff0000, v194
  v_lshlrev_b32 v226, 16, v195
  v_and_b32 v227, 0xffff0000, v195
  v_readlane_b32 s41, v212, 0
  s_waitcnt lgkmcnt(0)
  s_barrier
  s_cmp_eq_u32 s22, 0
  s_cbranch_scc1 L_mlp_kernel_w1_31
  buffer_load_dword v175, v174, s[52:55], s42 offen
  s_branch L_mlp_kernel_w0_28
L_mlp_kernel_w1_31:
  s_mov_b64 exec, 0xffff
  buffer_store_dword v249, v247, s[44:47], 0 offen sc0 sc1
  s_mov_b64 exec, -1
  s_mov_b32 s31, 400000
L_mlp_kernel_spin_29:
  buffer_load_dword v250, v248, s[44:47], 0 offen sc0 sc1
  s_waitcnt vmcnt(0)
  v_cmp_eq_u32 vcc, 0, v250
  s_nop 1
  s_cbranch_vccz L_mlp_kernel_w0_28
  s_sleep 1
  s_sub_u32 s31, s31, 1
  s_cmp_lg_u32 s31, 0
  s_cbranch_scc1 L_mlp_kernel_spin_29
L_mlp_kernel_w0_28:
  s_barrier
  s_add_u32 m0, s24, 0
  s_mov_b32 s25, 0
  buffer_load_dwordx4 v246, s[8:11], s25 offen sc0 sc1 lds
  s_add_u32 m0, s24, 1024
  s_mov_b32 s25, 1048576
  buffer_load_dwordx4 v246, s[8:11], s25 offen sc0 sc1 lds
  s_add_u32 m0, s24, 4096
  s_mov_b32 s25, 4194304
  buffer_load_dwordx4 v246, s[8:11], s25 offen sc0 sc1 lds
  s_add_u32 m0, s24, 5120
  s_mov_b32 s25, 5242880
  buffer_load_dwordx4 v246, s[8:11], s25 offen sc0 sc1 lds
  s_add_u32 m0, s24, 2048
  s_mov_b32 s25, 2097152
  buffer_load_dwordx4 v246, s[8:11], s25 offen sc0 sc1 lds
  s_add_u32 m0, s24, 3072
  s_mov_b32 s25, 3145728
  buffer_load_dwordx4 v246, s[8:11], s25 offen sc0 sc1 lds
  s_add_u32 m0, s24, 6144
  s_mov_b32 s25, 6291456
  buffer_load_dwordx4 v246, s[8:11], s25 offen sc0 sc1 lds
  s_add_u32 m0, s24, 7168
  s_mov_b32 s25, 7340032
  buffer_load_dwordx4 v246, s[8:11], s25 offen sc0 sc1 lds
  s_waitcnt vmcnt(4)
  ds_read_b64_tr_b16 v[76:77], v176 offset:0
  ds_read_b64_tr_b16 v[78:79], v176 offset:512
  ds_read_b64_tr_b16 v[92:93], v176 offset:4096
  ds_read_b64_tr_b16 v[94:95], v176 offset:4608
  ds_read_b64_tr_b16 v[84:85], v172 offset:0
  ds_read_b64_tr_b16 v[86:87], v172 offset:512
  ds_read_b64_tr_b16 v[100:101], v172 offset:4096
  ds_read_b64_tr_b16 v[102:103], v172 offset:4608
  s_waitcnt lgkmcnt(6)
  v_mfma_f32_32x32x16_bf16 v[108:123], v[76:79], v[12:15], 0
  v_mfma_f32_32x32x16_bf16 v[124:139], v[76:79], v[20:23], 0
  s_waitcnt lgkmcnt(4)
  v_mfma_f32_32x32x16_bf16 v[108:123], v[92:95], v[12:15], v[108:123]
  v_mfma_f32_32x32x16_bf16 v[124:139], v[92:95], v[20:23], v[124:139]
  s_waitcnt lgkmcnt(2)
  v_mfma_f32_32x32x16_bf16 v[140:155], v[84:87], v[12:15], 0
  v_mfma_f32_32x32x16_bf16 v[156:171], v[84:87], v[20:23], 0
  s_waitcnt lgkmcnt(0)
  v_mfma_f32_32x32x16_bf16 v[140:155], v[100:103], v[12:15], v[140:155]
  v_mfma_f32_32x32x16_bf16 v[156:171], v[100:103], v[20:23], v[156:171]
  s_waitcnt vmcnt(0)
  ds_read_b64_tr_b16 v[80:81], v176 offset:2048
  ds_read_b64_tr_b16 v[82:83], v176 offset:2560
  ds_read_b64_tr_b16 v[96:97], v176 offset:6144
  ds_read_b64_tr_b16 v[98:99], v176 offset:6656
  ds_read_b64_tr_b16 v[88:89], v172 offset:2048
  ds_read_b64_tr_b16 v[90:91], v172 offset:2560
  ds_read_b64_tr_b16 v[104:105], v172 offset:6144
  ds_read_b64_tr_b16 v[106:107], v172 offset:6656
  s_waitcnt lgkmcnt(6)
  v_mfma_f32_32x32x16_bf16 v[108:123], v[80:83], v[16:19], v[108:123]
  v_mfma_f32_32x32x16_bf16 v[124:139], v[80:83], v[24:27], v[124:139]
  s_waitcnt lgkmcnt(4)
  v_mfma_f32_32x32x16_bf16 v[108:123], v[96:99], v[16:19], v[108:123]
  v_mfma_f32_32x32x16_bf16 v[124:139], v[96:99], v[24:27], v[124:139]
  s_waitcnt lgkmcnt(2)
  v_mfma_f32_32x32x16_bf16 v[140:155], v[88:91], v[16:19], v[140:155]
  v_mfma_f32_32x32x16_bf16 v[156:171], v[88:91], v[24:27], v[156:171]
  s_waitcnt lgkmcnt(0)
  v_mfma_f32_32x32x16_bf16 v[140:155], v[104:107], v[16:19], v[140:155]
  v_mfma_f32_32x32x16_bf16 v[156:171], v[104:107], v[24:27], v[156:171]
  s_nop 4
  v_pk_mul_f32 v[2:3], v[108:109], v[28:29]
  v_pk_mul_f32 v[4:5], v[124:125], v[28:29]
  v_pk_mul_f32 v[6:7], v[110:111], v[30:31]
  v_pk_mul_f32 v[8:9], v[126:127], v[30:31]
  v_pk_fma_f32 v[2:3], v[124:125], v[44:45], v[2:3]
  v_pk_fma_f32 v[4:5], v[108:109], v[44:45], v[4:5] neg_lo:[1,0,0] neg_hi:[1,0,0]
  v_pk_fma_f32 v[6:7], v[126:127], v[46:47], v[6:7]
  v_pk_fma_f32 v[8:9], v[110:111], v[46:47], v[8:9] neg_lo:[1,0,0] neg_hi:[1,0,0]
  v_cvt_pk_bf16_f32 v76, v2, v4
  v_cvt_pk_bf16_f32 v77, v3, v5
  v_cvt_pk_bf16_f32 v78, v6, v8
  v_cvt_pk_bf16_f32 v79, v7, v9
  v_pk_mul_f32 v[2:3], v[112:113], v[32:33]
  v_pk_mul_f32 v[4:5], v[128:129], v[32:33]
  v_pk_mul_f32 v[6:7], v[114:115], v[34:35]
  v_pk_mul_f32 v[8:9], v[130:131], v[34:35]
  v_pk_fma_f32 v[2:3], v[128:129], v[48:49], v[2:3]
  v_pk_fma_f32 v[4:5], v[112:113], v[48:49], v[4:5] neg_lo:[1,0,0] neg_hi:[1,0,0]
  v_pk_fma_f32 v[6:7], v[130:131], v[50:51], v[6:7]
  v_pk_fma_f32 v[8:9], v[114:115], v[50:51], v[8:9] neg_lo:[1,0,0] neg_hi:[1,0,0]
  v_cvt_pk_bf16_f32 v80, v2, v4
  v_cvt_pk_bf16_f32 v81, v3, v5
  v_cvt_pk_bf16_f32 v82, v6, v8
  v_cvt_pk_bf16_f32 v83, v7, v9
  v_pk_mul_f32 v[2:3], v[116:117], v[36:37]
  v_pk_mul_f32 v[4:5], v[132:133], v[36:37]
  v_pk_mul_f32 v[6:7], v[118:119], v[38:39]
  v_pk_mul_f32 v[8:9], v[134:135], v[38:39]
  v_pk_fma_f32 v[2:3], v[132:133], v[52:53], v[2:3]
  v_pk_fma_f32 v[4:5], v[116:117], v[52:53], v[4:5] neg_lo:[1,0,0] neg_hi:[1,0,0]
  v_pk_fma_f32 v[6:7], v[134:135], v[54:55], v[6:7]
  v_pk_fma_f32 v[8:9], v[118:119], v[54:55], v[8:9] neg_lo:[1,0,0] neg_hi:[1,0,0]
  v_cvt_pk_bf16_f32 v84, v2, v4
  v_cvt_pk_bf16_f32 v85, v3, v5
  v_cvt_pk_bf16_f32 v86, v6, v8
  v_cvt_pk_bf16_f32 v87, v7, v9
  v_pk_mul_f32 v[2:3], v[120:121], v[40:41]
  v_pk_mul_f32 v[4:5], v[136:137], v[40:41]
  v_pk_mul_f32 v[6:7], v[122:123], v[42:43]
  v_pk_mul_f32 v[8:9], v[138:139], v[42:43]
  v_pk_fma_f32 v[2:3], v[136:137], v[56:57], v[2:3]
  v_pk_fma_f32 v[4:5], v[120:121], v[56:57], v[4:5] neg_lo:[1,0,0] neg_hi:[1,0,0]
  v_pk_fma_f32 v[6:7], v[138:139], v[58:59], v[6:7]
  v_pk_fma_f32 v[8:9], v[122:123], v[58:59], v[8:9] neg_lo:[1,0,0] neg_hi:[1,0,0]
  v_cvt_pk_bf16_f32 v88, v2, v4
  v_cvt_pk_bf16_f32 v89, v3, v5
  v_cvt_pk_bf16_f32 v90, v6, v8
  v_cvt_pk_bf16_f32 v91, v7, v9
  v_mfma_f32_32x32x16_bf16 v[196:211], v[60:63], v[76:79], v[196:211]
  v_mfma_f32_32x32x16_bf16 v[196:211], v[64:67], v[80:83], v[196:211]
  v_mfma_f32_32x32x16_bf16 v[196:211], v[68:71], v[84:87], v[196:211]
  v_mfma_f32_32x32x16_bf16 v[196:211], v[72:75], v[88:91], v[196:211]
  v_pk_mul_f32 v[2:3], v[140:141], v[28:29]
  v_pk_mul_f32 v[4:5], v[156:157], v[28:29]
  v_pk_mul_f32 v[6:7], v[142:143], v[30:31]
  v_pk_mul_f32 v[8:9], v[158:159], v[30:31]
  v_pk_fma_f32 v[2:3], v[156:157], v[44:45], v[2:3]
  v_pk_fma_f32 v[4:5], v[140:141], v[44:45], v[4:5] neg_lo:[1,0,0] neg_hi:[1,0,0]
  v_pk_fma_f32 v[6:7], v[158:159], v[46:47], v[6:7]
  v_pk_fma_f32 v[8:9], v[142:143], v[46:47], v[8:9] neg_lo:[1,0,0] neg_hi:[1,0,0]
  v_cvt_pk_bf16_f32 v92, v2, v4
  v_cvt_pk_bf16_f32 v93, v3, v5
  v_cvt_pk_bf16_f32 v94, v6, v8
  v_cvt_pk_bf16_f32 v95, v7, v9
  v_pk_mul_f32 v[2:3], v[144:145], v[32:33]
  v_pk_mul_f32 v[4:5], v[160:161], v[32:33]
  v_pk_mul_f32 v[6:7], v[146:147], v[34:35]
  v_pk_mul_f32 v[8:9], v[162:163], v[34:35]
  v_pk_fma_f32 v[2:3], v[160:161], v[48:49], v[2:3]
  v_pk_fma_f32 v[4:5], v[144:145], v[48:49], v[4:5] neg_lo:[1,0,0] neg_hi:[1,0,0]
  v_pk_fma_f32 v[6:7], v[162:163], v[50:51], v[6:7]
  v_pk_fma_f32 v[8:9], v[146:147], v[50:51], v[8:9] neg_lo:[1,0,0] neg_hi:[1,0,0]
  v_cvt_pk_bf16_f32 v96, v2, v4
  v_cvt_pk_bf16_f32 v97, v3, v5
  v_cvt_pk_bf16_f32 v98, v6, v8
  v_cvt_pk_bf16_f32 v99, v7, v9
  v_pk_mul_f32 v[2:3], v[148:149], v[36:37]
  v_pk_mul_f32 v[4:5], v[164:165], v[36:37]
  v_pk_mul_f32 v[6:7], v[150:151], v[38:39]
  v_pk_mul_f32 v[8:9], v[166:167], v[38:39]
  v_pk_fma_f32 v[2:3], v[164:165], v[52:53], v[2:3]
  v_pk_fma_f32 v[4:5], v[148:149], v[52:53], v[4:5] neg_lo:[1,0,0] neg_hi:[1,0,0]
  v_pk_fma_f32 v[6:7], v[166:167], v[54:55], v[6:7]
  v_pk_fma_f32 v[8:9], v[150:151], v[54:55], v[8:9] neg_lo:[1,0,0] neg_hi:[1,0,0]
  v_cvt_pk_bf16_f32 v100, v2, v4
  v_cvt_pk_bf16_f32 v101, v3, v5
  v_cvt_pk_bf16_f32 v102, v6, v8
  v_cvt_pk_bf16_f32 v103, v7, v9
  v_pk_mul_f32 v[2:3], v[152:153], v[40:41]
  v_pk_mul_f32 v[4:5], v[168:169], v[40:41]
  v_pk_mul_f32 v[6:7], v[154:155], v[42:43]
  v_pk_mul_f32 v[8:9], v[170:171], v[42:43]
  v_pk_fma_f32 v[2:3], v[168:169], v[56:57], v[2:3]
  v_pk_fma_f32 v[4:5], v[152:153], v[56:57], v[4:5] neg_lo:[1,0,0] neg_hi:[1,0,0]
  v_pk_fma_f32 v[6:7], v[170:171], v[58:59], v[6:7]
  v_pk_fma_f32 v[8:9], v[154:155], v[58:59], v[8:9] neg_lo:[1,0,0] neg_hi:[1,0,0]
  v_cvt_pk_bf16_f32 v104, v2, v4
  v_cvt_pk_bf16_f32 v105, v3, v5
  v_cvt_pk_bf16_f32 v106, v6, v8
  v_cvt_pk_bf16_f32 v107, v7, v9
  v_mfma_f32_32x32x16_bf16 v[212:227], v[60:63], v[92:95], v[212:227]
  v_mfma_f32_32x32x16_bf16 v[212:227], v[64:67], v[96:99], v[212:227]
  v_mfma_f32_32x32x16_bf16 v[212:227], v[68:71], v[100:103], v[212:227]
  v_mfma_f32_32x32x16_bf16 v[212:227], v[72:75], v[104:107], v[212:227]
  v_pk_add_f32 v[2:3], v[108:109], v[110:111]
  v_pk_add_f32 v[2:3], v[2:3], v[112:113]
  v_pk_add_f32 v[2:3], v[2:3], v[114:115]
  v_pk_add_f32 v[2:3], v[2:3], v[116:117]
  v_pk_add_f32 v[2:3], v[2:3], v[118:119]
  v_pk_add_f32 v[2:3], v[2:3], v[120:121]
  v_pk_add_f32 v[2:3], v[2:3], v[122:123]
  v_sub_f32 v2, v2, v3
  v_pk_add_f32 v[4:5], v[140:141], v[142:143]
  v_pk_add_f32 v[4:5], v[4:5], v[144:145]
  v_pk_add_f32 v[4:5], v[4:5], v[146:147]
  v_pk_add_f32 v[4:5], v[4:5], v[148:149]
  v_pk_add_f32 v[4:5], v[4:5], v[150:151]
  v_pk_add_f32 v[4:5], v[4:5], v[152:153]
  v_pk_add_f32 v[4:5], v[4:5], v[154:155]
  v_sub_f32 v4, v4, v5
  v_readlane_b32 s34, v2, 32
  v_readlane_b32 s35, v4, 32
  s_nop 0
  v_add_f32 v2, s34, v2
  v_mul_f32 v2, 0x3f3504f3, v2
  v_add_f32 v2, s40, v2
  v_add_f32 v4, s35, v4
  v_mul_f32 v4, 0x3f3504f3, v4
  v_add_f32 v4, s41, v4
  v_readlane_b32 s38, v196, 0
  v_cndmask_b32 v196, v196, v2, s[32:33]
  v_cndmask_b32 v197, v197, 0, s[32:33]
  v_cvt_pk_bf16_f32 v124, v196, v197
  v_cvt_pk_bf16_f32 v125, v198, v199
  v_cvt_pk_bf16_f32 v128, v200, v201
  v_cvt_pk_bf16_f32 v129, v202, v203
  v_cvt_pk_bf16_f32 v132, v204, v205
  v_cvt_pk_bf16_f32 v133, v206, v207
  v_cvt_pk_bf16_f32 v136, v208, v209
  v_cvt_pk_bf16_f32 v137, v210, v211
  v_readlane_b32 s39, v212, 0
  v_cndmask_b32 v212, v212, v4, s[32:33]
  v_cndmask_b32 v213, v213, 0, s[32:33]
  v_cvt_pk_bf16_f32 v126, v212, v213
  v_cvt_pk_bf16_f32 v127, v214, v215
  v_cvt_pk_bf16_f32 v130, v216, v217
  v_cvt_pk_bf16_f32 v131, v218, v219
  v_cvt_pk_bf16_f32 v134, v220, v221
  v_cvt_pk_bf16_f32 v135, v222, v223
  v_cvt_pk_bf16_f32 v138, v224, v225
  v_cvt_pk_bf16_f32 v139, v226, v227
  ds_write_b128 v252, v[124:127] offset:0
  ds_write_b128 v253, v[128:131] offset:0
  ds_write_b128 v252, v[132:135] offset:8192
  ds_write_b128 v253, v[136:139] offset:8192
  v_dot2_f32_bf16 v10, v124, v124, 0
  v_dot2_f32_bf16 v11, v126, v126, 0
  v_dot2_f32_bf16 v10, v125, v125, v10
  v_dot2_f32_bf16 v11, v127, v127, v11
  v_dot2_f32_bf16 v10, v128, v128, v10
  v_dot2_f32_bf16 v11, v130, v130, v11
  v_dot2_f32_bf16 v10, v129, v129, v10
  v_dot2_f32_bf16 v11, v131, v131, v11
  v_dot2_f32_bf16 v10, v132, v132, v10
  v_dot2_f32_bf16 v11, v134, v134, v11
  v_dot2_f32_bf16 v10, v133, v133, v10
  v_dot2_f32_bf16 v11, v135, v135, v11
  v_dot2_f32_bf16 v10, v136, v136, v10
  v_dot2_f32_bf16 v11, v138, v138, v11
  v_dot2_f32_bf16 v10, v137, v137, v10
  v_dot2_f32_bf16 v11, v139, v139, v11
  s_waitcnt lgkmcnt(0)
  s_barrier
  ds_read_b128 v[108:111], v173 offset:0
  ds_read_b128 v[112:115], v173 offset:4096
  ds_read_b128 v[116:119], v173 offset:8192
  ds_read_b128 v[120:123], v173 offset:12288
  v_add_f32_dpp v10, v10, v10 row_shr:1 row_mask:0xf bank_mask:0xf
  v_add_f32_dpp v11, v11, v11 row_shr:1 row_mask:0xf bank_mask:0xf
  s_nop 0
  v_add_f32_dpp v10, v10, v10 row_shr:2 row_mask:0xf bank_mask:0xf
  v_add_f32_dpp v11, v11, v11 row_shr:2 row_mask:0xf bank_mask:0xf
  s_nop 0
  v_add_f32_dpp v10, v10, v10 row_shr:4 row_mask:0xf bank_mask:0xf
  v_add_f32_dpp v11, v11, v11 row_shr:4 row_mask:0xf bank_mask:0xf
  s_nop 0
  v_add_f32_dpp v10, v10, v10 row_shr:8 row_mask:0xf bank_mask:0xf
  v_add_f32_dpp v11, v11, v11 row_shr:8 row_mask:0xf bank_mask:0xf
  s_nop 0
  v_add_f32_dpp v10, v10, v10 row_bcast:15 row_mask:0xa bank_mask:0xf
  v_add_f32_dpp v11, v11, v11 row_bcast:15 row_mask:0xa bank_mask:0xf
  s_nop 0
  v_add_f32_dpp v10, v10, v10 row_bcast:31 row_mask:0xc bank_mask:0xf
  v_add_f32_dpp v11, v11, v11 row_bcast:31 row_mask:0xc bank_mask:0xf
  s_mov_b32 s25, 0
  s_waitcnt lgkmcnt(3)
  buffer_store_dwordx4 v[108:111], v251, s[12:15], s25 offen sc0 sc1
  s_mov_b32 s25, 1048576
  s_waitcnt lgkmcnt(2)
  buffer_store_dwordx4 v[112:115], v251, s[12:15], s25 offen sc0 sc1
  s_mov_b32 s25, 2097152
  s_waitcnt lgkmcnt(1)
  buffer_store_dwordx4 v[116:119], v251, s[12:15], s25 offen sc0 sc1
  s_mov_b32 s25, 3145728
  s_waitcnt lgkmcnt(0)
  buffer_store_dwordx4 v[120:123], v251, s[12:15], s25 offen sc0 sc1
  v_mov_b32 v4, 0x3727c5ac
  v_fmamk_f32 v2, v10, 0x36000000, v4
  v_fmamk_f32 v3, v11, 0x36000000, v4
  v_rsq_f32 v2, v2
  v_rsq_f32 v3, v3
  v_add_f32 v178, s38, v178
  v_add_f32 v179, s39, v179
  v_subrev_f32 v178, s40, v178
  v_subrev_f32 v179, s41, v179
  s_mov_b32 exec_lo, 0
  s_mov_b32 exec_hi, 0x80000000
  buffer_store_dwordx2 v[2:3], v177, s[16:19], 0 offen sc0 sc1
  buffer_store_dwordx2 v[178:179], v177, s[16:19], s30 offen sc0 sc1
  s_mov_b64 exec, -1
  s_lshr_b32 s26, s2, 3
  s_lshl_b32 s27, s22, 5
  s_add_u32 s26, s26, s27
  s_cmp_ge_u32 s26, 3
  s_cbranch_scc1 L_mlp_kernel_pfx_32
  s_getpc_b64 s[50:51]
L_mlp_kernel_pc_33:
  s_add_u32 s50, s50, colb_kernel-L_mlp_kernel_pc_33
  s_addc_u32 s51, s51, 0
  s_lshl_b32 s52, s26, 13
  v_lshl_add_u32 v2, v1, 7, s52
  v_min_u32 v2, 24572, v2
  global_load_dword v3, v2, s[50:51]
L_mlp_kernel_pfx_32:
  s_endpgm
L_mlp_inv:
  s_load_dwordx2 s[6:7], s[0:1], 64
  s_lshl4_add_u32 s26, s20, s21
  s_getpc_b64 s[48:49]
L_mlp_kernel_pc_34:
  s_add_u32 s48, s48, tab_inv-L_mlp_kernel_pc_34
  s_addc_u32 s49, s49, 0
  s_lshl_b32 s50, s22, 12
  v_and_b32 v5, 63, v0
  v_lshl_add_u32 v5, v5, 4, s50
  s_add_u32 m0, s50, 49152
  s_nop 0
  global_load_lds_dwordx4 v5, s[48:49] offset:0
  global_load_lds_dwordx4 v5, s[48:49] offset:1024
  global_load_lds_dwordx4 v5, s[48:49] offset:2048
  global_load_lds_dwordx4 v5, s[48:49] offset:3072
  s_lshl_b32 s27, s20, 11
  s_lshl2_add_u32 s27, s21, s27
  s_add_u32 s27, s27, 32
  s_lshl_b32 s21, s26, 6
  s_lshl_b32 s20, s26, 3
  s_lshl1_add_u32 s20, s22, s20
  s_lshl_b32 s24, s22, 13
  s_lshl_b32 s23, s22, 10
  s_add_u32 s16, s4, 0x400000
  s_addc_u32 s17, s5, 0
  s_mov_b32 s18, 0x4000
  s_mov_b32 s19, 0x20000
  s_add_u32 s8, s4, 0x3800000
  s_addc_u32 s9, s5, 0
  s_mov_b32 s10, 0x800000
  s_mov_b32 s11, 0x20000
  s_lshl_b32 s23, s20, 2
  v_mov_b32 v237, s23
  s_movk_i32 s30, 0x2000
  buffer_load_dwordx2 v[242:243], v237, s[16:19], s30 offen
  v_lshrrev_b32 v3, 2, v1
  v_xor_b32 v3, v3, v1
  v_and_b32 v3, 4, v3
  v_lshrrev_b32 v2, 3, v1
  v_lshlrev_b32 v2, 17, v2
  v_and_or_b32 v3, v1, 3, v3
  v_lshl_add_u32 v2, v3, 4, v2
  s_lshl_b32 s23, s20, 6
  v_add_u32 v246, s23, v2
  v_and_b32 v2, 15, v1
  v_lshl_add_u32 v247, v2, 7, s27
  s_lshl_b32 s23, s26, 7
  s_add_u32 s23, s23, 32
  v_lshl_add_u32 v248, v2, 2, s23
  v_mov_b32 v249, 1
  v_lshlrev_b32 v5, 4, v1
  s_and_b32 s23, s20, 0x700
  s_bfe_u32 s25, s20, 0x50001
  s_or_b32 s23, s23, s25
  s_and_b32 s25, s20, 64
  s_lshl1_add_u32 s23, s25, s23
  s_and_b32 s25, s20, 128
  s_lshr_b32 s25, s25, 1
  s_or_b32 s23, s23, s25
  s_lshl_b32 s23, s23, 11
  s_mov_b32 s29, 0x10000
  v_and_b32 v2, 15, v1
  v_lshl_add_u32 v240, v2, 6, s23
  v_lshrrev_b32 v2, 5, v1
  v_lshl_add_u32 v240, v2, 4, v240
  v_lshl_add_u32 v244, v2, 5, s24
  v_bfe_u32 v2, v1, 4, 1
  v_lshl_add_u32 v240, v2, 5, v240
  v_and_b32 v2, 31, v1
  v_lshl_add_u32 v244, v2, 7, v244
  v_bfe_u32 v2, v1, 1, 1
  v_lshl_add_u32 v244, v2, 6, v244
  v_xor_b32 v245, 64, v244
  v_and_b32 v2, 1, v1
  v_cvt_f32_u32 v241, v2
  v_mul_f32 v241, 0xbb3504f3, v241
  v_add_f32 v241, 0xba15f61a, v241
  v_cmp_gt_u32 vcc, 32, v1
  s_waitcnt lgkmcnt(0)
  s_nop 0
  v_cndmask_b32 v241, 0, v241, vcc
  s_mov_b32 s40, s6
  s_mov_b32 s41, s7
  s_mov_b32 s42, 0x400000
  s_mov_b32 s43, 0x20000
  s_waitcnt vmcnt(0)
  s_barrier
  ds_read_b64 v[76:77], v252 offset:0
  ds_read_b64 v[78:79], v253 offset:0
  ds_read_b64 v[80:81], v252 offset:8192
  ds_read_b64 v[82:83], v253 offset:8192
  ds_read_b64 v[84:85], v252 offset:8
  ds_read_b64 v[86:87], v253 offset:8
  ds_read_b64 v[88:89], v252 offset:8200
  ds_read_b64 v[90:91], v253 offset:8200
  ds_read_b128 v[12:15], v5 offset:49152
  ds_read_b128 v[16:19], v5 offset:50176
  ds_read_b128 v[20:23], v5 offset:51200
  ds_read_b128 v[24:27], v5 offset:52224
  v_mul_f32 v242, 0x3a800000, v242
  v_mul_f32 v243, 0x3a800000, v243
  v_mov_b32 v188, v242
  v_mov_b32 v189, v242
  v_mov_b32 v190, v242
  v_mov_b32 v191, v242
  v_mov_b32 v192, v242
  v_mov_b32 v193, v242
  v_mov_b32 v194, v242
  v_mov_b32 v195, v242
  v_mov_b32 v196, v242
  v_mov_b32 v197, v242
  v_mov_b32 v198, v242
  v_mov_b32 v199, v242
  v_mov_b32 v200, v242
  v_mov_b32 v201, v242
  v_mov_b32 v202, v242
  v_mov_b32 v203, v242
  v_mov_b32 v204, v243
  v_mov_b32 v205, v243
  v_mov_b32 v206, v243
  v_mov_b32 v207, v243
  v_mov_b32 v208, v243
  v_mov_b32 v209, v243
  v_mov_b32 v210, v243
  v_mov_b32 v211, v243
  v_mov_b32 v212, v243
  v_mov_b32 v213, v243
  v_mov_b32 v214, v243
  v_mov_b32 v215, v243
  v_mov_b32 v216, v243
  v_mov_b32 v217, v243
  v_mov_b32 v218, v243
  v_mov_b32 v219, v243
  s_waitcnt lgkmcnt(0)
  ds_read_b128 v[28:31], v5 offset:53248
  ds_read_b128 v[32:35], v5 offset:54272
  ds_read_b128 v[36:39], v5 offset:55296
  ds_read_b128 v[40:43], v5 offset:56320
  ds_read_b128 v[44:47], v5 offset:57344
  ds_read_b128 v[48:51], v5 offset:58368
  ds_read_b128 v[52:55], v5 offset:59392
  ds_read_b128 v[56:59], v5 offset:60416
  ds_read_b128 v[60:63], v5 offset:61440
  ds_read_b128 v[64:67], v5 offset:62464
  ds_read_b128 v[68:71], v5 offset:63488
  ds_read_b128 v[72:75], v5 offset:64512
  v_mfma_f32_32x32x16_bf16 v[92:107], v[76:79], v[12:15], 0
  v_mfma_f32_32x32x16_bf16 v[108:123], v[76:79], v[20:23], 0
  v_mfma_f32_32x32x16_bf16 v[92:107], v[80:83], v[16:19], v[92:107]
  v_mfma_f32_32x32x16_bf16 v[108:123], v[80:83], v[24:27], v[108:123]
  v_readlane_b32 s34, v76, 0
  v_mfma_f32_32x32x16_bf16 v[124:139], v[84:87], v[12:15], 0
  v_mfma_f32_32x32x16_bf16 v[140:155], v[84:87], v[20:23], 0
  v_mfma_f32_32x32x16_bf16 v[124:139], v[88:91], v[16:19], v[124:139]
  v_mfma_f32_32x32x16_bf16 v[140:155], v[88:91], v[24:27], v[140:155]
  v_readlane_b32 s35, v84, 0
  s_lshl_b32 s34, s34, 16
  s_lshl_b32 s35, s35, 16
  s_waitcnt lgkmcnt(0)
  s_barrier
  s_cmp_eq_u32 s22, 0
  s_cbranch_scc1 L_mlp_kernel_w1_38
  s_branch L_mlp_kernel_w0_35
L_mlp_kernel_w1_38:
  s_mov_b64 exec, 0xffff
  buffer_store_dword v249, v247, s[44:47], 0 offen sc0 sc1
  s_mov_b64 exec, -1
  s_mov_b32 s31, 400000
L_mlp_kernel_spin_36:
  buffer_load_dword v250, v248, s[44:47], 0 offen sc0 sc1
  s_waitcnt vmcnt(0)
  v_cmp_eq_u32 vcc, 0, v250
  s_nop 1
  s_cbranch_vccz L_mlp_kernel_w0_35
  s_sleep 1
  s_sub_u32 s31, s31, 1
  s_cmp_lg_u32 s31, 0
  s_cbranch_scc1 L_mlp_kernel_spin_36
L_mlp_kernel_w0_35:
  s_barrier
  s_add_u32 m0, s24, 0
  s_mov_b32 s25, 0
  buffer_load_dwordx4 v246, s[8:11], s25 offen sc0 sc1 lds
  s_add_u32 m0, s24, 1024
  s_mov_b32 s25, 1048576
  buffer_load_dwordx4 v246, s[8:11], s25 offen sc0 sc1 lds
  s_add_u32 m0, s24, 2048
  s_mov_b32 s25, 2097152
  buffer_load_dwordx4 v246, s[8:11], s25 offen sc0 sc1 lds
  s_add_u32 m0, s24, 3072
  s_mov_b32 s25, 3145728
  buffer_load_dwordx4 v246, s[8:11], s25 offen sc0 sc1 lds
  s_add_u32 m0, s24, 4096
  s_mov_b32 s25, 4194304
  buffer_load_dwordx4 v246, s[8:11], s25 offen sc0 sc1 lds
  s_add_u32 m0, s24, 5120
  s_mov_b32 s25, 5242880
  buffer_load_dwordx4 v246, s[8:11], s25 offen sc0 sc1 lds
  s_add_u32 m0, s24, 6144
  s_mov_b32 s25, 6291456
  buffer_load_dwordx4 v246, s[8:11], s25 offen sc0 sc1 lds
  s_add_u32 m0, s24, 7168
  s_mov_b32 s25, 7340032
  buffer_load_dwordx4 v246, s[8:11], s25 offen sc0 sc1 lds
  v_fmac_f32 v92, s34, v241
  v_pk_mul_f32 v[2:3], v[92:93], v[28:29]
  v_pk_mul_f32 v[4:5], v[108:109], v[28:29]
  v_pk_mul_f32 v[6:7], v[94:95], v[30:31]
  v_pk_mul_f32 v[8:9], v[110:111], v[30:31]
  v_pk_fma_f32 v[2:3], v[108:109], v[44:45], v[2:3] neg_lo:[1,0,0] neg_hi:[1,0,0]
  v_pk_fma_f32 v[4:5], v[92:93], v[44:45], v[4:5]
  v_pk_fma_f32 v[6:7], v[110:111], v[46:47], v[6:7] neg_lo:[1,0,0] neg_hi:[1,0,0]
  v_pk_fma_f32 v[8:9], v[94:95], v[46:47], v[8:9]
  v_cvt_pk_bf16_f32 v156, v2, v4
  v_cvt_pk_bf16_f32 v157, v3, v5
  v_cvt_pk_bf16_f32 v158, v6, v8
  v_cvt_pk_bf16_f32 v159, v7, v9
  v_pk_mul_f32 v[2:3], v[96:97], v[32:33]
  v_pk_mul_f32 v[4:5], v[112:113], v[32:33]
  v_pk_mul_f32 v[6:7], v[98:99], v[34:35]
  v_pk_mul_f32 v[8:9], v[114:115], v[34:35]
  v_pk_fma_f32 v[2:3], v[112:113], v[48:49], v[2:3] neg_lo:[1,0,0] neg_hi:[1,0,0]
  v_pk_fma_f32 v[4:5], v[96:97], v[48:49], v[4:5]
  v_pk_fma_f32 v[6:7], v[114:115], v[50:51], v[6:7] neg_lo:[1,0,0] neg_hi:[1,0,0]
  v_pk_fma_f32 v[8:9], v[98:99], v[50:51], v[8:9]
  v_cvt_pk_bf16_f32 v160, v2, v4
  v_cvt_pk_bf16_f32 v161, v3, v5
  v_cvt_pk_bf16_f32 v162, v6, v8
  v_cvt_pk_bf16_f32 v163, v7, v9
  v_pk_mul_f32 v[2:3], v[100:101], v[36:37]
  v_pk_mul_f32 v[4:5], v[116:117], v[36:37]
  v_pk_mul_f32 v[6:7], v[102:103], v[38:39]
  v_pk_mul_f32 v[8:9], v[118:119], v[38:39]
  v_pk_fma_f32 v[2:3], v[116:117], v[52:53], v[2:3] neg_lo:[1,0,0] neg_hi:[1,0,0]
  v_pk_fma_f32 v[4:5], v[100:101], v[52:53], v[4:5]
  v_pk_fma_f32 v[6:7], v[118:119], v[54:55], v[6:7] neg_lo:[1,0,0] neg_hi:[1,0,0]
  v_pk_fma_f32 v[8:9], v[102:103], v[54:55], v[8:9]
  v_cvt_pk_bf16_f32 v164, v2, v4
  v_cvt_pk_bf16_f32 v165, v3, v5
  v_cvt_pk_bf16_f32 v166, v6, v8
  v_cvt_pk_bf16_f32 v167, v7, v9
  v_pk_mul_f32 v[2:3], v[104:105], v[40:41]
  v_pk_mul_f32 v[4:5], v[120:121], v[40:41]
  v_pk_mul_f32 v[6:7], v[106:107], v[42:43]
  v_pk_mul_f32 v[8:9], v[122:123], v[42:43]
  v_pk_fma_f32 v[2:3], v[120:121], v[56:57], v[2:3] neg_lo:[1,0,0] neg_hi:[1,0,0]
  v_pk_fma_f32 v[4:5], v[104:105], v[56:57], v[4:5]
  v_pk_fma_f32 v[6:7], v[122:123], v[58:59], v[6:7] neg_lo:[1,0,0] neg_hi:[1,0,0]
  v_pk_fma_f32 v[8:9], v[106:107], v[58:59], v[8:9]
  v_cvt_pk_bf16_f32 v168, v2, v4
  v_cvt_pk_bf16_f32 v169, v3, v5
  v_cvt_pk_bf16_f32 v170, v6, v8
  v_cvt_pk_bf16_f32 v171, v7, v9
  v_mfma_f32_32x32x16_bf16 v[188:203], v[156:159], v[60:63], v[188:203]
  v_mfma_f32_32x32x16_bf16 v[188:203], v[160:163], v[64:67], v[188:203]
  v_mfma_f32_32x32x16_bf16 v[188:203], v[164:167], v[68:71], v[188:203]
  v_mfma_f32_32x32x16_bf16 v[188:203], v[168:171], v[72:75], v[188:203]
  v_fmac_f32 v124, s35, v241
  v_pk_mul_f32 v[2:3], v[124:125], v[28:29]
  v_pk_mul_f32 v[4:5], v[140:141], v[28:29]
  v_pk_mul_f32 v[6:7], v[126:127], v[30:31]
  v_pk_mul_f32 v[8:9], v[142:143], v[30:31]
  v_pk_fma_f32 v[2:3], v[140:141], v[44:45], v[2:3] neg_lo:[1,0,0] neg_hi:[1,0,0]
  v_pk_fma_f32 v[4:5], v[124:125], v[44:45], v[4:5]
  v_pk_fma_f32 v[6:7], v[142:143], v[46:47], v[6:7] neg_lo:[1,0,0] neg_hi:[1,0,0]
  v_pk_fma_f32 v[8:9], v[126:127], v[46:47], v[8:9]
  v_cvt_pk_bf16_f32 v172, v2, v4
  v_cvt_pk_bf16_f32 v173, v3, v5
  v_cvt_pk_bf16_f32 v174, v6, v8
  v_cvt_pk_bf16_f32 v175, v7, v9
  v_pk_mul_f32 v[2:3], v[128:129], v[32:33]
  v_pk_mul_f32 v[4:5], v[144:145], v[32:33]
  v_pk_mul_f32 v[6:7], v[130:131], v[34:35]
  v_pk_mul_f32 v[8:9], v[146:147], v[34:35]
  v_pk_fma_f32 v[2:3], v[144:145], v[48:49], v[2:3] neg_lo:[1,0,0] neg_hi:[1,0,0]
  v_pk_fma_f32 v[4:5], v[128:129], v[48:49], v[4:5]
  v_pk_fma_f32 v[6:7], v[146:147], v[50:51], v[6:7] neg_lo:[1,0,0] neg_hi:[1,0,0]
  v_pk_fma_f32 v[8:9], v[130:131], v[50:51], v[8:9]
  v_cvt_pk_bf16_f32 v176, v2, v4
  v_cvt_pk_bf16_f32 v177, v3, v5
  v_cvt_pk_bf16_f32 v178, v6, v8
  v_cvt_pk_bf16_f32 v179, v7, v9
  v_pk_mul_f32 v[2:3], v[132:133], v[36:37]
  v_pk_mul_f32 v[4:5], v[148:149], v[36:37]
  v_pk_mul_f32 v[6:7], v[134:135], v[38:39]
  v_pk_mul_f32 v[8:9], v[150:151], v[38:39]
  v_pk_fma_f32 v[2:3], v[148:149], v[52:53], v[2:3] neg_lo:[1,0,0] neg_hi:[1,0,0]
  v_pk_fma_f32 v[4:5], v[132:133], v[52:53], v[4:5]
  v_pk_fma_f32 v[6:7], v[150:151], v[54:55], v[6:7] neg_lo:[1,0,0] neg_hi:[1,0,0]
  v_pk_fma_f32 v[8:9], v[134:135], v[54:55], v[8:9]
  v_cvt_pk_bf16_f32 v180, v2, v4
  v_cvt_pk_bf16_f32 v181, v3, v5
  v_cvt_pk_bf16_f32 v182, v6, v8
  v_cvt_pk_bf16_f32 v183, v7, v9
  v_pk_mul_f32 v[2:3], v[136:137], v[40:41]
  v_pk_mul_f32 v[4:5], v[152:153], v[40:41]
  v_pk_mul_f32 v[6:7], v[138:139], v[42:43]
  v_pk_mul_f32 v[8:9], v[154:155], v[42:43]
  v_pk_fma_f32 v[2:3], v[152:153], v[56:57], v[2:3] neg_lo:[1,0,0] neg_hi:[1,0,0]
  v_pk_fma_f32 v[4:5], v[136:137], v[56:57], v[4:5]
  v_pk_fma_f32 v[6:7], v[154:155], v[58:59], v[6:7] neg_lo:[1,0,0] neg_hi:[1,0,0]
  v_pk_fma_f32 v[8:9], v[138:139], v[58:59], v[8:9]
  v_cvt_pk_bf16_f32 v184, v2, v4
  v_cvt_pk_bf16_f32 v185, v3, v5
  v_cvt_pk_bf16_f32 v186, v6, v8
  v_cvt_pk_bf16_f32 v187, v7, v9
  v_mfma_f32_32x32x16_bf16 v[204:219], v[172:175], v[60:63], v[204:219]
  v_mfma_f32_32x32x16_bf16 v[204:219], v[176:179], v[64:67], v[204:219]
  v_mfma_f32_32x32x16_bf16 v[204:219], v[180:183], v[68:71], v[204:219]
  v_mfma_f32_32x32x16_bf16 v[204:219], v[184:187], v[72:75], v[204:219]
  s_waitcnt vmcnt(0)
  ds_read_b128 v[108:111], v244 offset:0
  ds_read_b128 v[112:115], v244 offset:16
  ds_read_b128 v[116:119], v244 offset:4096
  ds_read_b128 v[120:123], v244 offset:4112
  ds_read_b128 v[140:143], v245 offset:0
  ds_read_b128 v[144:147], v245 offset:16
  ds_read_b128 v[148:151], v245 offset:4096
  ds_read_b128 v[152:155], v245 offset:4112
  s_waitcnt lgkmcnt(4)
  v_lshlrev_b32 v12, 16, v108
  v_and_b32 v13, 0xffff0000, v108
  v_lshlrev_b32 v14, 16, v109
  v_and_b32 v15, 0xffff0000, v109
  v_lshlrev_b32 v16, 16, v110
  v_and_b32 v17, 0xffff0000, v110
  v_lshlrev_b32 v18, 16, v111
  v_and_b32 v19, 0xffff0000, v111
  v_lshlrev_b32 v20, 16, v112
  v_and_b32 v21, 0xffff0000, v112
  v_lshlrev_b32 v22, 16, v113
  v_and_b32 v23, 0xffff0000, v113
  v_lshlrev_b32 v24, 16, v114
  v_and_b32 v25, 0xffff0000, v114
  v_lshlrev_b32 v26, 16, v115
  v_and_b32 v27, 0xffff0000, v115
  v_lshlrev_b32 v28, 16, v116
  v_and_b32 v29, 0xffff0000, v116
  v_lshlrev_b32 v30, 16, v117
  v_and_b32 v31, 0xffff0000, v117
  v_lshlrev_b32 v32, 16, v118
  v_and_b32 v33, 0xffff0000, v118
  v_lshlrev_b32 v34, 16, v119
  v_and_b32 v35, 0xffff0000, v119
  v_lshlrev_b32 v36, 16, v120
  v_and_b32 v37, 0xffff0000, v120
  v_lshlrev_b32 v38, 16, v121
  v_and_b32 v39, 0xffff0000, v121
  v_lshlrev_b32 v40, 16, v122
  v_and_b32 v41, 0xffff0000, v122
  v_lshlrev_b32 v42, 16, v123
  v_and_b32 v43, 0xffff0000, v123
  v_pk_add_f32 v[188:189], v[188:189], v[12:13]
  v_pk_add_f32 v[190:191], v[190:191], v[14:15]
  v_pk_add_f32 v[192:193], v[192:193], v[16:17]
  v_pk_add_f32 v[194:195], v[194:195], v[18:19]
  v_pk_add_f32 v[196:197], v[196:197], v[20:21]
  v_pk_add_f32 v[198:199], v[198:199], v[22:23]
  v_pk_add_f32 v[200:201], v[200:201], v[24:25]
  v_pk_add_f32 v[202:203], v[202:203], v[26:27]
  v_pk_add_f32 v[188:189], v[188:189], v[28:29]
  v_pk_add_f32 v[190:191], v[190:191], v[30:31]
  v_pk_add_f32 v[192:193], v[192:193], v[32:33]
  v_pk_add_f32 v[194:195], v[194:195], v[34:35]
  v_pk_add_f32 v[196:197], v[196:197], v[36:37]
  v_pk_add_f32 v[198:199], v[198:199], v[38:39]
  v_pk_add_f32 v[200:201], v[200:201], v[40:41]
  v_pk_add_f32 v[202:203], v[202:203], v[42:43]
  v_cvt_pk_bf16_f32 v92, v188, v189
  v_cvt_pk_bf16_f32 v93, v190, v191
  v_cvt_pk_bf16_f32 v96, v192, v193
  v_cvt_pk_bf16_f32 v97, v194, v195
  v_cvt_pk_bf16_f32 v94, v196, v197
  v_cvt_pk_bf16_f32 v95, v198, v199
  v_cvt_pk_bf16_f32 v98, v200, v201
  v_cvt_pk_bf16_f32 v99, v202, v203
  v_permlane16_swap_b32 v92, v96
  v_permlane16_swap_b32 v93, v97
  v_permlane16_swap_b32 v94, v98
  v_permlane16_swap_b32 v95, v99
  buffer_store_dwordx4 v[92:95], v240, s[40:43], 0 offen offset:0 sc0 sc1
  buffer_store_dwordx4 v[96:99], v240, s[40:43], 0 offen offset:1024 sc0 sc1
  s_waitcnt lgkmcnt(0)
  v_lshlrev_b32 v12, 16, v140
  v_and_b32 v13, 0xffff0000, v140
  v_lshlrev_b32 v14, 16, v141
  v_and_b32 v15, 0xffff0000, v141
  v_lshlrev_b32 v16, 16, v142
  v_and_b32 v17, 0xffff0000, v142
  v_lshlrev_b32 v18, 16, v143
  v_and_b32 v19, 0xffff0000, v143
  v_lshlrev_b32 v20, 16, v144
  v_and_b32 v21, 0xffff0000, v144
  v_lshlrev_b32 v22, 16, v145
  v_and_b32 v23, 0xffff0000, v145
  v_lshlrev_b32 v24, 16, v146
  v_and_b32 v25, 0xffff0000, v146
  v_lshlrev_b32 v26, 16, v147
  v_and_b32 v27, 0xffff0000, v147
  v_lshlrev_b32 v28, 16, v148
  v_and_b32 v29, 0xffff0000, v148
  v_lshlrev_b32 v30, 16, v149
  v_and_b32 v31, 0xffff0000, v149
  v_lshlrev_b32 v32, 16, v150
  v_and_b32 v33, 0xffff0000, v150
  v_lshlrev_b32 v34, 16, v151
  v_and_b32 v35, 0xffff0000, v151
  v_lshlrev_b32 v36, 16, v152
  v_and_b32 v37, 0xffff0000, v152
  v_lshlrev_b32 v38, 16, v153
  v_and_b32 v39, 0xffff0000, v153
  v_lshlrev_b32 v40, 16, v154
  v_and_b32 v41, 0xffff0000, v154
  v_lshlrev_b32 v42, 16, v155
  v_and_b32 v43, 0xffff0000, v155
  v_pk_add_f32 v[204:205], v[204:205], v[12:13]
  v_pk_add_f32 v[206:207], v[206:207], v[14:15]
  v_pk_add_f32 v[208:209], v[208:209], v[16:17]
  v_pk_add_f32 v[210:211], v[210:211], v[18:19]
  v_pk_add_f32 v[212:213], v[212:213], v[20:21]
  v_pk_add_f32 v[214:215], v[214:215], v[22:23]
  v_pk_add_f32 v[216:217], v[216:217], v[24:25]
  v_pk_add_f32 v[218:219], v[218:219], v[26:27]
  v_pk_add_f32 v[204:205], v[204:205], v[28:29]
  v_pk_add_f32 v[206:207], v[206:207], v[30:31]
  v_pk_add_f32 v[208:209], v[208:209], v[32:33]
  v_pk_add_f32 v[210:211], v[210:211], v[34:35]
  v_pk_add_f32 v[212:213], v[212:213], v[36:37]
  v_pk_add_f32 v[214:215], v[214:215], v[38:39]
  v_pk_add_f32 v[216:217], v[216:217], v[40:41]
  v_pk_add_f32 v[218:219], v[218:219], v[42:43]
  v_cvt_pk_bf16_f32 v124, v204, v205
  v_cvt_pk_bf16_f32 v125, v206, v207
  v_cvt_pk_bf16_f32 v128, v208, v209
  v_cvt_pk_bf16_f32 v129, v210, v211
  v_cvt_pk_bf16_f32 v126, v212, v213
  v_cvt_pk_bf16_f32 v127, v214, v215
  v_cvt_pk_bf16_f32 v130, v216, v217
  v_cvt_pk_bf16_f32 v131, v218, v219
  v_permlane16_swap_b32 v124, v128
  v_permlane16_swap_b32 v125, v129
  v_permlane16_swap_b32 v126, v130
  v_permlane16_swap_b32 v127, v131
  buffer_store_dwordx4 v[124:127], v240, s[40:43], s29 offen offset:0 sc0 sc1
  buffer_store_dwordx4 v[128:131], v240, s[40:43], s29 offen offset:1024 sc0 sc1
  s_endpgm
L_mlp_mma:
  s_mov_b32 s56, s20
  s_and_b32 s57, s21, 7
  s_lshr_b32 s58, s21, 3
  s_and_b32 s59, s57, 3
  s_lshl_b32 s59, s59, 7
  s_and_b32 s55, s57, 4
  s_lshl_b32 s55, s55, 8
  s_add_u32 s59, s59, s55
  v_and_b32 v228, 63, v0
  s_and_b32 s23, s22, 1
  s_lshr_b32 s24, s22, 1
  s_mov_b32 s28, 139264
  s_lshl_b32 s29, s23, 9
  s_add_u32 s29, s29, s28
  v_lshrrev_b32 v230, 4, v228
  v_lshl_add_u32 v231, v230, 4, s29
  s_lshl_b32 s29, s23, 6
  s_add_u32 s29, s29, s28
  v_lshl_add_u32 v232, v230, 4, s29
  v_and_b32 v233, 15, v228
  v_and_b32 v234, 7, v228
  v_xor_b32 v234, v234, v230
  v_lshlrev_b32 v234, 4, v234
  v_lshl_add_u32 v234, v233, 7, v234
  s_mul_i32 s28, s23, 14336
  v_add_u32 v204, s28, v234
  v_xor_b32 v205, 64, v204
  v_mul_u32_u24 v234, 2176, v230
  v_lshl_add_u32 v234, v233, 3, v234
  s_lshl_b32 s28, s24, 9
  s_add_u32 s28, s28, 28672
  v_add_u32 v210, s28, v234
  s_lshl_b32 s28, s24, 8
  s_lshl_b32 s29, s20, 9
  s_add_u32 s28, s28, s29
  s_add_u32 s28, s28, 0x8000
  v_lshl_add_u32 v229, v233, 2, s28
  v_add_u32 v206, 46080, v204
  v_add_u32 v207, 46080, v205
  v_add_u32 v211, 46080, v210
  v_add_u32 v208, 92160, v204
  v_add_u32 v209, 92160, v205
  v_add_u32 v212, 92160, v210
  v_lshlrev_b32 v238, 4, v228
  v_add_u32 v252, 0x300, v238
  v_add_u32 v234, 0x80, v238
  v_cmp_lt_u32 vcc, 23, v228
  s_nop 1
  v_cndmask_b32 v238, v238, v234, vcc
  v_add_u32 v234, 0x80, v252
  v_cmp_lt_u32 vcc, 39, v228
  s_nop 1
  v_cndmask_b32 v252, v252, v234, vcc
  s_mul_i32 s28, s20, 112
  s_mul_i32 s29, s21, 7
  s_add_u32 s28, s28, s29
  s_lshl_b32 s28, s28, 14
  s_lshl_b32 s29, s24, 13
  s_add_u32 s28, s28, s29
  s_cmp_eq_u32 s23, 0
  s_cselect_b64 vcc, 0, -1
  v_add_u32 v252, 0x800, v252
  s_add_u32 s29, s28, 49152
  v_cndmask_b32 v239, v238, v252, vcc
  v_add_u32 v239, s29, v239
  s_lshl_b32 s29, s23, 16
  s_add_u32 s29, s29, s28
  v_add_u32 v238, s29, v238
  v_add_u32 v252, s29, v252
  v_lshrrev_b32 v235, 2, v228
  v_bfe_u32 v234, v228, 3, 2
  v_lshlrev_b32 v234, 5, v234
  v_lshl_add_u32 v234, v235, 7, v234
  v_and_b32 v235, 3, v228
  v_lshl_add_u32 v234, v235, 3, v234
  s_lshl_b32 s26, s23, 12
  v_add_u32 v234, s26, v234
  s_lshl_b32 s26, s24, 12
  s_add_u32 s26, s26, 16384
  v_lshl_add_u32 v235, v228, 4, s26
  v_lshlrev_b32 v236, 6, v233
  v_lshl_add_u32 v236, v230, 4, v236
  s_lshl_b32 s26, s56, 13
  s_lshl_b32 s27, s24, 12
  s_add_u32 s26, s26, s27
  s_lshl_b32 s27, s58, 22
  s_add_u32 s26, s26, s27
  s_mul_i32 s27, s23, 512
  s_add_u32 s27, s27, s59
  s_lshl_b32 s25, s27, 11
  s_add_u32 s26, s26, s25
  v_add_u32 v236, s26, v236
  s_lshl_b32 s27, s23, 7
  s_add_u32 s27, s27, 140288
  v_lshl_add_u32 v237, v230, 3, s27
  s_lshl_b32 s27, s24, 8
  s_add_u32 s27, s27, 138752
  v_lshl_add_u32 v233, v233, 2, s27
  s_waitcnt lgkmcnt(0)
  s_add_u32 s12, s4, 0x1800000
  s_addc_u32 s13, s5, 0
  s_mov_b32 s14, 0x1c00000
  s_mov_b32 s15, 0x20000
  s_add_u32 s40, s4, 0x3800000
  s_addc_u32 s41, s5, 0
  s_mov_b32 s42, 0x800000
  s_mov_b32 s43, 0x20000
  s_add_u32 s44, s4, 0x410000
  s_addc_u32 s45, s5, 0
  s_mov_b32 s46, 0xa000
  s_mov_b32 s47, 0x20000
  v_mov_b32 v214, v234
  v_xor_b32 v216, 32, v234
  v_xor_b32 v218, 64, v234
  v_xor_b32 v220, 96, v234
  v_mov_b32 v222, v235
  v_add_u32 v215, 0x10000, v214
  v_add_u32 v217, 0x10000, v216
  v_add_u32 v219, 0x10000, v218
  v_add_u32 v221, 0x10000, v220
  v_add_u32 v223, 0x10000, v222
  s_waitcnt lgkmcnt(0)
  s_barrier
  ds_read_b128 v[112:115], v204 offset:0
  ds_read_b64 v[140:141], v210 offset:0
  ds_read_b64 v[142:143], v210 offset:1088
  ds_read_b64 v[144:145], v210 offset:128
  ds_read_b64 v[146:147], v210 offset:1216
  ds_read_b64 v[148:149], v210 offset:256
  ds_read_b64 v[150:151], v210 offset:1344
  ds_read_b64 v[152:153], v210 offset:384
  ds_read_b64 v[154:155], v210 offset:1472
  ds_read_b128 v[116:119], v204 offset:2048
  ds_read_b128 v[120:123], v204 offset:4096
  ds_read_b128 v[124:127], v204 offset:6144
  ds_read_b128 v[128:131], v204 offset:8192
  ds_read_b128 v[132:135], v204 offset:10240
  ds_read_b128 v[136:139], v204 offset:12288
  s_waitcnt lgkmcnt(0)
  v_mfma_f32_16x16x32_bf16 v[0:3], v[112:115], v[140:143], 0
  ds_read_b128 v[156:159], v205 offset:0
  v_mfma_f32_16x16x32_bf16 v[16:19], v[116:119], v[140:143], 0
  ds_read_b64 v[184:185], v210 offset:8704
  v_mfma_f32_16x16x32_bf16 v[32:35], v[120:123], v[140:143], 0
  ds_read_b64 v[186:187], v210 offset:9792
  v_mfma_f32_16x16x32_bf16 v[48:51], v[124:127], v[140:143], 0
  ds_read_b64 v[188:189], v210 offset:8832
  v_mfma_f32_16x16x32_bf16 v[64:67], v[128:131], v[140:143], 0
  ds_read_b64 v[190:191], v210 offset:9920
  v_mfma_f32_16x16x32_bf16 v[80:83], v[132:135], v[140:143], 0
  ds_read_b64 v[192:193], v210 offset:8960
  v_mfma_f32_16x16x32_bf16 v[96:99], v[136:139], v[140:143], 0
  ds_read_b64 v[194:195], v210 offset:10048
  v_mfma_f32_16x16x32_bf16 v[100:103], v[136:139], v[144:147], 0
  ds_read_b64 v[196:197], v210 offset:9088
  v_mfma_f32_16x16x32_bf16 v[84:87], v[132:135], v[144:147], 0
  ds_read_b64 v[198:199], v210 offset:10176
  v_mfma_f32_16x16x32_bf16 v[68:71], v[128:131], v[144:147], 0
  ds_read_b128 v[160:163], v205 offset:2048
  v_mfma_f32_16x16x32_bf16 v[52:55], v[124:127], v[144:147], 0
  ds_read_b128 v[164:167], v205 offset:4096
  v_mfma_f32_16x16x32_bf16 v[36:39], v[120:123], v[144:147], 0
  ds_read_b128 v[168:171], v205 offset:6144
  v_mfma_f32_16x16x32_bf16 v[20:23], v[116:119], v[144:147], 0
  ds_read_b128 v[172:175], v205 offset:8192
  v_mfma_f32_16x16x32_bf16 v[4:7], v[112:115], v[144:147], 0
  ds_read_b128 v[176:179], v205 offset:10240
  v_mfma_f32_16x16x32_bf16 v[8:11], v[112:115], v[148:151], 0
  ds_read_b128 v[180:183], v205 offset:12288
  v_mfma_f32_16x16x32_bf16 v[24:27], v[116:119], v[148:151], 0
  v_mfma_f32_16x16x32_bf16 v[40:43], v[120:123], v[148:151], 0
  v_mfma_f32_16x16x32_bf16 v[56:59], v[124:127], v[148:151], 0
  v_mfma_f32_16x16x32_bf16 v[72:75], v[128:131], v[148:151], 0
  v_mfma_f32_16x16x32_bf16 v[88:91], v[132:135], v[148:151], 0
  v_mfma_f32_16x16x32_bf16 v[104:107], v[136:139], v[148:151], 0
  v_mfma_f32_16x16x32_bf16 v[108:111], v[136:139], v[152:155], 0
  v_mfma_f32_16x16x32_bf16 v[92:95], v[132:135], v[152:155], 0
  v_mfma_f32_16x16x32_bf16 v[76:79], v[128:131], v[152:155], 0
  v_mfma_f32_16x16x32_bf16 v[60:63], v[124:127], v[152:155], 0
  v_mfma_f32_16x16x32_bf16 v[44:47], v[120:123], v[152:155], 0
  v_mfma_f32_16x16x32_bf16 v[28:31], v[116:119], v[152:155], 0
  v_mfma_f32_16x16x32_bf16 v[12:15], v[112:115], v[152:155], 0
  s_mov_b32 s31, 5
  s_branch L_g1_l1
L_g1_l0:
  s_waitcnt lgkmcnt(0)
  s_barrier
  v_mfma_f32_16x16x32_bf16 v[0:3], v[156:159], v[184:187], v[0:3]
  ds_read_b128 v[112:115], v204 offset:0
  v_mfma_f32_16x16x32_bf16 v[16:19], v[160:163], v[184:187], v[16:19]
  ds_read_b64 v[140:141], v210 offset:0
  v_mfma_f32_16x16x32_bf16 v[32:35], v[164:167], v[184:187], v[32:35]
  ds_read_b64 v[142:143], v210 offset:1088
  v_mfma_f32_16x16x32_bf16 v[48:51], v[168:171], v[184:187], v[48:51]
  ds_read_b64 v[144:145], v210 offset:128
  v_mfma_f32_16x16x32_bf16 v[64:67], v[172:175], v[184:187], v[64:67]
  ds_read_b64 v[146:147], v210 offset:1216
  v_mfma_f32_16x16x32_bf16 v[80:83], v[176:179], v[184:187], v[80:83]
  ds_read_b64 v[148:149], v210 offset:256
  v_mfma_f32_16x16x32_bf16 v[96:99], v[180:183], v[184:187], v[96:99]
  ds_read_b64 v[150:151], v210 offset:1344
  v_mfma_f32_16x16x32_bf16 v[100:103], v[180:183], v[188:191], v[100:103]
  ds_read_b64 v[152:153], v210 offset:384
  v_mfma_f32_16x16x32_bf16 v[84:87], v[176:179], v[188:191], v[84:87]
  ds_read_b64 v[154:155], v210 offset:1472
  v_mfma_f32_16x16x32_bf16 v[68:71], v[172:175], v[188:191], v[68:71]
  ds_read_b128 v[116:119], v204 offset:2048
  v_mfma_f32_16x16x32_bf16 v[52:55], v[168:171], v[188:191], v[52:55]
  ds_read_b128 v[120:123], v204 offset:4096
  v_mfma_f32_16x16x32_bf16 v[36:39], v[164:167], v[188:191], v[36:39]
  ds_read_b128 v[124:127], v204 offset:6144
  v_mfma_f32_16x16x32_bf16 v[20:23], v[160:163], v[188:191], v[20:23]
  ds_read_b128 v[128:131], v204 offset:8192
  v_mfma_f32_16x16x32_bf16 v[4:7], v[156:159], v[188:191], v[4:7]
  ds_read_b128 v[132:135], v204 offset:10240
  v_mfma_f32_16x16x32_bf16 v[8:11], v[156:159], v[192:195], v[8:11]
  ds_read_b128 v[136:139], v204 offset:12288
  v_mfma_f32_16x16x32_bf16 v[24:27], v[160:163], v[192:195], v[24:27]
  v_mfma_f32_16x16x32_bf16 v[40:43], v[164:167], v[192:195], v[40:43]
  v_mfma_f32_16x16x32_bf16 v[56:59], v[168:171], v[192:195], v[56:59]
  v_mfma_f32_16x16x32_bf16 v[72:75], v[172:175], v[192:195], v[72:75]
  v_mfma_f32_16x16x32_bf16 v[88:91], v[176:179], v[192:195], v[88:91]
  v_mfma_f32_16x16x32_bf16 v[104:107], v[180:183], v[192:195], v[104:107]
  v_mfma_f32_16x16x32_bf16 v[108:111], v[180:183], v[196:199], v[108:111]
  v_mfma_f32_16x16x32_bf16 v[92:95], v[176:179], v[196:199], v[92:95]
  v_mfma_f32_16x16x32_bf16 v[76:79], v[172:175], v[196:199], v[76:79]
  v_mfma_f32_16x16x32_bf16 v[60:63], v[168:171], v[196:199], v[60:63]
  v_mfma_f32_16x16x32_bf16 v[44:47], v[164:167], v[196:199], v[44:47]
  v_mfma_f32_16x16x32_bf16 v[28:31], v[160:163], v[196:199], v[28:31]
  v_mfma_f32_16x16x32_bf16 v[12:15], v[156:159], v[196:199], v[12:15]
  s_waitcnt lgkmcnt(0)
  v_mfma_f32_16x16x32_bf16 v[0:3], v[112:115], v[140:143], v[0:3]
  ds_read_b128 v[156:159], v205 offset:0
  v_mfma_f32_16x16x32_bf16 v[16:19], v[116:119], v[140:143], v[16:19]
  ds_read_b64 v[184:185], v210 offset:8704
  v_mfma_f32_16x16x32_bf16 v[32:35], v[120:123], v[140:143], v[32:35]
  ds_read_b64 v[186:187], v210 offset:9792
  v_mfma_f32_16x16x32_bf16 v[48:51], v[124:127], v[140:143], v[48:51]
  ds_read_b64 v[188:189], v210 offset:8832
  v_mfma_f32_16x16x32_bf16 v[64:67], v[128:131], v[140:143], v[64:67]
  ds_read_b64 v[190:191], v210 offset:9920
  v_mfma_f32_16x16x32_bf16 v[80:83], v[132:135], v[140:143], v[80:83]
  ds_read_b64 v[192:193], v210 offset:8960
  v_mfma_f32_16x16x32_bf16 v[96:99], v[136:139], v[140:143], v[96:99]
  ds_read_b64 v[194:195], v210 offset:10048
  v_mfma_f32_16x16x32_bf16 v[100:103], v[136:139], v[144:147], v[100:103]
  ds_read_b64 v[196:197], v210 offset:9088
  v_mfma_f32_16x16x32_bf16 v[84:87], v[132:135], v[144:147], v[84:87]
  ds_read_b64 v[198:199], v210 offset:10176
  v_mfma_f32_16x16x32_bf16 v[68:71], v[128:131], v[144:147], v[68:71]
  ds_read_b128 v[160:163], v205 offset:2048
  v_mfma_f32_16x16x32_bf16 v[52:55], v[124:127], v[144:147], v[52:55]
  ds_read_b128 v[164:167], v205 offset:4096
  v_mfma_f32_16x16x32_bf16 v[36:39], v[120:123], v[144:147], v[36:39]
  ds_read_b128 v[168:171], v205 offset:6144
  v_mfma_f32_16x16x32_bf16 v[20:23], v[116:119], v[144:147], v[20:23]
  ds_read_b128 v[172:175], v205 offset:8192
  v_mfma_f32_16x16x32_bf16 v[4:7], v[112:115], v[144:147], v[4:7]
  ds_read_b128 v[176:179], v205 offset:10240
  v_mfma_f32_16x16x32_bf16 v[8:11], v[112:115], v[148:151], v[8:11]
  ds_read_b128 v[180:183], v205 offset:12288
  v_mfma_f32_16x16x32_bf16 v[24:27], v[116:119], v[148:151], v[24:27]
  v_mfma_f32_16x16x32_bf16 v[40:43], v[120:123], v[148:151], v[40:43]
  v_mfma_f32_16x16x32_bf16 v[56:59], v[124:127], v[148:151], v[56:59]
  v_mfma_f32_16x16x32_bf16 v[72:75], v[128:131], v[148:151], v[72:75]
  v_mfma_f32_16x16x32_bf16 v[88:91], v[132:135], v[148:151], v[88:91]
  v_mfma_f32_16x16x32_bf16 v[104:107], v[136:139], v[148:151], v[104:107]
  v_mfma_f32_16x16x32_bf16 v[108:111], v[136:139], v[152:155], v[108:111]
  v_mfma_f32_16x16x32_bf16 v[92:95], v[132:135], v[152:155], v[92:95]
  v_mfma_f32_16x16x32_bf16 v[76:79], v[128:131], v[152:155], v[76:79]
  v_mfma_f32_16x16x32_bf16 v[60:63], v[124:127], v[152:155], v[60:63]
  v_mfma_f32_16x16x32_bf16 v[44:47], v[120:123], v[152:155], v[44:47]
  v_mfma_f32_16x16x32_bf16 v[28:31], v[116:119], v[152:155], v[28:31]
  v_mfma_f32_16x16x32_bf16 v[12:15], v[112:115], v[152:155], v[12:15]
L_g1_l1:
  s_waitcnt lgkmcnt(0)
  s_barrier
  v_mfma_f32_16x16x32_bf16 v[0:3], v[156:159], v[184:187], v[0:3]
  ds_read_b128 v[112:115], v206 offset:0
  v_mfma_f32_16x16x32_bf16 v[16:19], v[160:163], v[184:187], v[16:19]
  ds_read_b64 v[140:141], v211 offset:0
  v_mfma_f32_16x16x32_bf16 v[32:35], v[164:167], v[184:187], v[32:35]
  ds_read_b64 v[142:143], v211 offset:1088
  v_mfma_f32_16x16x32_bf16 v[48:51], v[168:171], v[184:187], v[48:51]
  ds_read_b64 v[144:145], v211 offset:128
  v_mfma_f32_16x16x32_bf16 v[64:67], v[172:175], v[184:187], v[64:67]
  ds_read_b64 v[146:147], v211 offset:1216
  v_mfma_f32_16x16x32_bf16 v[80:83], v[176:179], v[184:187], v[80:83]
  ds_read_b64 v[148:149], v211 offset:256
  v_mfma_f32_16x16x32_bf16 v[96:99], v[180:183], v[184:187], v[96:99]
  ds_read_b64 v[150:151], v211 offset:1344
  v_mfma_f32_16x16x32_bf16 v[100:103], v[180:183], v[188:191], v[100:103]
  ds_read_b64 v[152:153], v211 offset:384
  v_mfma_f32_16x16x32_bf16 v[84:87], v[176:179], v[188:191], v[84:87]
  ds_read_b64 v[154:155], v211 offset:1472
  v_mfma_f32_16x16x32_bf16 v[68:71], v[172:175], v[188:191], v[68:71]
  ds_read_b128 v[116:119], v206 offset:2048
  v_mfma_f32_16x16x32_bf16 v[52:55], v[168:171], v[188:191], v[52:55]
  ds_read_b128 v[120:123], v206 offset:4096
  v_mfma_f32_16x16x32_bf16 v[36:39], v[164:167], v[188:191], v[36:39]
  ds_read_b128 v[124:127], v206 offset:6144
  v_mfma_f32_16x16x32_bf16 v[20:23], v[160:163], v[188:191], v[20:23]
  ds_read_b128 v[128:131], v206 offset:8192
  v_mfma_f32_16x16x32_bf16 v[4:7], v[156:159], v[188:191], v[4:7]
  ds_read_b128 v[132:135], v206 offset:10240
  v_mfma_f32_16x16x32_bf16 v[8:11], v[156:159], v[192:195], v[8:11]
  ds_read_b128 v[136:139], v206 offset:12288
  v_mfma_f32_16x16x32_bf16 v[24:27], v[160:163], v[192:195], v[24:27]
  v_mfma_f32_16x16x32_bf16 v[40:43], v[164:167], v[192:195], v[40:43]
  v_mfma_f32_16x16x32_bf16 v[56:59], v[168:171], v[192:195], v[56:59]
  v_mfma_f32_16x16x32_bf16 v[72:75], v[172:175], v[192:195], v[72:75]
  v_mfma_f32_16x16x32_bf16 v[88:91], v[176:179], v[192:195], v[88:91]
  v_mfma_f32_16x16x32_bf16 v[104:107], v[180:183], v[192:195], v[104:107]
  v_mfma_f32_16x16x32_bf16 v[108:111], v[180:183], v[196:199], v[108:111]
  v_mfma_f32_16x16x32_bf16 v[92:95], v[176:179], v[196:199], v[92:95]
  v_mfma_f32_16x16x32_bf16 v[76:79], v[172:175], v[196:199], v[76:79]
  v_mfma_f32_16x16x32_bf16 v[60:63], v[168:171], v[196:199], v[60:63]
  v_mfma_f32_16x16x32_bf16 v[44:47], v[164:167], v[196:199], v[44:47]
  v_mfma_f32_16x16x32_bf16 v[28:31], v[160:163], v[196:199], v[28:31]
  v_mfma_f32_16x16x32_bf16 v[12:15], v[156:159], v[196:199], v[12:15]
  s_waitcnt lgkmcnt(0)
  v_mfma_f32_16x16x32_bf16 v[0:3], v[112:115], v[140:143], v[0:3]
  ds_read_b128 v[156:159], v207 offset:0
  v_mfma_f32_16x16x32_bf16 v[16:19], v[116:119], v[140:143], v[16:19]
  ds_read_b64 v[184:185], v211 offset:8704
  v_mfma_f32_16x16x32_bf16 v[32:35], v[120:123], v[140:143], v[32:35]
  ds_read_b64 v[186:187], v211 offset:9792
  v_mfma_f32_16x16x32_bf16 v[48:51], v[124:127], v[140:143], v[48:51]
  ds_read_b64 v[188:189], v211 offset:8832
  v_mfma_f32_16x16x32_bf16 v[64:67], v[128:131], v[140:143], v[64:67]
  ds_read_b64 v[190:191], v211 offset:9920
  v_mfma_f32_16x16x32_bf16 v[80:83], v[132:135], v[140:143], v[80:83]
  ds_read_b64 v[192:193], v211 offset:8960
  v_mfma_f32_16x16x32_bf16 v[96:99], v[136:139], v[140:143], v[96:99]
  ds_read_b64 v[194:195], v211 offset:10048
  v_mfma_f32_16x16x32_bf16 v[100:103], v[136:139], v[144:147], v[100:103]
  ds_read_b64 v[196:197], v211 offset:9088
  v_mfma_f32_16x16x32_bf16 v[84:87], v[132:135], v[144:147], v[84:87]
  ds_read_b64 v[198:199], v211 offset:10176
  v_mfma_f32_16x16x32_bf16 v[68:71], v[128:131], v[144:147], v[68:71]
  ds_read_b128 v[160:163], v207 offset:2048
  v_mfma_f32_16x16x32_bf16 v[52:55], v[124:127], v[144:147], v[52:55]
  ds_read_b128 v[164:167], v207 offset:4096
  v_mfma_f32_16x16x32_bf16 v[36:39], v[120:123], v[144:147], v[36:39]
  ds_read_b128 v[168:171], v207 offset:6144
  v_mfma_f32_16x16x32_bf16 v[20:23], v[116:119], v[144:147], v[20:23]
  ds_read_b128 v[172:175], v207 offset:8192
  v_mfma_f32_16x16x32_bf16 v[4:7], v[112:115], v[144:147], v[4:7]
  ds_read_b128 v[176:179], v207 offset:10240
  v_mfma_f32_16x16x32_bf16 v[8:11], v[112:115], v[148:151], v[8:11]
  ds_read_b128 v[180:183], v207 offset:12288
  v_mfma_f32_16x16x32_bf16 v[24:27], v[116:119], v[148:151], v[24:27]
  v_mfma_f32_16x16x32_bf16 v[40:43], v[120:123], v[148:151], v[40:43]
  v_mfma_f32_16x16x32_bf16 v[56:59], v[124:127], v[148:151], v[56:59]
  v_mfma_f32_16x16x32_bf16 v[72:75], v[128:131], v[148:151], v[72:75]
  v_mfma_f32_16x16x32_bf16 v[88:91], v[132:135], v[148:151], v[88:91]
  v_mfma_f32_16x16x32_bf16 v[104:107], v[136:139], v[148:151], v[104:107]
  v_mfma_f32_16x16x32_bf16 v[108:111], v[136:139], v[152:155], v[108:111]
  v_mfma_f32_16x16x32_bf16 v[92:95], v[132:135], v[152:155], v[92:95]
  v_mfma_f32_16x16x32_bf16 v[76:79], v[128:131], v[152:155], v[76:79]
  v_mfma_f32_16x16x32_bf16 v[60:63], v[124:127], v[152:155], v[60:63]
  v_mfma_f32_16x16x32_bf16 v[44:47], v[120:123], v[152:155], v[44:47]
  v_mfma_f32_16x16x32_bf16 v[28:31], v[116:119], v[152:155], v[28:31]
  v_mfma_f32_16x16x32_bf16 v[12:15], v[112:115], v[152:155], v[12:15]
  s_waitcnt lgkmcnt(0)
  s_barrier
  v_mfma_f32_16x16x32_bf16 v[0:3], v[156:159], v[184:187], v[0:3]
  ds_read_b128 v[112:115], v208 offset:0
  v_mfma_f32_16x16x32_bf16 v[16:19], v[160:163], v[184:187], v[16:19]
  ds_read_b64 v[140:141], v212 offset:0
  v_mfma_f32_16x16x32_bf16 v[32:35], v[164:167], v[184:187], v[32:35]
  ds_read_b64 v[142:143], v212 offset:1088
  v_mfma_f32_16x16x32_bf16 v[48:51], v[168:171], v[184:187], v[48:51]
  ds_read_b64 v[144:145], v212 offset:128
  v_mfma_f32_16x16x32_bf16 v[64:67], v[172:175], v[184:187], v[64:67]
  ds_read_b64 v[146:147], v212 offset:1216
  v_mfma_f32_16x16x32_bf16 v[80:83], v[176:179], v[184:187], v[80:83]
  ds_read_b64 v[148:149], v212 offset:256
  v_mfma_f32_16x16x32_bf16 v[96:99], v[180:183], v[184:187], v[96:99]
  ds_read_b64 v[150:151], v212 offset:1344
  v_mfma_f32_16x16x32_bf16 v[100:103], v[180:183], v[188:191], v[100:103]
  ds_read_b64 v[152:153], v212 offset:384
  v_mfma_f32_16x16x32_bf16 v[84:87], v[176:179], v[188:191], v[84:87]
  ds_read_b64 v[154:155], v212 offset:1472
  v_mfma_f32_16x16x32_bf16 v[68:71], v[172:175], v[188:191], v[68:71]
  ds_read_b128 v[116:119], v208 offset:2048
  v_mfma_f32_16x16x32_bf16 v[52:55], v[168:171], v[188:191], v[52:55]
  ds_read_b128 v[120:123], v208 offset:4096
  v_mfma_f32_16x16x32_bf16 v[36:39], v[164:167], v[188:191], v[36:39]
  ds_read_b128 v[124:127], v208 offset:6144
  v_mfma_f32_16x16x32_bf16 v[20:23], v[160:163], v[188:191], v[20:23]
  ds_read_b128 v[128:131], v208 offset:8192
  v_mfma_f32_16x16x32_bf16 v[4:7], v[156:159], v[188:191], v[4:7]
  ds_read_b128 v[132:135], v208 offset:10240
  v_mfma_f32_16x16x32_bf16 v[8:11], v[156:159], v[192:195], v[8:11]
  ds_read_b128 v[136:139], v208 offset:12288
  v_mfma_f32_16x16x32_bf16 v[24:27], v[160:163], v[192:195], v[24:27]
  v_mfma_f32_16x16x32_bf16 v[40:43], v[164:167], v[192:195], v[40:43]
  v_mfma_f32_16x16x32_bf16 v[56:59], v[168:171], v[192:195], v[56:59]
  v_mfma_f32_16x16x32_bf16 v[72:75], v[172:175], v[192:195], v[72:75]
  v_mfma_f32_16x16x32_bf16 v[88:91], v[176:179], v[192:195], v[88:91]
  v_mfma_f32_16x16x32_bf16 v[104:107], v[180:183], v[192:195], v[104:107]
  v_mfma_f32_16x16x32_bf16 v[108:111], v[180:183], v[196:199], v[108:111]
  v_mfma_f32_16x16x32_bf16 v[92:95], v[176:179], v[196:199], v[92:95]
  v_mfma_f32_16x16x32_bf16 v[76:79], v[172:175], v[196:199], v[76:79]
  v_mfma_f32_16x16x32_bf16 v[60:63], v[168:171], v[196:199], v[60:63]
  v_mfma_f32_16x16x32_bf16 v[44:47], v[164:167], v[196:199], v[44:47]
  v_mfma_f32_16x16x32_bf16 v[28:31], v[160:163], v[196:199], v[28:31]
  v_mfma_f32_16x16x32_bf16 v[12:15], v[156:159], v[196:199], v[12:15]
  s_waitcnt lgkmcnt(0)
  v_mfma_f32_16x16x32_bf16 v[0:3], v[112:115], v[140:143], v[0:3]
  ds_read_b128 v[156:159], v209 offset:0
  v_mfma_f32_16x16x32_bf16 v[16:19], v[116:119], v[140:143], v[16:19]
  ds_read_b64 v[184:185], v212 offset:8704
  v_mfma_f32_16x16x32_bf16 v[32:35], v[120:123], v[140:143], v[32:35]
  ds_read_b64 v[186:187], v212 offset:9792
  v_mfma_f32_16x16x32_bf16 v[48:51], v[124:127], v[140:143], v[48:51]
  ds_read_b64 v[188:189], v212 offset:8832
  v_mfma_f32_16x16x32_bf16 v[64:67], v[128:131], v[140:143], v[64:67]
  ds_read_b64 v[190:191], v212 offset:9920
  v_mfma_f32_16x16x32_bf16 v[80:83], v[132:135], v[140:143], v[80:83]
  ds_read_b64 v[192:193], v212 offset:8960
  v_mfma_f32_16x16x32_bf16 v[96:99], v[136:139], v[140:143], v[96:99]
  ds_read_b64 v[194:195], v212 offset:10048
  v_mfma_f32_16x16x32_bf16 v[100:103], v[136:139], v[144:147], v[100:103]
  ds_read_b64 v[196:197], v212 offset:9088
  v_mfma_f32_16x16x32_bf16 v[84:87], v[132:135], v[144:147], v[84:87]
  ds_read_b64 v[198:199], v212 offset:10176
  v_mfma_f32_16x16x32_bf16 v[68:71], v[128:131], v[144:147], v[68:71]
  ds_read_b128 v[160:163], v209 offset:2048
  v_mfma_f32_16x16x32_bf16 v[52:55], v[124:127], v[144:147], v[52:55]
  ds_read_b128 v[164:167], v209 offset:4096
  v_mfma_f32_16x16x32_bf16 v[36:39], v[120:123], v[144:147], v[36:39]
  ds_read_b128 v[168:171], v209 offset:6144
  v_mfma_f32_16x16x32_bf16 v[20:23], v[116:119], v[144:147], v[20:23]
  ds_read_b128 v[172:175], v209 offset:8192
  v_mfma_f32_16x16x32_bf16 v[4:7], v[112:115], v[144:147], v[4:7]
  ds_read_b128 v[176:179], v209 offset:10240
  v_mfma_f32_16x16x32_bf16 v[8:11], v[112:115], v[148:151], v[8:11]
  ds_read_b128 v[180:183], v209 offset:12288
  v_mfma_f32_16x16x32_bf16 v[24:27], v[116:119], v[148:151], v[24:27]
  v_mfma_f32_16x16x32_bf16 v[40:43], v[120:123], v[148:151], v[40:43]
  v_mfma_f32_16x16x32_bf16 v[56:59], v[124:127], v[148:151], v[56:59]
  v_mfma_f32_16x16x32_bf16 v[72:75], v[128:131], v[148:151], v[72:75]
  v_mfma_f32_16x16x32_bf16 v[88:91], v[132:135], v[148:151], v[88:91]
  v_mfma_f32_16x16x32_bf16 v[104:107], v[136:139], v[148:151], v[104:107]
  v_mfma_f32_16x16x32_bf16 v[108:111], v[136:139], v[152:155], v[108:111]
  v_mfma_f32_16x16x32_bf16 v[92:95], v[132:135], v[152:155], v[92:95]
  v_mfma_f32_16x16x32_bf16 v[76:79], v[128:131], v[152:155], v[76:79]
  v_mfma_f32_16x16x32_bf16 v[60:63], v[124:127], v[152:155], v[60:63]
  v_mfma_f32_16x16x32_bf16 v[44:47], v[120:123], v[152:155], v[44:47]
  v_mfma_f32_16x16x32_bf16 v[28:31], v[116:119], v[152:155], v[28:31]
  v_mfma_f32_16x16x32_bf16 v[12:15], v[112:115], v[152:155], v[12:15]
  s_sub_u32 s31, s31, 1
  s_cmp_lg_u32 s31, 0
  s_cbranch_scc1 L_g1_l0
  s_waitcnt lgkmcnt(0)
  s_barrier
  v_mfma_f32_16x16x32_bf16 v[0:3], v[156:159], v[184:187], v[0:3]
  ds_read_b128 v[112:115], v204 offset:0
  v_mfma_f32_16x16x32_bf16 v[16:19], v[160:163], v[184:187], v[16:19]
  ds_read_b64 v[140:141], v210 offset:0
  v_mfma_f32_16x16x32_bf16 v[32:35], v[164:167], v[184:187], v[32:35]
  ds_read_b64 v[142:143], v210 offset:1088
  v_mfma_f32_16x16x32_bf16 v[48:51], v[168:171], v[184:187], v[48:51]
  ds_read_b64 v[144:145], v210 offset:128
  v_mfma_f32_16x16x32_bf16 v[64:67], v[172:175], v[184:187], v[64:67]
  ds_read_b64 v[146:147], v210 offset:1216
  v_mfma_f32_16x16x32_bf16 v[80:83], v[176:179], v[184:187], v[80:83]
  ds_read_b64 v[148:149], v210 offset:256
  v_mfma_f32_16x16x32_bf16 v[96:99], v[180:183], v[184:187], v[96:99]
  ds_read_b64 v[150:151], v210 offset:1344
  v_mfma_f32_16x16x32_bf16 v[100:103], v[180:183], v[188:191], v[100:103]
  ds_read_b64 v[152:153], v210 offset:384
  v_mfma_f32_16x16x32_bf16 v[84:87], v[176:179], v[188:191], v[84:87]
  ds_read_b64 v[154:155], v210 offset:1472
  v_mfma_f32_16x16x32_bf16 v[68:71], v[172:175], v[188:191], v[68:71]
  ds_read_b128 v[116:119], v204 offset:2048
  v_mfma_f32_16x16x32_bf16 v[52:55], v[168:171], v[188:191], v[52:55]
  ds_read_b128 v[120:123], v204 offset:4096
  v_mfma_f32_16x16x32_bf16 v[36:39], v[164:167], v[188:191], v[36:39]
  ds_read_b128 v[124:127], v204 offset:6144
  v_mfma_f32_16x16x32_bf16 v[20:23], v[160:163], v[188:191], v[20:23]
  ds_read_b128 v[128:131], v204 offset:8192
  v_mfma_f32_16x16x32_bf16 v[4:7], v[156:159], v[188:191], v[4:7]
  ds_read_b128 v[132:135], v204 offset:10240
  v_mfma_f32_16x16x32_bf16 v[8:11], v[156:159], v[192:195], v[8:11]
  ds_read_b128 v[136:139], v204 offset:12288
  v_mfma_f32_16x16x32_bf16 v[24:27], v[160:163], v[192:195], v[24:27]
  v_mfma_f32_16x16x32_bf16 v[40:43], v[164:167], v[192:195], v[40:43]
  v_mfma_f32_16x16x32_bf16 v[56:59], v[168:171], v[192:195], v[56:59]
  v_mfma_f32_16x16x32_bf16 v[72:75], v[172:175], v[192:195], v[72:75]
  v_mfma_f32_16x16x32_bf16 v[88:91], v[176:179], v[192:195], v[88:91]
  v_mfma_f32_16x16x32_bf16 v[104:107], v[180:183], v[192:195], v[104:107]
  v_mfma_f32_16x16x32_bf16 v[108:111], v[180:183], v[196:199], v[108:111]
  v_mfma_f32_16x16x32_bf16 v[92:95], v[176:179], v[196:199], v[92:95]
  v_mfma_f32_16x16x32_bf16 v[76:79], v[172:175], v[196:199], v[76:79]
  v_mfma_f32_16x16x32_bf16 v[60:63], v[168:171], v[196:199], v[60:63]
  v_mfma_f32_16x16x32_bf16 v[44:47], v[164:167], v[196:199], v[44:47]
  v_mfma_f32_16x16x32_bf16 v[28:31], v[160:163], v[196:199], v[28:31]
  v_mfma_f32_16x16x32_bf16 v[12:15], v[156:159], v[196:199], v[12:15]
  s_waitcnt lgkmcnt(0)
  v_mfma_f32_16x16x32_bf16 v[0:3], v[112:115], v[140:143], v[0:3]
  ds_read_b128 v[156:159], v205 offset:0
  v_mfma_f32_16x16x32_bf16 v[16:19], v[116:119], v[140:143], v[16:19]
  ds_read_b64 v[184:185], v210 offset:8704
  v_mfma_f32_16x16x32_bf16 v[32:35], v[120:123], v[140:143], v[32:35]
  ds_read_b64 v[186:187], v210 offset:9792
  v_mfma_f32_16x16x32_bf16 v[48:51], v[124:127], v[140:143], v[48:51]
  ds_read_b64 v[188:189], v210 offset:8832
  v_mfma_f32_16x16x32_bf16 v[64:67], v[128:131], v[140:143], v[64:67]
  ds_read_b64 v[190:191], v210 offset:9920
  v_mfma_f32_16x16x32_bf16 v[80:83], v[132:135], v[140:143], v[80:83]
  ds_read_b64 v[192:193], v210 offset:8960
  v_mfma_f32_16x16x32_bf16 v[96:99], v[136:139], v[140:143], v[96:99]
  ds_read_b64 v[194:195], v210 offset:10048
  v_mfma_f32_16x16x32_bf16 v[100:103], v[136:139], v[144:147], v[100:103]
  ds_read_b64 v[196:197], v210 offset:9088
  v_mfma_f32_16x16x32_bf16 v[84:87], v[132:135], v[144:147], v[84:87]
  ds_read_b64 v[198:199], v210 offset:10176
  v_mfma_f32_16x16x32_bf16 v[68:71], v[128:131], v[144:147], v[68:71]
  ds_read_b128 v[160:163], v205 offset:2048
  v_mfma_f32_16x16x32_bf16 v[52:55], v[124:127], v[144:147], v[52:55]
  ds_read_b128 v[164:167], v205 offset:4096
  v_mfma_f32_16x16x32_bf16 v[36:39], v[120:123], v[144:147], v[36:39]
  ds_read_b128 v[168:171], v205 offset:6144
  v_mfma_f32_16x16x32_bf16 v[20:23], v[116:119], v[144:147], v[20:23]
  v_mfma_f32_16x16x32_bf16 v[4:7], v[112:115], v[144:147], v[4:7]
  ds_read_b128 v[172:175], v205 offset:8192
  v_mfma_f32_16x16x32_bf16 v[8:11], v[112:115], v[148:151], v[8:11]
  ds_read_b128 v[176:179], v205 offset:10240
  v_mfma_f32_16x16x32_bf16 v[24:27], v[116:119], v[148:151], v[24:27]
  ds_read_b128 v[180:183], v205 offset:12288
  v_mfma_f32_16x16x32_bf16 v[40:43], v[120:123], v[148:151], v[40:43]
  ds_read_b32 v200, v233 offset:0
  v_mfma_f32_16x16x32_bf16 v[56:59], v[124:127], v[148:151], v[56:59]
  ds_read_b32 v201, v233 offset:64
  v_mfma_f32_16x16x32_bf16 v[72:75], v[128:131], v[148:151], v[72:75]
  ds_read_b32 v202, v233 offset:128
  v_mfma_f32_16x16x32_bf16 v[88:91], v[132:135], v[148:151], v[88:91]
  ds_read_b32 v203, v233 offset:192
  v_mfma_f32_16x16x32_bf16 v[104:107], v[136:139], v[148:151], v[104:107]
  ds_read_b64 v[240:241], v237 offset:0
  v_mfma_f32_16x16x32_bf16 v[108:111], v[136:139], v[152:155], v[108:111]
  ds_read_b64 v[242:243], v237 offset:32
  v_mfma_f32_16x16x32_bf16 v[92:95], v[132:135], v[152:155], v[92:95]
  ds_read_b64 v[244:245], v237 offset:64
  v_mfma_f32_16x16x32_bf16 v[76:79], v[128:131], v[152:155], v[76:79]
  ds_read_b64 v[246:247], v237 offset:96
  v_mfma_f32_16x16x32_bf16 v[60:63], v[124:127], v[152:155], v[60:63]
  v_mfma_f32_16x16x32_bf16 v[44:47], v[120:123], v[152:155], v[44:47]
  v_mfma_f32_16x16x32_bf16 v[28:31], v[116:119], v[152:155], v[28:31]
  v_mfma_f32_16x16x32_bf16 v[12:15], v[112:115], v[152:155], v[12:15]
  s_waitcnt lgkmcnt(0)
  s_barrier
  v_mfma_f32_16x16x32_bf16 v[0:3], v[156:159], v[184:187], v[0:3]
  ds_read_b128 v[112:115], v231 offset:0
  v_mfma_f32_16x16x32_bf16 v[16:19], v[160:163], v[184:187], v[16:19]
  v_mfma_f32_16x16x32_bf16 v[32:35], v[164:167], v[184:187], v[32:35]
  ds_read_b128 v[116:119], v231 offset:64
  v_mfma_f32_16x16x32_bf16 v[48:51], v[168:171], v[184:187], v[48:51]
  v_mfma_f32_16x16x32_bf16 v[64:67], v[172:175], v[184:187], v[64:67]
  ds_read_b128 v[120:123], v231 offset:128
  v_mfma_f32_16x16x32_bf16 v[80:83], v[176:179], v[184:187], v[80:83]
  v_mfma_f32_16x16x32_bf16 v[96:99], v[180:183], v[184:187], v[96:99]
  ds_read_b128 v[124:127], v231 offset:192
  v_mfma_f32_16x16x32_bf16 v[100:103], v[180:183], v[188:191], v[100:103]
  v_mfma_f32_16x16x32_bf16 v[84:87], v[176:179], v[188:191], v[84:87]
  v_mfma_f32_16x16x32_bf16 v[68:71], v[172:175], v[188:191], v[68:71]
  ds_read_b128 v[128:131], v231 offset:256
  v_mfma_f32_16x16x32_bf16 v[52:55], v[168:171], v[188:191], v[52:55]
  v_mfma_f32_16x16x32_bf16 v[36:39], v[164:167], v[188:191], v[36:39]
  ds_read_b128 v[132:135], v231 offset:320
  v_mfma_f32_16x16x32_bf16 v[20:23], v[160:163], v[188:191], v[20:23]
  v_mfma_f32_16x16x32_bf16 v[4:7], v[156:159], v[188:191], v[4:7]
  ds_read_b128 v[136:139], v232 offset:384
  v_mfma_f32_16x16x32_bf16 v[8:11], v[156:159], v[192:195], v[8:11]
  v_mfma_f32_16x16x32_bf16 v[24:27], v[160:163], v[192:195], v[24:27]
  v_mfma_f32_16x16x32_bf16 v[40:43], v[164:167], v[192:195], v[40:43]
  v_mfma_f32_16x16x32_bf16 v[56:59], v[168:171], v[192:195], v[56:59]
  v_mfma_f32_16x16x32_bf16 v[72:75], v[172:175], v[192:195], v[72:75]
  v_mfma_f32_16x16x32_bf16 v[88:91], v[176:179], v[192:195], v[88:91]
  v_mfma_f32_16x16x32_bf16 v[104:107], v[180:183], v[192:195], v[104:107]
  v_mfma_f32_16x16x32_bf16 v[108:111], v[180:183], v[196:199], v[108:111]
  v_mfma_f32_16x16x32_bf16 v[92:95], v[176:179], v[196:199], v[92:95]
  v_mfma_f32_16x16x32_bf16 v[76:79], v[172:175], v[196:199], v[76:79]
  v_mfma_f32_16x16x32_bf16 v[60:63], v[168:171], v[196:199], v[60:63]
  v_mfma_f32_16x16x32_bf16 v[44:47], v[164:167], v[196:199], v[44:47]
  v_mfma_f32_16x16x32_bf16 v[28:31], v[160:163], v[196:199], v[28:31]
  v_mfma_f32_16x16x32_bf16 v[12:15], v[156:159], v[196:199], v[12:15]
  s_mov_b32 s36, 0x3eeff558
  s_mov_b32 s37, 0x3eeff558
  s_mov_b32 s38, 0x409d30fc
  s_mov_b32 s39, 0x409d30fc
  s_mov_b32 s31, 400000
L_mlp_kernel_rs_39:
  v_min_u32 v230, v200, v201
  v_min3_u32 v230, v230, v202, v203
  v_cmp_eq_u32 vcc, 0, v230
  s_nop 1
  s_cbranch_vccz L_mlp_kernel_rsok_40
  s_sleep 4
  buffer_load_dword v200, v229, s[44:47], 0 offen offset:0 sc0 sc1
  buffer_load_dword v201, v229, s[44:47], 0 offen offset:64 sc0 sc1
  buffer_load_dword v202, v229, s[44:47], 0 offen offset:128 sc0 sc1
  buffer_load_dword v203, v229, s[44:47], 0 offen offset:192 sc0 sc1
  s_sub_u32 s31, s31, 1
  s_cmp_lg_u32 s31, 0
  s_waitcnt vmcnt(0)
  s_cbranch_scc1 L_mlp_kernel_rs_39
L_mlp_kernel_rsok_40:
  s_waitcnt lgkmcnt(0)
  v_mov_b32 v248, 1
  v_mov_b32 v249, 138240
  s_lshl_b32 s26, s23, 13
  v_add_u32 v250, s26, v235
  v_add_u32 v251, 0x10000, v250
  v_pk_fma_f32 v[0:1], v[0:1], v[200:201], v[112:113] op_sel_hi:[1,0,1]
  v_pk_fma_f32 v[2:3], v[2:3], v[200:201], v[114:115] op_sel_hi:[1,0,1]
  v_pk_fma_f32 v[16:17], v[16:17], v[200:201], v[116:117] op_sel_hi:[1,0,1]
  v_pk_fma_f32 v[18:19], v[18:19], v[200:201], v[118:119] op_sel_hi:[1,0,1]
  v_pk_fma_f32 v[140:141], v[0:1], v[0:1], s[38:39]
  v_pk_fma_f32 v[142:143], v[2:3], v[2:3], s[38:39]
  v_pk_fma_f32 v[144:145], v[16:17], v[16:17], s[38:39]
  v_pk_fma_f32 v[146:147], v[18:19], v[18:19], s[38:39]
  v_pk_mul_f32 v[140:141], v[140:141], v[0:1]
  v_pk_mul_f32 v[142:143], v[142:143], v[2:3]
  v_pk_mul_f32 v[144:145], v[144:145], v[16:17]
  v_pk_mul_f32 v[146:147], v[146:147], v[18:19]
  v_exp_f32 v140, -v140
  v_exp_f32 v141, -v141
  v_exp_f32 v142, -v142
  v_exp_f32 v143, -v143
  v_exp_f32 v144, -v144
  v_exp_f32 v145, -v145
  v_exp_f32 v146, -v146
  v_exp_f32 v147, -v147
  v_pk_fma_f32 v[140:141], v[140:141], s[36:37], s[36:37]
  v_pk_fma_f32 v[142:143], v[142:143], s[36:37], s[36:37]
  v_pk_fma_f32 v[144:145], v[144:145], s[36:37], s[36:37]
  v_pk_fma_f32 v[146:147], v[146:147], s[36:37], s[36:37]
  v_rcp_f32 v140, v140
  v_rcp_f32 v141, v141
  v_rcp_f32 v142, v142
  v_rcp_f32 v143, v143
  v_rcp_f32 v144, v144
  v_rcp_f32 v145, v145
  v_rcp_f32 v146, v146
  v_rcp_f32 v147, v147
  v_pk_mul_f32 v[140:141], v[140:141], v[0:1]
  v_pk_mul_f32 v[142:143], v[142:143], v[2:3]
  v_pk_mul_f32 v[144:145], v[144:145], v[16:17]
  v_pk_mul_f32 v[146:147], v[146:147], v[18:19]
  v_cvt_pk_bf16_f32 v0, v140, v141
  v_cvt_pk_bf16_f32 v1, v142, v143
  v_cvt_pk_bf16_f32 v2, v144, v145
  v_cvt_pk_bf16_f32 v3, v146, v147
  s_mov_b32 s26, 0
  buffer_store_dwordx4 v[0:3], v238, s[12:15], s26 offen sc0 sc1
  ds_write_b128 v250, v[0:3] offset:0
  v_pk_fma_f32 v[4:5], v[4:5], v[200:201], v[112:113] op_sel:[0,1,0] op_sel_hi:[1,1,1]
  v_pk_fma_f32 v[6:7], v[6:7], v[200:201], v[114:115] op_sel:[0,1,0] op_sel_hi:[1,1,1]
  v_pk_fma_f32 v[20:21], v[20:21], v[200:201], v[116:117] op_sel:[0,1,0] op_sel_hi:[1,1,1]
  v_pk_fma_f32 v[22:23], v[22:23], v[200:201], v[118:119] op_sel:[0,1,0] op_sel_hi:[1,1,1]
  v_pk_fma_f32 v[140:141], v[4:5], v[4:5], s[38:39]
  v_pk_fma_f32 v[142:143], v[6:7], v[6:7], s[38:39]
  v_pk_fma_f32 v[144:145], v[20:21], v[20:21], s[38:39]
  v_pk_fma_f32 v[146:147], v[22:23], v[22:23], s[38:39]
  v_pk_mul_f32 v[140:141], v[140:141], v[4:5]
  v_pk_mul_f32 v[142:143], v[142:143], v[6:7]
  v_pk_mul_f32 v[144:145], v[144:145], v[20:21]
  v_pk_mul_f32 v[146:147], v[146:147], v[22:23]
  v_exp_f32 v140, -v140
  v_exp_f32 v141, -v141
  v_exp_f32 v142, -v142
  v_exp_f32 v143, -v143
  v_exp_f32 v144, -v144
  v_exp_f32 v145, -v145
  v_exp_f32 v146, -v146
  v_exp_f32 v147, -v147
  v_pk_fma_f32 v[140:141], v[140:141], s[36:37], s[36:37]
  v_pk_fma_f32 v[142:143], v[142:143], s[36:37], s[36:37]
  v_pk_fma_f32 v[144:145], v[144:145], s[36:37], s[36:37]
  v_pk_fma_f32 v[146:147], v[146:147], s[36:37], s[36:37]
  v_rcp_f32 v140, v140
  v_rcp_f32 v141, v141
  v_rcp_f32 v142, v142
  v_rcp_f32 v143, v143
  v_rcp_f32 v144, v144
  v_rcp_f32 v145, v145
  v_rcp_f32 v146, v146
  v_rcp_f32 v147, v147
  v_pk_mul_f32 v[140:141], v[140:141], v[4:5]
  v_pk_mul_f32 v[142:143], v[142:143], v[6:7]
  v_pk_mul_f32 v[144:145], v[144:145], v[20:21]
  v_pk_mul_f32 v[146:147], v[146:147], v[22:23]
  v_cvt_pk_bf16_f32 v4, v140, v141
  v_cvt_pk_bf16_f32 v5, v142, v143
  v_cvt_pk_bf16_f32 v6, v144, v145
  v_cvt_pk_bf16_f32 v7, v146, v147
  s_mov_b32 s26, 0
  buffer_store_dwordx4 v[4:7], v252, s[12:15], s26 offen sc0 sc1
  ds_write_b128 v250, v[4:7] offset:1024
  v_pk_fma_f32 v[8:9], v[8:9], v[202:203], v[112:113] op_sel_hi:[1,0,1]
  v_pk_fma_f32 v[10:11], v[10:11], v[202:203], v[114:115] op_sel_hi:[1,0,1]
  v_pk_fma_f32 v[24:25], v[24:25], v[202:203], v[116:117] op_sel_hi:[1,0,1]
  v_pk_fma_f32 v[26:27], v[26:27], v[202:203], v[118:119] op_sel_hi:[1,0,1]
  v_pk_fma_f32 v[140:141], v[8:9], v[8:9], s[38:39]
  v_pk_fma_f32 v[142:143], v[10:11], v[10:11], s[38:39]
  v_pk_fma_f32 v[144:145], v[24:25], v[24:25], s[38:39]
  v_pk_fma_f32 v[146:147], v[26:27], v[26:27], s[38:39]
  v_pk_mul_f32 v[140:141], v[140:141], v[8:9]
  v_pk_mul_f32 v[142:143], v[142:143], v[10:11]
  v_pk_mul_f32 v[144:145], v[144:145], v[24:25]
  v_pk_mul_f32 v[146:147], v[146:147], v[26:27]
  v_exp_f32 v140, -v140
  v_exp_f32 v141, -v141
  v_exp_f32 v142, -v142
  v_exp_f32 v143, -v143
  v_exp_f32 v144, -v144
  v_exp_f32 v145, -v145
  v_exp_f32 v146, -v146
  v_exp_f32 v147, -v147
  v_pk_fma_f32 v[140:141], v[140:141], s[36:37], s[36:37]
  v_pk_fma_f32 v[142:143], v[142:143], s[36:37], s[36:37]
  v_pk_fma_f32 v[144:145], v[144:145], s[36:37], s[36:37]
  v_pk_fma_f32 v[146:147], v[146:147], s[36:37], s[36:37]
  v_rcp_f32 v140, v140
  v_rcp_f32 v141, v141
  v_rcp_f32 v142, v142
  v_rcp_f32 v143, v143
  v_rcp_f32 v144, v144
  v_rcp_f32 v145, v145
  v_rcp_f32 v146, v146
  v_rcp_f32 v147, v147
  v_pk_mul_f32 v[140:141], v[140:141], v[8:9]
  v_pk_mul_f32 v[142:143], v[142:143], v[10:11]
  v_pk_mul_f32 v[144:145], v[144:145], v[24:25]
  v_pk_mul_f32 v[146:147], v[146:147], v[26:27]
  v_cvt_pk_bf16_f32 v8, v140, v141
  v_cvt_pk_bf16_f32 v9, v142, v143
  v_cvt_pk_bf16_f32 v10, v144, v145
  v_cvt_pk_bf16_f32 v11, v146, v147
  s_mov_b32 s26, 4096
  buffer_store_dwordx4 v[8:11], v238, s[12:15], s26 offen sc0 sc1
  ds_write_b128 v250, v[8:11] offset:2048
  v_pk_fma_f32 v[12:13], v[12:13], v[202:203], v[112:113] op_sel:[0,1,0] op_sel_hi:[1,1,1]
  v_pk_fma_f32 v[14:15], v[14:15], v[202:203], v[114:115] op_sel:[0,1,0] op_sel_hi:[1,1,1]
  v_pk_fma_f32 v[28:29], v[28:29], v[202:203], v[116:117] op_sel:[0,1,0] op_sel_hi:[1,1,1]
  v_pk_fma_f32 v[30:31], v[30:31], v[202:203], v[118:119] op_sel:[0,1,0] op_sel_hi:[1,1,1]
  v_pk_fma_f32 v[140:141], v[12:13], v[12:13], s[38:39]
  v_pk_fma_f32 v[142:143], v[14:15], v[14:15], s[38:39]
  v_pk_fma_f32 v[144:145], v[28:29], v[28:29], s[38:39]
  v_pk_fma_f32 v[146:147], v[30:31], v[30:31], s[38:39]
  v_pk_mul_f32 v[140:141], v[140:141], v[12:13]
  v_pk_mul_f32 v[142:143], v[142:143], v[14:15]
  v_pk_mul_f32 v[144:145], v[144:145], v[28:29]
  v_pk_mul_f32 v[146:147], v[146:147], v[30:31]
  v_exp_f32 v140, -v140
  v_exp_f32 v141, -v141
  v_exp_f32 v142, -v142
  v_exp_f32 v143, -v143
  v_exp_f32 v144, -v144
  v_exp_f32 v145, -v145
  v_exp_f32 v146, -v146
  v_exp_f32 v147, -v147
  v_pk_fma_f32 v[140:141], v[140:141], s[36:37], s[36:37]
  v_pk_fma_f32 v[142:143], v[142:143], s[36:37], s[36:37]
  v_pk_fma_f32 v[144:145], v[144:145], s[36:37], s[36:37]
  v_pk_fma_f32 v[146:147], v[146:147], s[36:37], s[36:37]
  v_rcp_f32 v140, v140
  v_rcp_f32 v141, v141
  v_rcp_f32 v142, v142
  v_rcp_f32 v143, v143
  v_rcp_f32 v144, v144
  v_rcp_f32 v145, v145
  v_rcp_f32 v146, v146
  v_rcp_f32 v147, v147
  v_pk_mul_f32 v[140:141], v[140:141], v[12:13]
  v_pk_mul_f32 v[142:143], v[142:143], v[14:15]
  v_pk_mul_f32 v[144:145], v[144:145], v[28:29]
  v_pk_mul_f32 v[146:147], v[146:147], v[30:31]
  v_cvt_pk_bf16_f32 v12, v140, v141
  v_cvt_pk_bf16_f32 v13, v142, v143
  v_cvt_pk_bf16_f32 v14, v144, v145
  v_cvt_pk_bf16_f32 v15, v146, v147
  s_mov_b32 s26, 4096
  buffer_store_dwordx4 v[12:15], v252, s[12:15], s26 offen sc0 sc1
  ds_write_b128 v250, v[12:15] offset:3072
  v_pk_fma_f32 v[32:33], v[32:33], v[200:201], v[120:121] op_sel_hi:[1,0,1]
  v_pk_fma_f32 v[34:35], v[34:35], v[200:201], v[122:123] op_sel_hi:[1,0,1]
  v_pk_fma_f32 v[48:49], v[48:49], v[200:201], v[124:125] op_sel_hi:[1,0,1]
  v_pk_fma_f32 v[50:51], v[50:51], v[200:201], v[126:127] op_sel_hi:[1,0,1]
  v_pk_fma_f32 v[140:141], v[32:33], v[32:33], s[38:39]
  v_pk_fma_f32 v[142:143], v[34:35], v[34:35], s[38:39]
  v_pk_fma_f32 v[144:145], v[48:49], v[48:49], s[38:39]
  v_pk_fma_f32 v[146:147], v[50:51], v[50:51], s[38:39]
  v_pk_mul_f32 v[140:141], v[140:141], v[32:33]
  v_pk_mul_f32 v[142:143], v[142:143], v[34:35]
  v_pk_mul_f32 v[144:145], v[144:145], v[48:49]
  v_pk_mul_f32 v[146:147], v[146:147], v[50:51]
  v_exp_f32 v140, -v140
  v_exp_f32 v141, -v141
  v_exp_f32 v142, -v142
  v_exp_f32 v143, -v143
  v_exp_f32 v144, -v144
  v_exp_f32 v145, -v145
  v_exp_f32 v146, -v146
  v_exp_f32 v147, -v147
  v_pk_fma_f32 v[140:141], v[140:141], s[36:37], s[36:37]
  v_pk_fma_f32 v[142:143], v[142:143], s[36:37], s[36:37]
  v_pk_fma_f32 v[144:145], v[144:145], s[36:37], s[36:37]
  v_pk_fma_f32 v[146:147], v[146:147], s[36:37], s[36:37]
  v_rcp_f32 v140, v140
  v_rcp_f32 v141, v141
  v_rcp_f32 v142, v142
  v_rcp_f32 v143, v143
  v_rcp_f32 v144, v144
  v_rcp_f32 v145, v145
  v_rcp_f32 v146, v146
  v_rcp_f32 v147, v147
  v_pk_mul_f32 v[140:141], v[140:141], v[32:33]
  v_pk_mul_f32 v[142:143], v[142:143], v[34:35]
  v_pk_mul_f32 v[144:145], v[144:145], v[48:49]
  v_pk_mul_f32 v[146:147], v[146:147], v[50:51]
  v_cvt_pk_bf16_f32 v32, v140, v141
  v_cvt_pk_bf16_f32 v33, v142, v143
  v_cvt_pk_bf16_f32 v34, v144, v145
  v_cvt_pk_bf16_f32 v35, v146, v147
  s_mov_b32 s26, 16384
  buffer_store_dwordx4 v[32:35], v238, s[12:15], s26 offen sc0 sc1
  ds_write_b128 v250, v[32:35] offset:32768
  v_pk_fma_f32 v[36:37], v[36:37], v[200:201], v[120:121] op_sel:[0,1,0] op_sel_hi:[1,1,1]
  v_pk_fma_f32 v[38:39], v[38:39], v[200:201], v[122:123] op_sel:[0,1,0] op_sel_hi:[1,1,1]
  v_pk_fma_f32 v[52:53], v[52:53], v[200:201], v[124:125] op_sel:[0,1,0] op_sel_hi:[1,1,1]
  v_pk_fma_f32 v[54:55], v[54:55], v[200:201], v[126:127] op_sel:[0,1,0] op_sel_hi:[1,1,1]
  v_pk_fma_f32 v[140:141], v[36:37], v[36:37], s[38:39]
  v_pk_fma_f32 v[142:143], v[38:39], v[38:39], s[38:39]
  v_pk_fma_f32 v[144:145], v[52:53], v[52:53], s[38:39]
  v_pk_fma_f32 v[146:147], v[54:55], v[54:55], s[38:39]
  v_pk_mul_f32 v[140:141], v[140:141], v[36:37]
  v_pk_mul_f32 v[142:143], v[142:143], v[38:39]
  v_pk_mul_f32 v[144:145], v[144:145], v[52:53]
  v_pk_mul_f32 v[146:147], v[146:147], v[54:55]
  v_exp_f32 v140, -v140
  v_exp_f32 v141, -v141
  v_exp_f32 v142, -v142
  v_exp_f32 v143, -v143
  v_exp_f32 v144, -v144
  v_exp_f32 v145, -v145
  v_exp_f32 v146, -v146
  v_exp_f32 v147, -v147
  v_pk_fma_f32 v[140:141], v[140:141], s[36:37], s[36:37]
  v_pk_fma_f32 v[142:143], v[142:143], s[36:37], s[36:37]
  v_pk_fma_f32 v[144:145], v[144:145], s[36:37], s[36:37]
  v_pk_fma_f32 v[146:147], v[146:147], s[36:37], s[36:37]
  v_rcp_f32 v140, v140
  v_rcp_f32 v141, v141
  v_rcp_f32 v142, v142
  v_rcp_f32 v143, v143
  v_rcp_f32 v144, v144
  v_rcp_f32 v145, v145
  v_rcp_f32 v146, v146
  v_rcp_f32 v147, v147
  v_pk_mul_f32 v[140:141], v[140:141], v[36:37]
  v_pk_mul_f32 v[142:143], v[142:143], v[38:39]
  v_pk_mul_f32 v[144:145], v[144:145], v[52:53]
  v_pk_mul_f32 v[146:147], v[146:147], v[54:55]
  v_cvt_pk_bf16_f32 v36, v140, v141
  v_cvt_pk_bf16_f32 v37, v142, v143
  v_cvt_pk_bf16_f32 v38, v144, v145
  v_cvt_pk_bf16_f32 v39, v146, v147
  s_mov_b32 s26, 16384
  buffer_store_dwordx4 v[36:39], v252, s[12:15], s26 offen sc0 sc1
  ds_write_b128 v250, v[36:39] offset:33792
  v_pk_fma_f32 v[40:41], v[40:41], v[202:203], v[120:121] op_sel_hi:[1,0,1]
  v_pk_fma_f32 v[42:43], v[42:43], v[202:203], v[122:123] op_sel_hi:[1,0,1]
  v_pk_fma_f32 v[56:57], v[56:57], v[202:203], v[124:125] op_sel_hi:[1,0,1]
  v_pk_fma_f32 v[58:59], v[58:59], v[202:203], v[126:127] op_sel_hi:[1,0,1]
  v_pk_fma_f32 v[140:141], v[40:41], v[40:41], s[38:39]
  v_pk_fma_f32 v[142:143], v[42:43], v[42:43], s[38:39]
  v_pk_fma_f32 v[144:145], v[56:57], v[56:57], s[38:39]
  v_pk_fma_f32 v[146:147], v[58:59], v[58:59], s[38:39]
  v_pk_mul_f32 v[140:141], v[140:141], v[40:41]
  v_pk_mul_f32 v[142:143], v[142:143], v[42:43]
  v_pk_mul_f32 v[144:145], v[144:145], v[56:57]
  v_pk_mul_f32 v[146:147], v[146:147], v[58:59]
  v_exp_f32 v140, -v140
  v_exp_f32 v141, -v141
  v_exp_f32 v142, -v142
  v_exp_f32 v143, -v143
  v_exp_f32 v144, -v144
  v_exp_f32 v145, -v145
  v_exp_f32 v146, -v146
  v_exp_f32 v147, -v147
  v_pk_fma_f32 v[140:141], v[140:141], s[36:37], s[36:37]
  v_pk_fma_f32 v[142:143], v[142:143], s[36:37], s[36:37]
  v_pk_fma_f32 v[144:145], v[144:145], s[36:37], s[36:37]
  v_pk_fma_f32 v[146:147], v[146:147], s[36:37], s[36:37]
  v_rcp_f32 v140, v140
  v_rcp_f32 v141, v141
  v_rcp_f32 v142, v142
  v_rcp_f32 v143, v143
  v_rcp_f32 v144, v144
  v_rcp_f32 v145, v145
  v_rcp_f32 v146, v146
  v_rcp_f32 v147, v147
  v_pk_mul_f32 v[140:141], v[140:141], v[40:41]
  v_pk_mul_f32 v[142:143], v[142:143], v[42:43]
  v_pk_mul_f32 v[144:145], v[144:145], v[56:57]
  v_pk_mul_f32 v[146:147], v[146:147], v[58:59]
  v_cvt_pk_bf16_f32 v40, v140, v141
  v_cvt_pk_bf16_f32 v41, v142, v143
  v_cvt_pk_bf16_f32 v42, v144, v145
  v_cvt_pk_bf16_f32 v43, v146, v147
  s_mov_b32 s26, 20480
  buffer_store_dwordx4 v[40:43], v238, s[12:15], s26 offen sc0 sc1
  s_waitcnt vmcnt(3)
  s_mov_b64 exec, 1
  ds_add_u32 v249, v248
  s_mov_b64 exec, -1
  ds_write_b128 v250, v[40:43] offset:34816
  v_pk_fma_f32 v[44:45], v[44:45], v[202:203], v[120:121] op_sel:[0,1,0] op_sel_hi:[1,1,1]
  v_pk_fma_f32 v[46:47], v[46:47], v[202:203], v[122:123] op_sel:[0,1,0] op_sel_hi:[1,1,1]
  v_pk_fma_f32 v[60:61], v[60:61], v[202:203], v[124:125] op_sel:[0,1,0] op_sel_hi:[1,1,1]
  v_pk_fma_f32 v[62:63], v[62:63], v[202:203], v[126:127] op_sel:[0,1,0] op_sel_hi:[1,1,1]
  v_pk_fma_f32 v[140:141], v[44:45], v[44:45], s[38:39]
  v_pk_fma_f32 v[142:143], v[46:47], v[46:47], s[38:39]
  v_pk_fma_f32 v[144:145], v[60:61], v[60:61], s[38:39]
  v_pk_fma_f32 v[146:147], v[62:63], v[62:63], s[38:39]
  v_pk_mul_f32 v[140:141], v[140:141], v[44:45]
  v_pk_mul_f32 v[142:143], v[142:143], v[46:47]
  v_pk_mul_f32 v[144:145], v[144:145], v[60:61]
  v_pk_mul_f32 v[146:147], v[146:147], v[62:63]
  v_exp_f32 v140, -v140
  v_exp_f32 v141, -v141
  v_exp_f32 v142, -v142
  v_exp_f32 v143, -v143
  v_exp_f32 v144, -v144
  v_exp_f32 v145, -v145
  v_exp_f32 v146, -v146
  v_exp_f32 v147, -v147
  v_pk_fma_f32 v[140:141], v[140:141], s[36:37], s[36:37]
  v_pk_fma_f32 v[142:143], v[142:143], s[36:37], s[36:37]
  v_pk_fma_f32 v[144:145], v[144:145], s[36:37], s[36:37]
  v_pk_fma_f32 v[146:147], v[146:147], s[36:37], s[36:37]
  v_rcp_f32 v140, v140
  v_rcp_f32 v141, v141
  v_rcp_f32 v142, v142
  v_rcp_f32 v143, v143
  v_rcp_f32 v144, v144
  v_rcp_f32 v145, v145
  v_rcp_f32 v146, v146
  v_rcp_f32 v147, v147
  v_pk_mul_f32 v[140:141], v[140:141], v[44:45]
  v_pk_mul_f32 v[142:143], v[142:143], v[46:47]
  v_pk_mul_f32 v[144:145], v[144:145], v[60:61]
  v_pk_mul_f32 v[146:147], v[146:147], v[62:63]
  v_cvt_pk_bf16_f32 v44, v140, v141
  v_cvt_pk_bf16_f32 v45, v142, v143
  v_cvt_pk_bf16_f32 v46, v144, v145
  v_cvt_pk_bf16_f32 v47, v146, v147
  s_mov_b32 s26, 20480
  buffer_store_dwordx4 v[44:47], v252, s[12:15], s26 offen sc0 sc1
  ds_write_b128 v250, v[44:47] offset:35840
  v_pk_fma_f32 v[64:65], v[64:65], v[200:201], v[128:129] op_sel_hi:[1,0,1]
  v_pk_fma_f32 v[66:67], v[66:67], v[200:201], v[130:131] op_sel_hi:[1,0,1]
  v_pk_fma_f32 v[80:81], v[80:81], v[200:201], v[132:133] op_sel_hi:[1,0,1]
  v_pk_fma_f32 v[82:83], v[82:83], v[200:201], v[134:135] op_sel_hi:[1,0,1]
  v_pk_fma_f32 v[140:141], v[64:65], v[64:65], s[38:39]
  v_pk_fma_f32 v[142:143], v[66:67], v[66:67], s[38:39]
  v_pk_fma_f32 v[144:145], v[80:81], v[80:81], s[38:39]
  v_pk_fma_f32 v[146:147], v[82:83], v[82:83], s[38:39]
  v_pk_mul_f32 v[140:141], v[140:141], v[64:65]
  v_pk_mul_f32 v[142:143], v[142:143], v[66:67]
  v_pk_mul_f32 v[144:145], v[144:145], v[80:81]
  v_pk_mul_f32 v[146:147], v[146:147], v[82:83]
  v_exp_f32 v140, -v140
  v_exp_f32 v141, -v141
  v_exp_f32 v142, -v142
  v_exp_f32 v143, -v143
  v_exp_f32 v144, -v144
  v_exp_f32 v145, -v145
  v_exp_f32 v146, -v146
  v_exp_f32 v147, -v147
  v_pk_fma_f32 v[140:141], v[140:141], s[36:37], s[36:37]
  v_pk_fma_f32 v[142:143], v[142:143], s[36:37], s[36:37]
  v_pk_fma_f32 v[144:145], v[144:145], s[36:37], s[36:37]
  v_pk_fma_f32 v[146:147], v[146:147], s[36:37], s[36:37]
  v_rcp_f32 v140, v140
  v_rcp_f32 v141, v141
  v_rcp_f32 v142, v142
  v_rcp_f32 v143, v143
  v_rcp_f32 v144, v144
  v_rcp_f32 v145, v145
  v_rcp_f32 v146, v146
  v_rcp_f32 v147, v147
  v_pk_mul_f32 v[140:141], v[140:141], v[64:65]
  v_pk_mul_f32 v[142:143], v[142:143], v[66:67]
  v_pk_mul_f32 v[144:145], v[144:145], v[80:81]
  v_pk_mul_f32 v[146:147], v[146:147], v[82:83]
  v_cvt_pk_bf16_f32 v64, v140, v141
  v_cvt_pk_bf16_f32 v65, v142, v143
  v_cvt_pk_bf16_f32 v66, v144, v145
  v_cvt_pk_bf16_f32 v67, v146, v147
  s_mov_b32 s26, 32768
  buffer_store_dwordx4 v[64:67], v238, s[12:15], s26 offen sc0 sc1
  ds_write_b128 v251, v[64:67] offset:0
  v_pk_fma_f32 v[68:69], v[68:69], v[200:201], v[128:129] op_sel:[0,1,0] op_sel_hi:[1,1,1]
  v_pk_fma_f32 v[70:71], v[70:71], v[200:201], v[130:131] op_sel:[0,1,0] op_sel_hi:[1,1,1]
  v_pk_fma_f32 v[84:85], v[84:85], v[200:201], v[132:133] op_sel:[0,1,0] op_sel_hi:[1,1,1]
  v_pk_fma_f32 v[86:87], v[86:87], v[200:201], v[134:135] op_sel:[0,1,0] op_sel_hi:[1,1,1]
  v_pk_fma_f32 v[140:141], v[68:69], v[68:69], s[38:39]
  v_pk_fma_f32 v[142:143], v[70:71], v[70:71], s[38:39]
  v_pk_fma_f32 v[144:145], v[84:85], v[84:85], s[38:39]
  v_pk_fma_f32 v[146:147], v[86:87], v[86:87], s[38:39]
  v_pk_mul_f32 v[140:141], v[140:141], v[68:69]
  v_pk_mul_f32 v[142:143], v[142:143], v[70:71]
  v_pk_mul_f32 v[144:145], v[144:145], v[84:85]
  v_pk_mul_f32 v[146:147], v[146:147], v[86:87]
  v_exp_f32 v140, -v140
  v_exp_f32 v141, -v141
  v_exp_f32 v142, -v142
  v_exp_f32 v143, -v143
  v_exp_f32 v144, -v144
  v_exp_f32 v145, -v145
  v_exp_f32 v146, -v146
  v_exp_f32 v147, -v147
  v_pk_fma_f32 v[140:141], v[140:141], s[36:37], s[36:37]
  v_pk_fma_f32 v[142:143], v[142:143], s[36:37], s[36:37]
  v_pk_fma_f32 v[144:145], v[144:145], s[36:37], s[36:37]
  v_pk_fma_f32 v[146:147], v[146:147], s[36:37], s[36:37]
  v_rcp_f32 v140, v140
  v_rcp_f32 v141, v141
  v_rcp_f32 v142, v142
  v_rcp_f32 v143, v143
  v_rcp_f32 v144, v144
  v_rcp_f32 v145, v145
  v_rcp_f32 v146, v146
  v_rcp_f32 v147, v147
  v_pk_mul_f32 v[140:141], v[140:141], v[68:69]
  v_pk_mul_f32 v[142:143], v[142:143], v[70:71]
  v_pk_mul_f32 v[144:145], v[144:145], v[84:85]
  v_pk_mul_f32 v[146:147], v[146:147], v[86:87]
  v_cvt_pk_bf16_f32 v68, v140, v141
  v_cvt_pk_bf16_f32 v69, v142, v143
  v_cvt_pk_bf16_f32 v70, v144, v145
  v_cvt_pk_bf16_f32 v71, v146, v147
  s_mov_b32 s26, 32768
  buffer_store_dwordx4 v[68:71], v252, s[12:15], s26 offen sc0 sc1
  ds_write_b128 v251, v[68:71] offset:1024
  v_pk_fma_f32 v[72:73], v[72:73], v[202:203], v[128:129] op_sel_hi:[1,0,1]
  v_pk_fma_f32 v[74:75], v[74:75], v[202:203], v[130:131] op_sel_hi:[1,0,1]
  v_pk_fma_f32 v[88:89], v[88:89], v[202:203], v[132:133] op_sel_hi:[1,0,1]
  v_pk_fma_f32 v[90:91], v[90:91], v[202:203], v[134:135] op_sel_hi:[1,0,1]
  v_pk_fma_f32 v[140:141], v[72:73], v[72:73], s[38:39]
  v_pk_fma_f32 v[142:143], v[74:75], v[74:75], s[38:39]
  v_pk_fma_f32 v[144:145], v[88:89], v[88:89], s[38:39]
  v_pk_fma_f32 v[146:147], v[90:91], v[90:91], s[38:39]
  v_pk_mul_f32 v[140:141], v[140:141], v[72:73]
  v_pk_mul_f32 v[142:143], v[142:143], v[74:75]
  v_pk_mul_f32 v[144:145], v[144:145], v[88:89]
  v_pk_mul_f32 v[146:147], v[146:147], v[90:91]
  v_exp_f32 v140, -v140
  v_exp_f32 v141, -v141
  v_exp_f32 v142, -v142
  v_exp_f32 v143, -v143
  v_exp_f32 v144, -v144
  v_exp_f32 v145, -v145
  v_exp_f32 v146, -v146
  v_exp_f32 v147, -v147
  v_pk_fma_f32 v[140:141], v[140:141], s[36:37], s[36:37]
  v_pk_fma_f32 v[142:143], v[142:143], s[36:37], s[36:37]
  v_pk_fma_f32 v[144:145], v[144:145], s[36:37], s[36:37]
  v_pk_fma_f32 v[146:147], v[146:147], s[36:37], s[36:37]
  v_rcp_f32 v140, v140
  v_rcp_f32 v141, v141
  v_rcp_f32 v142, v142
  v_rcp_f32 v143, v143
  v_rcp_f32 v144, v144
  v_rcp_f32 v145, v145
  v_rcp_f32 v146, v146
  v_rcp_f32 v147, v147
  v_pk_mul_f32 v[140:141], v[140:141], v[72:73]
  v_pk_mul_f32 v[142:143], v[142:143], v[74:75]
  v_pk_mul_f32 v[144:145], v[144:145], v[88:89]
  v_pk_mul_f32 v[146:147], v[146:147], v[90:91]
  v_cvt_pk_bf16_f32 v72, v140, v141
  v_cvt_pk_bf16_f32 v73, v142, v143
  v_cvt_pk_bf16_f32 v74, v144, v145
  v_cvt_pk_bf16_f32 v75, v146, v147
  s_mov_b32 s26, 36864
  buffer_store_dwordx4 v[72:75], v238, s[12:15], s26 offen sc0 sc1
  ds_write_b128 v251, v[72:75] offset:2048
  v_pk_fma_f32 v[76:77], v[76:77], v[202:203], v[128:129] op_sel:[0,1,0] op_sel_hi:[1,1,1]
  v_pk_fma_f32 v[78:79], v[78:79], v[202:203], v[130:131] op_sel:[0,1,0] op_sel_hi:[1,1,1]
  v_pk_fma_f32 v[92:93], v[92:93], v[202:203], v[132:133] op_sel:[0,1,0] op_sel_hi:[1,1,1]
  v_pk_fma_f32 v[94:95], v[94:95], v[202:203], v[134:135] op_sel:[0,1,0] op_sel_hi:[1,1,1]
  v_pk_fma_f32 v[140:141], v[76:77], v[76:77], s[38:39]
  v_pk_fma_f32 v[142:143], v[78:79], v[78:79], s[38:39]
  v_pk_fma_f32 v[144:145], v[92:93], v[92:93], s[38:39]
  v_pk_fma_f32 v[146:147], v[94:95], v[94:95], s[38:39]
  v_pk_mul_f32 v[140:141], v[140:141], v[76:77]
  v_pk_mul_f32 v[142:143], v[142:143], v[78:79]
  v_pk_mul_f32 v[144:145], v[144:145], v[92:93]
  v_pk_mul_f32 v[146:147], v[146:147], v[94:95]
  v_exp_f32 v140, -v140
  v_exp_f32 v141, -v141
  v_exp_f32 v142, -v142
  v_exp_f32 v143, -v143
  v_exp_f32 v144, -v144
  v_exp_f32 v145, -v145
  v_exp_f32 v146, -v146
  v_exp_f32 v147, -v147
  v_pk_fma_f32 v[140:141], v[140:141], s[36:37], s[36:37]
  v_pk_fma_f32 v[142:143], v[142:143], s[36:37], s[36:37]
  v_pk_fma_f32 v[144:145], v[144:145], s[36:37], s[36:37]
  v_pk_fma_f32 v[146:147], v[146:147], s[36:37], s[36:37]
  v_rcp_f32 v140, v140
  v_rcp_f32 v141, v141
  v_rcp_f32 v142, v142
  v_rcp_f32 v143, v143
  v_rcp_f32 v144, v144
  v_rcp_f32 v145, v145
  v_rcp_f32 v146, v146
  v_rcp_f32 v147, v147
  v_pk_mul_f32 v[140:141], v[140:141], v[76:77]
  v_pk_mul_f32 v[142:143], v[142:143], v[78:79]
  v_pk_mul_f32 v[144:145], v[144:145], v[92:93]
  v_pk_mul_f32 v[146:147], v[146:147], v[94:95]
  v_cvt_pk_bf16_f32 v76, v140, v141
  v_cvt_pk_bf16_f32 v77, v142, v143
  v_cvt_pk_bf16_f32 v78, v144, v145
  v_cvt_pk_bf16_f32 v79, v146, v147
  s_mov_b32 s26, 36864
  buffer_store_dwordx4 v[76:79], v252, s[12:15], s26 offen sc0 sc1
  ds_write_b128 v251, v[76:79] offset:3072
  v_pk_fma_f32 v[96:97], v[96:97], v[200:201], v[136:137] op_sel_hi:[1,0,1]
  v_pk_fma_f32 v[98:99], v[98:99], v[200:201], v[138:139] op_sel_hi:[1,0,1]
  v_pk_fma_f32 v[100:101], v[100:101], v[200:201], v[136:137] op_sel:[0,1,0] op_sel_hi:[1,1,1]
  v_pk_fma_f32 v[102:103], v[102:103], v[200:201], v[138:139] op_sel:[0,1,0] op_sel_hi:[1,1,1]
  v_pk_fma_f32 v[140:141], v[96:97], v[96:97], s[38:39]
  v_pk_fma_f32 v[142:143], v[98:99], v[98:99], s[38:39]
  v_pk_fma_f32 v[144:145], v[100:101], v[100:101], s[38:39]
  v_pk_fma_f32 v[146:147], v[102:103], v[102:103], s[38:39]
  v_pk_mul_f32 v[140:141], v[140:141], v[96:97]
  v_pk_mul_f32 v[142:143], v[142:143], v[98:99]
  v_pk_mul_f32 v[144:145], v[144:145], v[100:101]
  v_pk_mul_f32 v[146:147], v[146:147], v[102:103]
  v_exp_f32 v140, -v140
  v_exp_f32 v141, -v141
  v_exp_f32 v142, -v142
  v_exp_f32 v143, -v143
  v_exp_f32 v144, -v144
  v_exp_f32 v145, -v145
  v_exp_f32 v146, -v146
  v_exp_f32 v147, -v147
  v_pk_fma_f32 v[140:141], v[140:141], s[36:37], s[36:37]
  v_pk_fma_f32 v[142:143], v[142:143], s[36:37], s[36:37]
  v_pk_fma_f32 v[144:145], v[144:145], s[36:37], s[36:37]
  v_pk_fma_f32 v[146:147], v[146:147], s[36:37], s[36:37]
  v_rcp_f32 v140, v140
  v_rcp_f32 v141, v141
  v_rcp_f32 v142, v142
  v_rcp_f32 v143, v143
  v_rcp_f32 v144, v144
  v_rcp_f32 v145, v145
  v_rcp_f32 v146, v146
  v_rcp_f32 v147, v147
  v_pk_mul_f32 v[140:141], v[140:141], v[96:97]
  v_pk_mul_f32 v[142:143], v[142:143], v[98:99]
  v_pk_mul_f32 v[144:145], v[144:145], v[100:101]
  v_pk_mul_f32 v[146:147], v[146:147], v[102:103]
  v_cvt_pk_bf16_f32 v96, v140, v141
  v_cvt_pk_bf16_f32 v97, v142, v143
  v_cvt_pk_bf16_f32 v98, v144, v145
  v_cvt_pk_bf16_f32 v99, v146, v147
  s_mov_b32 s26, 0
  buffer_store_dwordx4 v[96:99], v239, s[12:15], s26 offen sc0 sc1
  v_pk_fma_f32 v[104:105], v[104:105], v[202:203], v[136:137] op_sel_hi:[1,0,1]
  v_pk_fma_f32 v[106:107], v[106:107], v[202:203], v[138:139] op_sel_hi:[1,0,1]
  v_pk_fma_f32 v[108:109], v[108:109], v[202:203], v[136:137] op_sel:[0,1,0] op_sel_hi:[1,1,1]
  v_pk_fma_f32 v[110:111], v[110:111], v[202:203], v[138:139] op_sel:[0,1,0] op_sel_hi:[1,1,1]
  v_pk_fma_f32 v[140:141], v[104:105], v[104:105], s[38:39]
  v_pk_fma_f32 v[142:143], v[106:107], v[106:107], s[38:39]
  v_pk_fma_f32 v[144:145], v[108:109], v[108:109], s[38:39]
  v_pk_fma_f32 v[146:147], v[110:111], v[110:111], s[38:39]
  v_pk_mul_f32 v[140:141], v[140:141], v[104:105]
  v_pk_mul_f32 v[142:143], v[142:143], v[106:107]
  v_pk_mul_f32 v[144:145], v[144:145], v[108:109]
  v_pk_mul_f32 v[146:147], v[146:147], v[110:111]
  v_exp_f32 v140, -v140
  v_exp_f32 v141, -v141
  v_exp_f32 v142, -v142
  v_exp_f32 v143, -v143
  v_exp_f32 v144, -v144
  v_exp_f32 v145, -v145
  v_exp_f32 v146, -v146
  v_exp_f32 v147, -v147
  v_pk_fma_f32 v[140:141], v[140:141], s[36:37], s[36:37]
  v_pk_fma_f32 v[142:143], v[142:143], s[36:37], s[36:37]
  v_pk_fma_f32 v[144:145], v[144:145], s[36:37], s[36:37]
  v_pk_fma_f32 v[146:147], v[146:147], s[36:37], s[36:37]
  v_rcp_f32 v140, v140
  v_rcp_f32 v141, v141
  v_rcp_f32 v142, v142
  v_rcp_f32 v143, v143
  v_rcp_f32 v144, v144
  v_rcp_f32 v145, v145
  v_rcp_f32 v146, v146
  v_rcp_f32 v147, v147
  v_pk_mul_f32 v[140:141], v[140:141], v[104:105]
  v_pk_mul_f32 v[142:143], v[142:143], v[106:107]
  v_pk_mul_f32 v[144:145], v[144:145], v[108:109]
  v_pk_mul_f32 v[146:147], v[146:147], v[110:111]
  v_cvt_pk_bf16_f32 v104, v140, v141
  v_cvt_pk_bf16_f32 v105, v142, v143
  v_cvt_pk_bf16_f32 v106, v144, v145
  v_cvt_pk_bf16_f32 v107, v146, v147
  s_mov_b32 s26, 4096
  buffer_store_dwordx4 v[104:107], v239, s[12:15], s26 offen sc0 sc1
  s_mov_b32 s30, 131072
  s_waitcnt lgkmcnt(0)
  s_barrier
  ds_read_b64_tr_b16 v[64:65], v214 offset:0
  ds_read_b64_tr_b16 v[66:67], v214 offset:2048
  ds_read_b128 v[80:83], v222 offset:0
  ds_read_b128 v[84:87], v222 offset:1024
  ds_read_b128 v[88:91], v222 offset:2048
  ds_read_b128 v[92:95], v222 offset:3072
  ds_read_b64_tr_b16 v[68:69], v216 offset:0
  ds_read_b64_tr_b16 v[70:71], v216 offset:2048
  ds_read_b64_tr_b16 v[72:73], v218 offset:0
  ds_read_b64_tr_b16 v[74:75], v218 offset:2048
  ds_read_b64_tr_b16 v[76:77], v220 offset:0
  ds_read_b64_tr_b16 v[78:79], v220 offset:2048
  v_lshlrev_b32 v0, 16, v240
  v_and_b32 v1, 0xffff0000, v240
  v_lshlrev_b32 v2, 16, v241
  v_and_b32 v3, 0xffff0000, v241
  v_lshlrev_b32 v16, 16, v242
  v_and_b32 v17, 0xffff0000, v242
  v_lshlrev_b32 v18, 16, v243
  v_and_b32 v19, 0xffff0000, v243
  v_lshlrev_b32 v32, 16, v244
  v_and_b32 v33, 0xffff0000, v244
  v_lshlrev_b32 v34, 16, v245
  v_and_b32 v35, 0xffff0000, v245
  v_lshlrev_b32 v48, 16, v246
  v_and_b32 v49, 0xffff0000, v246
  v_lshlrev_b32 v50, 16, v247
  v_and_b32 v51, 0xffff0000, v247
  s_waitcnt lgkmcnt(0)
  v_mfma_f32_16x16x32_bf16 v[4:7], v[64:67], v[84:87], v[0:3]
  ds_read_b64_tr_b16 v[96:97], v214 offset:8192
  v_mfma_f32_16x16x32_bf16 v[8:11], v[64:67], v[88:91], v[0:3]
  ds_read_b64_tr_b16 v[98:99], v214 offset:10240
  v_mfma_f32_16x16x32_bf16 v[12:15], v[64:67], v[92:95], v[0:3]
  ds_read_b128 v[112:115], v222 offset:8192
  v_mfma_f32_16x16x32_bf16 v[0:3], v[64:67], v[80:83], v[0:3]
  ds_read_b128 v[116:119], v222 offset:9216
  v_mfma_f32_16x16x32_bf16 v[20:23], v[68:71], v[84:87], v[16:19]
  ds_read_b128 v[120:123], v222 offset:10240
  v_mfma_f32_16x16x32_bf16 v[24:27], v[68:71], v[88:91], v[16:19]
  ds_read_b128 v[124:127], v222 offset:11264
  v_mfma_f32_16x16x32_bf16 v[28:31], v[68:71], v[92:95], v[16:19]
  v_mfma_f32_16x16x32_bf16 v[16:19], v[68:71], v[80:83], v[16:19]
  ds_read_b64_tr_b16 v[100:101], v216 offset:8192
  v_mfma_f32_16x16x32_bf16 v[36:39], v[72:75], v[84:87], v[32:35]
  ds_read_b64_tr_b16 v[102:103], v216 offset:10240
  v_mfma_f32_16x16x32_bf16 v[40:43], v[72:75], v[88:91], v[32:35]
  ds_read_b64_tr_b16 v[104:105], v218 offset:8192
  v_mfma_f32_16x16x32_bf16 v[44:47], v[72:75], v[92:95], v[32:35]
  ds_read_b64_tr_b16 v[106:107], v218 offset:10240
  v_mfma_f32_16x16x32_bf16 v[32:35], v[72:75], v[80:83], v[32:35]
  ds_read_b64_tr_b16 v[108:109], v220 offset:8192
  v_mfma_f32_16x16x32_bf16 v[52:55], v[76:79], v[84:87], v[48:51]
  ds_read_b64_tr_b16 v[110:111], v220 offset:10240
  v_mfma_f32_16x16x32_bf16 v[56:59], v[76:79], v[88:91], v[48:51]
  v_mfma_f32_16x16x32_bf16 v[60:63], v[76:79], v[92:95], v[48:51]
  v_mfma_f32_16x16x32_bf16 v[48:51], v[76:79], v[80:83], v[48:51]
  s_mov_b32 s31, 6
  s_branch L_g2_l1
L_g2_l0:
  s_waitcnt lgkmcnt(0)
  s_barrier
  v_mfma_f32_16x16x32_bf16 v[0:3], v[96:99], v[112:115], v[0:3]
  ds_read_b64_tr_b16 v[64:65], v214 offset:0
  v_mfma_f32_16x16x32_bf16 v[16:19], v[100:103], v[112:115], v[16:19]
  ds_read_b64_tr_b16 v[66:67], v214 offset:2048
  v_mfma_f32_16x16x32_bf16 v[32:35], v[104:107], v[112:115], v[32:35]
  ds_read_b128 v[80:83], v222 offset:0
  v_mfma_f32_16x16x32_bf16 v[48:51], v[108:111], v[112:115], v[48:51]
  ds_read_b128 v[84:87], v222 offset:1024
  v_mfma_f32_16x16x32_bf16 v[52:55], v[108:111], v[116:119], v[52:55]
  ds_read_b128 v[88:91], v222 offset:2048
  v_mfma_f32_16x16x32_bf16 v[36:39], v[104:107], v[116:119], v[36:39]
  ds_read_b128 v[92:95], v222 offset:3072
  v_mfma_f32_16x16x32_bf16 v[20:23], v[100:103], v[116:119], v[20:23]
  v_mfma_f32_16x16x32_bf16 v[4:7], v[96:99], v[116:119], v[4:7]
  ds_read_b64_tr_b16 v[68:69], v216 offset:0
  v_mfma_f32_16x16x32_bf16 v[8:11], v[96:99], v[120:123], v[8:11]
  ds_read_b64_tr_b16 v[70:71], v216 offset:2048
  v_mfma_f32_16x16x32_bf16 v[24:27], v[100:103], v[120:123], v[24:27]
  ds_read_b64_tr_b16 v[72:73], v218 offset:0
  v_mfma_f32_16x16x32_bf16 v[40:43], v[104:107], v[120:123], v[40:43]
  ds_read_b64_tr_b16 v[74:75], v218 offset:2048
  v_mfma_f32_16x16x32_bf16 v[56:59], v[108:111], v[120:123], v[56:59]
  ds_read_b64_tr_b16 v[76:77], v220 offset:0
  v_mfma_f32_16x16x32_bf16 v[60:63], v[108:111], v[124:127], v[60:63]
  ds_read_b64_tr_b16 v[78:79], v220 offset:2048
  v_mfma_f32_16x16x32_bf16 v[44:47], v[104:107], v[124:127], v[44:47]
  v_mfma_f32_16x16x32_bf16 v[28:31], v[100:103], v[124:127], v[28:31]
  v_mfma_f32_16x16x32_bf16 v[12:15], v[96:99], v[124:127], v[12:15]
  s_waitcnt lgkmcnt(0)
  v_mfma_f32_16x16x32_bf16 v[0:3], v[64:67], v[80:83], v[0:3]
  ds_read_b64_tr_b16 v[96:97], v214 offset:8192
  v_mfma_f32_16x16x32_bf16 v[16:19], v[68:71], v[80:83], v[16:19]
  ds_read_b64_tr_b16 v[98:99], v214 offset:10240
  v_mfma_f32_16x16x32_bf16 v[32:35], v[72:75], v[80:83], v[32:35]
  ds_read_b128 v[112:115], v222 offset:8192
  v_mfma_f32_16x16x32_bf16 v[48:51], v[76:79], v[80:83], v[48:51]
  ds_read_b128 v[116:119], v222 offset:9216
  v_mfma_f32_16x16x32_bf16 v[52:55], v[76:79], v[84:87], v[52:55]
  ds_read_b128 v[120:123], v222 offset:10240
  v_mfma_f32_16x16x32_bf16 v[36:39], v[72:75], v[84:87], v[36:39]
  ds_read_b128 v[124:127], v222 offset:11264
  v_mfma_f32_16x16x32_bf16 v[20:23], v[68:71], v[84:87], v[20:23]
  v_mfma_f32_16x16x32_bf16 v[4:7], v[64:67], v[84:87], v[4:7]
  ds_read_b64_tr_b16 v[100:101], v216 offset:8192
  v_mfma_f32_16x16x32_bf16 v[8:11], v[64:67], v[88:91], v[8:11]
  ds_read_b64_tr_b16 v[102:103], v216 offset:10240
  v_mfma_f32_16x16x32_bf16 v[24:27], v[68:71], v[88:91], v[24:27]
  ds_read_b64_tr_b16 v[104:105], v218 offset:8192
  v_mfma_f32_16x16x32_bf16 v[40:43], v[72:75], v[88:91], v[40:43]
  ds_read_b64_tr_b16 v[106:107], v218 offset:10240
  v_mfma_f32_16x16x32_bf16 v[56:59], v[76:79], v[88:91], v[56:59]
  ds_read_b64_tr_b16 v[108:109], v220 offset:8192
  v_mfma_f32_16x16x32_bf16 v[60:63], v[76:79], v[92:95], v[60:63]
  ds_read_b64_tr_b16 v[110:111], v220 offset:10240
  v_mfma_f32_16x16x32_bf16 v[44:47], v[72:75], v[92:95], v[44:47]
  v_mfma_f32_16x16x32_bf16 v[28:31], v[68:71], v[92:95], v[28:31]
  v_mfma_f32_16x16x32_bf16 v[12:15], v[64:67], v[92:95], v[12:15]
L_g2_l1:
  s_waitcnt vmcnt(6)
  s_waitcnt lgkmcnt(0)
  s_barrier
  v_mfma_f32_16x16x32_bf16 v[0:3], v[96:99], v[112:115], v[0:3]
  ds_read_b64_tr_b16 v[64:65], v214 offset:32768
  v_mfma_f32_16x16x32_bf16 v[16:19], v[100:103], v[112:115], v[16:19]
  ds_read_b64_tr_b16 v[66:67], v214 offset:34816
  v_mfma_f32_16x16x32_bf16 v[32:35], v[104:107], v[112:115], v[32:35]
  ds_read_b128 v[80:83], v222 offset:32768
  v_mfma_f32_16x16x32_bf16 v[48:51], v[108:111], v[112:115], v[48:51]
  ds_read_b128 v[84:87], v222 offset:33792
  v_mfma_f32_16x16x32_bf16 v[52:55], v[108:111], v[116:119], v[52:55]
  ds_read_b128 v[88:91], v222 offset:34816
  v_mfma_f32_16x16x32_bf16 v[36:39], v[104:107], v[116:119], v[36:39]
  ds_read_b128 v[92:95], v222 offset:35840
  v_mfma_f32_16x16x32_bf16 v[20:23], v[100:103], v[116:119], v[20:23]
  v_mfma_f32_16x16x32_bf16 v[4:7], v[96:99], v[116:119], v[4:7]
  ds_read_b64_tr_b16 v[68:69], v216 offset:32768
  v_mfma_f32_16x16x32_bf16 v[8:11], v[96:99], v[120:123], v[8:11]
  ds_read_b64_tr_b16 v[70:71], v216 offset:34816
  v_mfma_f32_16x16x32_bf16 v[24:27], v[100:103], v[120:123], v[24:27]
  ds_read_b64_tr_b16 v[72:73], v218 offset:32768
  v_mfma_f32_16x16x32_bf16 v[40:43], v[104:107], v[120:123], v[40:43]
  ds_read_b64_tr_b16 v[74:75], v218 offset:34816
  v_mfma_f32_16x16x32_bf16 v[56:59], v[108:111], v[120:123], v[56:59]
  ds_read_b64_tr_b16 v[76:77], v220 offset:32768
  v_mfma_f32_16x16x32_bf16 v[60:63], v[108:111], v[124:127], v[60:63]
  ds_read_b64_tr_b16 v[78:79], v220 offset:34816
  v_mfma_f32_16x16x32_bf16 v[44:47], v[104:107], v[124:127], v[44:47]
  v_mfma_f32_16x16x32_bf16 v[28:31], v[100:103], v[124:127], v[28:31]
  v_mfma_f32_16x16x32_bf16 v[12:15], v[96:99], v[124:127], v[12:15]
  s_waitcnt lgkmcnt(0)
  v_mfma_f32_16x16x32_bf16 v[0:3], v[64:67], v[80:83], v[0:3]
  ds_read_b64_tr_b16 v[96:97], v214 offset:40960
  v_mfma_f32_16x16x32_bf16 v[16:19], v[68:71], v[80:83], v[16:19]
  ds_read_b64_tr_b16 v[98:99], v214 offset:43008
  v_mfma_f32_16x16x32_bf16 v[32:35], v[72:75], v[80:83], v[32:35]
  ds_read_b128 v[112:115], v222 offset:40960
  v_mfma_f32_16x16x32_bf16 v[48:51], v[76:79], v[80:83], v[48:51]
  ds_read_b128 v[116:119], v222 offset:41984
  v_mfma_f32_16x16x32_bf16 v[52:55], v[76:79], v[84:87], v[52:55]
  ds_read_b128 v[120:123], v222 offset:43008
  v_mfma_f32_16x16x32_bf16 v[36:39], v[72:75], v[84:87], v[36:39]
  ds_read_b128 v[124:127], v222 offset:44032
  v_mfma_f32_16x16x32_bf16 v[20:23], v[68:71], v[84:87], v[20:23]
  v_mfma_f32_16x16x32_bf16 v[4:7], v[64:67], v[84:87], v[4:7]
  ds_read_b64_tr_b16 v[100:101], v216 offset:40960
  v_mfma_f32_16x16x32_bf16 v[8:11], v[64:67], v[88:91], v[8:11]
  ds_read_b64_tr_b16 v[102:103], v216 offset:43008
  v_mfma_f32_16x16x32_bf16 v[24:27], v[68:71], v[88:91], v[24:27]
  ds_read_b64_tr_b16 v[104:105], v218 offset:40960
  v_mfma_f32_16x16x32_bf16 v[40:43], v[72:75], v[88:91], v[40:43]
  ds_read_b64_tr_b16 v[106:107], v218 offset:43008
  v_mfma_f32_16x16x32_bf16 v[56:59], v[76:79], v[88:91], v[56:59]
  ds_read_b64_tr_b16 v[108:109], v220 offset:40960
  v_mfma_f32_16x16x32_bf16 v[60:63], v[76:79], v[92:95], v[60:63]
  ds_read_b64_tr_b16 v[110:111], v220 offset:43008
  v_mfma_f32_16x16x32_bf16 v[44:47], v[72:75], v[92:95], v[44:47]
  v_mfma_f32_16x16x32_bf16 v[28:31], v[68:71], v[92:95], v[28:31]
  v_mfma_f32_16x16x32_bf16 v[12:15], v[64:67], v[92:95], v[12:15]
  s_waitcnt lgkmcnt(0)
  s_barrier
  v_mfma_f32_16x16x32_bf16 v[0:3], v[96:99], v[112:115], v[0:3]
  ds_read_b64_tr_b16 v[64:65], v215 offset:0
  v_mfma_f32_16x16x32_bf16 v[16:19], v[100:103], v[112:115], v[16:19]
  ds_read_b64_tr_b16 v[66:67], v215 offset:2048
  v_mfma_f32_16x16x32_bf16 v[32:35], v[104:107], v[112:115], v[32:35]
  ds_read_b128 v[80:83], v223 offset:0
  v_mfma_f32_16x16x32_bf16 v[48:51], v[108:111], v[112:115], v[48:51]
  ds_read_b128 v[84:87], v223 offset:1024
  v_mfma_f32_16x16x32_bf16 v[52:55], v[108:111], v[116:119], v[52:55]
  ds_read_b128 v[88:91], v223 offset:2048
  v_mfma_f32_16x16x32_bf16 v[36:39], v[104:107], v[116:119], v[36:39]
  ds_read_b128 v[92:95], v223 offset:3072
  v_mfma_f32_16x16x32_bf16 v[20:23], v[100:103], v[116:119], v[20:23]
  v_mfma_f32_16x16x32_bf16 v[4:7], v[96:99], v[116:119], v[4:7]
  ds_read_b64_tr_b16 v[68:69], v217 offset:0
  v_mfma_f32_16x16x32_bf16 v[8:11], v[96:99], v[120:123], v[8:11]
  ds_read_b64_tr_b16 v[70:71], v217 offset:2048
  v_mfma_f32_16x16x32_bf16 v[24:27], v[100:103], v[120:123], v[24:27]
  ds_read_b64_tr_b16 v[72:73], v219 offset:0
  v_mfma_f32_16x16x32_bf16 v[40:43], v[104:107], v[120:123], v[40:43]
  ds_read_b64_tr_b16 v[74:75], v219 offset:2048
  v_mfma_f32_16x16x32_bf16 v[56:59], v[108:111], v[120:123], v[56:59]
  ds_read_b64_tr_b16 v[76:77], v221 offset:0
  v_mfma_f32_16x16x32_bf16 v[60:63], v[108:111], v[124:127], v[60:63]
  ds_read_b64_tr_b16 v[78:79], v221 offset:2048
  v_mfma_f32_16x16x32_bf16 v[44:47], v[104:107], v[124:127], v[44:47]
  v_mfma_f32_16x16x32_bf16 v[28:31], v[100:103], v[124:127], v[28:31]
  v_mfma_f32_16x16x32_bf16 v[12:15], v[96:99], v[124:127], v[12:15]
  s_waitcnt lgkmcnt(0)
  v_mfma_f32_16x16x32_bf16 v[0:3], v[64:67], v[80:83], v[0:3]
  ds_read_b64_tr_b16 v[96:97], v215 offset:8192
  v_mfma_f32_16x16x32_bf16 v[16:19], v[68:71], v[80:83], v[16:19]
  ds_read_b64_tr_b16 v[98:99], v215 offset:10240
  v_mfma_f32_16x16x32_bf16 v[32:35], v[72:75], v[80:83], v[32:35]
  ds_read_b128 v[112:115], v223 offset:8192
  v_mfma_f32_16x16x32_bf16 v[48:51], v[76:79], v[80:83], v[48:51]
  ds_read_b128 v[116:119], v223 offset:9216
  v_mfma_f32_16x16x32_bf16 v[52:55], v[76:79], v[84:87], v[52:55]
  ds_read_b128 v[120:123], v223 offset:10240
  v_mfma_f32_16x16x32_bf16 v[36:39], v[72:75], v[84:87], v[36:39]
  ds_read_b128 v[124:127], v223 offset:11264
  v_mfma_f32_16x16x32_bf16 v[20:23], v[68:71], v[84:87], v[20:23]
  v_mfma_f32_16x16x32_bf16 v[4:7], v[64:67], v[84:87], v[4:7]
  ds_read_b64_tr_b16 v[100:101], v217 offset:8192
  v_mfma_f32_16x16x32_bf16 v[8:11], v[64:67], v[88:91], v[8:11]
  ds_read_b64_tr_b16 v[102:103], v217 offset:10240
  v_mfma_f32_16x16x32_bf16 v[24:27], v[68:71], v[88:91], v[24:27]
  ds_read_b64_tr_b16 v[104:105], v219 offset:8192
  v_mfma_f32_16x16x32_bf16 v[40:43], v[72:75], v[88:91], v[40:43]
  ds_read_b64_tr_b16 v[106:107], v219 offset:10240
  v_mfma_f32_16x16x32_bf16 v[56:59], v[76:79], v[88:91], v[56:59]
  ds_read_b64_tr_b16 v[108:109], v221 offset:8192
  v_mfma_f32_16x16x32_bf16 v[60:63], v[76:79], v[92:95], v[60:63]
  ds_read_b64_tr_b16 v[110:111], v221 offset:10240
  v_mfma_f32_16x16x32_bf16 v[44:47], v[72:75], v[92:95], v[44:47]
  v_mfma_f32_16x16x32_bf16 v[28:31], v[68:71], v[92:95], v[28:31]
  v_mfma_f32_16x16x32_bf16 v[12:15], v[64:67], v[92:95], v[12:15]
  s_waitcnt vmcnt(0)
  s_waitcnt lgkmcnt(0)
  s_barrier
  v_mfma_f32_16x16x32_bf16 v[0:3], v[96:99], v[112:115], v[0:3]
  ds_read_b64_tr_b16 v[64:65], v215 offset:32768
  v_mfma_f32_16x16x32_bf16 v[16:19], v[100:103], v[112:115], v[16:19]
  ds_read_b64_tr_b16 v[66:67], v215 offset:34816
  v_mfma_f32_16x16x32_bf16 v[32:35], v[104:107], v[112:115], v[32:35]
  ds_read_b128 v[80:83], v223 offset:32768
  v_mfma_f32_16x16x32_bf16 v[48:51], v[108:111], v[112:115], v[48:51]
  ds_read_b128 v[84:87], v223 offset:33792
  v_mfma_f32_16x16x32_bf16 v[52:55], v[108:111], v[116:119], v[52:55]
  ds_read_b128 v[88:91], v223 offset:34816
  v_mfma_f32_16x16x32_bf16 v[36:39], v[104:107], v[116:119], v[36:39]
  ds_read_b128 v[92:95], v223 offset:35840
  v_mfma_f32_16x16x32_bf16 v[20:23], v[100:103], v[116:119], v[20:23]
  v_mfma_f32_16x16x32_bf16 v[4:7], v[96:99], v[116:119], v[4:7]
  ds_read_b64_tr_b16 v[68:69], v217 offset:32768
  v_mfma_f32_16x16x32_bf16 v[8:11], v[96:99], v[120:123], v[8:11]
  ds_read_b64_tr_b16 v[70:71], v217 offset:34816
  v_mfma_f32_16x16x32_bf16 v[24:27], v[100:103], v[120:123], v[24:27]
  ds_read_b64_tr_b16 v[72:73], v219 offset:32768
  v_mfma_f32_16x16x32_bf16 v[40:43], v[104:107], v[120:123], v[40:43]
  ds_read_b64_tr_b16 v[74:75], v219 offset:34816
  v_mfma_f32_16x16x32_bf16 v[56:59], v[108:111], v[120:123], v[56:59]
  ds_read_b64_tr_b16 v[76:77], v221 offset:32768
  v_mfma_f32_16x16x32_bf16 v[60:63], v[108:111], v[124:127], v[60:63]
  ds_read_b64_tr_b16 v[78:79], v221 offset:34816
  v_mfma_f32_16x16x32_bf16 v[44:47], v[104:107], v[124:127], v[44:47]
  v_mfma_f32_16x16x32_bf16 v[28:31], v[100:103], v[124:127], v[28:31]
  v_mfma_f32_16x16x32_bf16 v[12:15], v[96:99], v[124:127], v[12:15]
  s_waitcnt lgkmcnt(0)
  v_mfma_f32_16x16x32_bf16 v[0:3], v[64:67], v[80:83], v[0:3]
  ds_read_b64_tr_b16 v[96:97], v215 offset:40960
  v_mfma_f32_16x16x32_bf16 v[16:19], v[68:71], v[80:83], v[16:19]
  ds_read_b64_tr_b16 v[98:99], v215 offset:43008
  v_mfma_f32_16x16x32_bf16 v[32:35], v[72:75], v[80:83], v[32:35]
  ds_read_b128 v[112:115], v223 offset:40960
  v_mfma_f32_16x16x32_bf16 v[48:51], v[76:79], v[80:83], v[48:51]
  ds_read_b128 v[116:119], v223 offset:41984
  v_mfma_f32_16x16x32_bf16 v[52:55], v[76:79], v[84:87], v[52:55]
  ds_read_b128 v[120:123], v223 offset:43008
  v_mfma_f32_16x16x32_bf16 v[36:39], v[72:75], v[84:87], v[36:39]
  ds_read_b128 v[124:127], v223 offset:44032
  v_mfma_f32_16x16x32_bf16 v[20:23], v[68:71], v[84:87], v[20:23]
  v_mfma_f32_16x16x32_bf16 v[4:7], v[64:67], v[84:87], v[4:7]
  ds_read_b64_tr_b16 v[100:101], v217 offset:40960
  v_mfma_f32_16x16x32_bf16 v[8:11], v[64:67], v[88:91], v[8:11]
  ds_read_b64_tr_b16 v[102:103], v217 offset:43008
  v_mfma_f32_16x16x32_bf16 v[24:27], v[68:71], v[88:91], v[24:27]
  ds_read_b64_tr_b16 v[104:105], v219 offset:40960
  v_mfma_f32_16x16x32_bf16 v[40:43], v[72:75], v[88:91], v[40:43]
  ds_read_b64_tr_b16 v[106:107], v219 offset:43008
  v_mfma_f32_16x16x32_bf16 v[56:59], v[76:79], v[88:91], v[56:59]
  ds_read_b64_tr_b16 v[108:109], v221 offset:40960
  v_mfma_f32_16x16x32_bf16 v[60:63], v[76:79], v[92:95], v[60:63]
  ds_read_b64_tr_b16 v[110:111], v221 offset:43008
  v_mfma_f32_16x16x32_bf16 v[44:47], v[72:75], v[92:95], v[44:47]
  v_mfma_f32_16x16x32_bf16 v[28:31], v[68:71], v[92:95], v[28:31]
  v_mfma_f32_16x16x32_bf16 v[12:15], v[64:67], v[92:95], v[12:15]
  s_sub_u32 s31, s31, 1
  s_cmp_lg_u32 s31, 0
  s_cbranch_scc1 L_g2_l0
  s_waitcnt lgkmcnt(0)
  s_barrier
  v_mfma_f32_16x16x32_bf16 v[0:3], v[96:99], v[112:115], v[0:3]
  ds_read_b64_tr_b16 v[64:65], v214 offset:0
  ds_read_b64_tr_b16 v[66:67], v214 offset:2048
  v_mfma_f32_16x16x32_bf16 v[16:19], v[100:103], v[112:115], v[16:19]
  ds_read_b64 v[80:81], v222 offset:0
  v_mfma_f32_16x16x32_bf16 v[32:35], v[104:107], v[112:115], v[32:35]
  ds_read_b64 v[82:83], v222 offset:1024
  v_mfma_f32_16x16x32_bf16 v[48:51], v[108:111], v[112:115], v[48:51]
  ds_read_b64 v[84:85], v222 offset:8
  v_mfma_f32_16x16x32_bf16 v[52:55], v[108:111], v[116:119], v[52:55]
  ds_read_b64 v[86:87], v222 offset:1032
  v_mfma_f32_16x16x32_bf16 v[36:39], v[104:107], v[116:119], v[36:39]
  ds_read_b64 v[88:89], v222 offset:2048
  v_mfma_f32_16x16x32_bf16 v[20:23], v[100:103], v[116:119], v[20:23]
  ds_read_b64 v[90:91], v222 offset:3072
  v_mfma_f32_16x16x32_bf16 v[4:7], v[96:99], v[116:119], v[4:7]
  ds_read_b64 v[92:93], v222 offset:2056
  ds_read_b64 v[94:95], v222 offset:3080
  v_mfma_f32_16x16x32_bf16 v[8:11], v[96:99], v[120:123], v[8:11]
  ds_read_b64_tr_b16 v[68:69], v216 offset:0
  v_mfma_f32_16x16x32_bf16 v[24:27], v[100:103], v[120:123], v[24:27]
  ds_read_b64_tr_b16 v[70:71], v216 offset:2048
  v_mfma_f32_16x16x32_bf16 v[40:43], v[104:107], v[120:123], v[40:43]
  ds_read_b64_tr_b16 v[72:73], v218 offset:0
  v_mfma_f32_16x16x32_bf16 v[56:59], v[108:111], v[120:123], v[56:59]
  ds_read_b64_tr_b16 v[74:75], v218 offset:2048
  v_mfma_f32_16x16x32_bf16 v[60:63], v[108:111], v[124:127], v[60:63]
  ds_read_b64_tr_b16 v[76:77], v220 offset:0
  v_mfma_f32_16x16x32_bf16 v[44:47], v[104:107], v[124:127], v[44:47]
  ds_read_b64_tr_b16 v[78:79], v220 offset:2048
  v_mfma_f32_16x16x32_bf16 v[28:31], v[100:103], v[124:127], v[28:31]
  v_mfma_f32_16x16x32_bf16 v[12:15], v[96:99], v[124:127], v[12:15]
  s_waitcnt lgkmcnt(0)
  v_mfma_f32_16x16x32_bf16 v[0:3], v[64:67], v[80:83], v[0:3]
  ds_read_b64_tr_b16 v[96:97], v214 offset:8192
  ds_read_b64_tr_b16 v[98:99], v214 offset:10240
  v_mfma_f32_16x16x32_bf16 v[16:19], v[68:71], v[80:83], v[16:19]
  ds_read_b64 v[112:113], v222 offset:8192
  v_mfma_f32_16x16x32_bf16 v[32:35], v[72:75], v[80:83], v[32:35]
  ds_read_b64 v[114:115], v222 offset:9216
  v_mfma_f32_16x16x32_bf16 v[48:51], v[76:79], v[80:83], v[48:51]
  ds_read_b64 v[116:117], v222 offset:8200
  v_mfma_f32_16x16x32_bf16 v[52:55], v[76:79], v[84:87], v[52:55]
  ds_read_b64 v[118:119], v222 offset:9224
  v_mfma_f32_16x16x32_bf16 v[36:39], v[72:75], v[84:87], v[36:39]
  ds_read_b64 v[120:121], v222 offset:10240
  v_mfma_f32_16x16x32_bf16 v[20:23], v[68:71], v[84:87], v[20:23]
  ds_read_b64 v[122:123], v222 offset:11264
  v_mfma_f32_16x16x32_bf16 v[4:7], v[64:67], v[84:87], v[4:7]
  ds_read_b64 v[124:125], v222 offset:10248
  ds_read_b64 v[126:127], v222 offset:11272
  v_mfma_f32_16x16x32_bf16 v[8:11], v[64:67], v[88:91], v[8:11]
  ds_read_b64_tr_b16 v[100:101], v216 offset:8192
  v_mfma_f32_16x16x32_bf16 v[24:27], v[68:71], v[88:91], v[24:27]
  ds_read_b64_tr_b16 v[102:103], v216 offset:10240
  v_mfma_f32_16x16x32_bf16 v[40:43], v[72:75], v[88:91], v[40:43]
  ds_read_b64_tr_b16 v[104:105], v218 offset:8192
  v_mfma_f32_16x16x32_bf16 v[56:59], v[76:79], v[88:91], v[56:59]
  ds_read_b64_tr_b16 v[106:107], v218 offset:10240
  v_mfma_f32_16x16x32_bf16 v[60:63], v[76:79], v[92:95], v[60:63]
  ds_read_b64_tr_b16 v[108:109], v220 offset:8192
  v_mfma_f32_16x16x32_bf16 v[44:47], v[72:75], v[92:95], v[44:47]
  ds_read_b64_tr_b16 v[110:111], v220 offset:10240
  v_mfma_f32_16x16x32_bf16 v[28:31], v[68:71], v[92:95], v[28:31]
  v_mfma_f32_16x16x32_bf16 v[12:15], v[64:67], v[92:95], v[12:15]
  s_waitcnt lgkmcnt(0)
  s_barrier
  v_mfma_f32_16x16x32_bf16 v[0:3], v[96:99], v[112:115], v[0:3]
  ds_read_b64_tr_b16 v[64:65], v214 offset:32768
  ds_read_b64_tr_b16 v[66:67], v214 offset:34816
  v_mfma_f32_16x16x32_bf16 v[16:19], v[100:103], v[112:115], v[16:19]
  ds_read_b64 v[80:81], v222 offset:32768
  v_mfma_f32_16x16x32_bf16 v[32:35], v[104:107], v[112:115], v[32:35]
  ds_read_b64 v[82:83], v222 offset:33792
  v_mfma_f32_16x16x32_bf16 v[48:51], v[108:111], v[112:115], v[48:51]
  ds_read_b64 v[84:85], v222 offset:32776
  v_mfma_f32_16x16x32_bf16 v[52:55], v[108:111], v[116:119], v[52:55]
  ds_read_b64 v[86:87], v222 offset:33800
  v_mfma_f32_16x16x32_bf16 v[36:39], v[104:107], v[116:119], v[36:39]
  ds_read_b64 v[88:89], v222 offset:34816
  v_mfma_f32_16x16x32_bf16 v[20:23], v[100:103], v[116:119], v[20:23]
  ds_read_b64 v[90:91], v222 offset:35840
  v_mfma_f32_16x16x32_bf16 v[4:7], v[96:99], v[116:119], v[4:7]
  ds_read_b64 v[92:93], v222 offset:34824
  ds_read_b64 v[94:95], v222 offset:35848
  v_mfma_f32_16x16x32_bf16 v[8:11], v[96:99], v[120:123], v[8:11]
  ds_read_b64_tr_b16 v[68:69], v216 offset:32768
  v_mfma_f32_16x16x32_bf16 v[24:27], v[100:103], v[120:123], v[24:27]
  ds_read_b64_tr_b16 v[70:71], v216 offset:34816
  v_mfma_f32_16x16x32_bf16 v[40:43], v[104:107], v[120:123], v[40:43]
  ds_read_b64_tr_b16 v[72:73], v218 offset:32768
  v_mfma_f32_16x16x32_bf16 v[56:59], v[108:111], v[120:123], v[56:59]
  ds_read_b64_tr_b16 v[74:75], v218 offset:34816
  v_mfma_f32_16x16x32_bf16 v[60:63], v[108:111], v[124:127], v[60:63]
  ds_read_b64_tr_b16 v[76:77], v220 offset:32768
  v_mfma_f32_16x16x32_bf16 v[44:47], v[104:107], v[124:127], v[44:47]
  ds_read_b64_tr_b16 v[78:79], v220 offset:34816
  v_mfma_f32_16x16x32_bf16 v[28:31], v[100:103], v[124:127], v[28:31]
  v_mfma_f32_16x16x32_bf16 v[12:15], v[96:99], v[124:127], v[12:15]
  s_waitcnt lgkmcnt(0)
  v_mfma_f32_16x16x32_bf16 v[0:3], v[64:67], v[80:83], v[0:3]
  ds_read_b64_tr_b16 v[96:97], v214 offset:40960
  ds_read_b64_tr_b16 v[98:99], v214 offset:43008
  v_mfma_f32_16x16x32_bf16 v[16:19], v[68:71], v[80:83], v[16:19]
  ds_read_b64 v[112:113], v222 offset:40960
  v_mfma_f32_16x16x32_bf16 v[32:35], v[72:75], v[80:83], v[32:35]
  ds_read_b64 v[114:115], v222 offset:41984
  v_mfma_f32_16x16x32_bf16 v[48:51], v[76:79], v[80:83], v[48:51]
  ds_read_b64 v[116:117], v222 offset:40968
  v_mfma_f32_16x16x32_bf16 v[52:55], v[76:79], v[84:87], v[52:55]
  ds_read_b64 v[118:119], v222 offset:41992
  v_mfma_f32_16x16x32_bf16 v[36:39], v[72:75], v[84:87], v[36:39]
  ds_read_b64 v[120:121], v222 offset:43008
  v_mfma_f32_16x16x32_bf16 v[20:23], v[68:71], v[84:87], v[20:23]
  ds_read_b64 v[122:123], v222 offset:44032
  v_mfma_f32_16x16x32_bf16 v[4:7], v[64:67], v[84:87], v[4:7]
  ds_read_b64 v[124:125], v222 offset:43016
  ds_read_b64 v[126:127], v222 offset:44040
  v_mfma_f32_16x16x32_bf16 v[8:11], v[64:67], v[88:91], v[8:11]
  ds_read_b64_tr_b16 v[100:101], v216 offset:40960
  v_mfma_f32_16x16x32_bf16 v[24:27], v[68:71], v[88:91], v[24:27]
  ds_read_b64_tr_b16 v[102:103], v216 offset:43008
  v_mfma_f32_16x16x32_bf16 v[40:43], v[72:75], v[88:91], v[40:43]
  ds_read_b64_tr_b16 v[104:105], v218 offset:40960
  v_mfma_f32_16x16x32_bf16 v[56:59], v[76:79], v[88:91], v[56:59]
  ds_read_b64_tr_b16 v[106:107], v218 offset:43008
  v_mfma_f32_16x16x32_bf16 v[60:63], v[76:79], v[92:95], v[60:63]
  ds_read_b64_tr_b16 v[108:109], v220 offset:40960
  v_mfma_f32_16x16x32_bf16 v[44:47], v[72:75], v[92:95], v[44:47]
  ds_read_b64_tr_b16 v[110:111], v220 offset:43008
  v_mfma_f32_16x16x32_bf16 v[28:31], v[68:71], v[92:95], v[28:31]
  v_mfma_f32_16x16x32_bf16 v[12:15], v[64:67], v[92:95], v[12:15]
  s_waitcnt lgkmcnt(0)
  s_barrier
  v_mfma_f32_16x16x32_bf16 v[0:3], v[96:99], v[112:115], v[0:3]
  ds_read_b64_tr_b16 v[64:65], v215 offset:0
  ds_read_b64_tr_b16 v[66:67], v215 offset:2048
  v_mfma_f32_16x16x32_bf16 v[16:19], v[100:103], v[112:115], v[16:19]
  ds_read_b64 v[80:81], v223 offset:0
  v_mfma_f32_16x16x32_bf16 v[32:35], v[104:107], v[112:115], v[32:35]
  ds_read_b64 v[82:83], v223 offset:1024
  v_mfma_f32_16x16x32_bf16 v[48:51], v[108:111], v[112:115], v[48:51]
  ds_read_b64 v[84:85], v223 offset:8
  v_mfma_f32_16x16x32_bf16 v[52:55], v[108:111], v[116:119], v[52:55]
  ds_read_b64 v[86:87], v223 offset:1032
  v_mfma_f32_16x16x32_bf16 v[36:39], v[104:107], v[116:119], v[36:39]
  ds_read_b64 v[88:89], v223 offset:2048
  v_mfma_f32_16x16x32_bf16 v[20:23], v[100:103], v[116:119], v[20:23]
  ds_read_b64 v[90:91], v223 offset:3072
  v_mfma_f32_16x16x32_bf16 v[4:7], v[96:99], v[116:119], v[4:7]
  ds_read_b64 v[92:93], v223 offset:2056
  ds_read_b64 v[94:95], v223 offset:3080
  v_mfma_f32_16x16x32_bf16 v[8:11], v[96:99], v[120:123], v[8:11]
  ds_read_b64_tr_b16 v[68:69], v217 offset:0
  v_mfma_f32_16x16x32_bf16 v[24:27], v[100:103], v[120:123], v[24:27]
  ds_read_b64_tr_b16 v[70:71], v217 offset:2048
  v_mfma_f32_16x16x32_bf16 v[40:43], v[104:107], v[120:123], v[40:43]
  ds_read_b64_tr_b16 v[72:73], v219 offset:0
  v_mfma_f32_16x16x32_bf16 v[56:59], v[108:111], v[120:123], v[56:59]
  ds_read_b64_tr_b16 v[74:75], v219 offset:2048
  v_mfma_f32_16x16x32_bf16 v[60:63], v[108:111], v[124:127], v[60:63]
  ds_read_b64_tr_b16 v[76:77], v221 offset:0
  v_mfma_f32_16x16x32_bf16 v[44:47], v[104:107], v[124:127], v[44:47]
  ds_read_b64_tr_b16 v[78:79], v221 offset:2048
  v_mfma_f32_16x16x32_bf16 v[28:31], v[100:103], v[124:127], v[28:31]
  v_mfma_f32_16x16x32_bf16 v[12:15], v[96:99], v[124:127], v[12:15]
  s_waitcnt lgkmcnt(0)
  v_mfma_f32_16x16x32_bf16 v[0:3], v[64:67], v[80:83], v[0:3]
  ds_read_b64_tr_b16 v[96:97], v215 offset:8192
  ds_read_b64_tr_b16 v[98:99], v215 offset:10240
  v_mfma_f32_16x16x32_bf16 v[16:19], v[68:71], v[80:83], v[16:19]
  ds_read_b64 v[112:113], v223 offset:8192
  v_mfma_f32_16x16x32_bf16 v[32:35], v[72:75], v[80:83], v[32:35]
  ds_read_b64 v[114:115], v223 offset:9216
  v_mfma_f32_16x16x32_bf16 v[48:51], v[76:79], v[80:83], v[48:51]
  ds_read_b64 v[116:117], v223 offset:8200
  v_mfma_f32_16x16x32_bf16 v[52:55], v[76:79], v[84:87], v[52:55]
  ds_read_b64 v[118:119], v223 offset:9224
  v_mfma_f32_16x16x32_bf16 v[36:39], v[72:75], v[84:87], v[36:39]
  ds_read_b64 v[120:121], v223 offset:10240
  v_mfma_f32_16x16x32_bf16 v[20:23], v[68:71], v[84:87], v[20:23]
  ds_read_b64 v[122:123], v223 offset:11264
  v_mfma_f32_16x16x32_bf16 v[4:7], v[64:67], v[84:87], v[4:7]
  ds_read_b64 v[124:125], v223 offset:10248
  ds_read_b64 v[126:127], v223 offset:11272
  v_mfma_f32_16x16x32_bf16 v[8:11], v[64:67], v[88:91], v[8:11]
  ds_read_b64_tr_b16 v[100:101], v217 offset:8192
  v_mfma_f32_16x16x32_bf16 v[24:27], v[68:71], v[88:91], v[24:27]
  ds_read_b64_tr_b16 v[102:103], v217 offset:10240
  v_mfma_f32_16x16x32_bf16 v[40:43], v[72:75], v[88:91], v[40:43]
  ds_read_b64_tr_b16 v[104:105], v219 offset:8192
  v_mfma_f32_16x16x32_bf16 v[56:59], v[76:79], v[88:91], v[56:59]
  ds_read_b64_tr_b16 v[106:107], v219 offset:10240
  v_mfma_f32_16x16x32_bf16 v[60:63], v[76:79], v[92:95], v[60:63]
  ds_read_b64_tr_b16 v[108:109], v221 offset:8192
  v_mfma_f32_16x16x32_bf16 v[44:47], v[72:75], v[92:95], v[44:47]
  ds_read_b64_tr_b16 v[110:111], v221 offset:10240
  v_mfma_f32_16x16x32_bf16 v[28:31], v[68:71], v[92:95], v[28:31]
  v_mfma_f32_16x16x32_bf16 v[12:15], v[64:67], v[92:95], v[12:15]
  s_waitcnt lgkmcnt(0)
  s_barrier
  v_mfma_f32_16x16x32_bf16 v[0:3], v[96:99], v[112:115], v[0:3]
  ds_read_b64_tr_b16 v[64:65], v215 offset:32768
  ds_read_b64_tr_b16 v[66:67], v215 offset:34816
  v_mfma_f32_16x16x32_bf16 v[16:19], v[100:103], v[112:115], v[16:19]
  ds_read_b64 v[80:81], v223 offset:32768
  ds_read_b64 v[82:83], v223 offset:33792
  v_mfma_f32_16x16x32_bf16 v[32:35], v[104:107], v[112:115], v[32:35]
  ds_read_b64 v[84:85], v223 offset:32776
  ds_read_b64 v[86:87], v223 offset:33800
  v_mfma_f32_16x16x32_bf16 v[48:51], v[108:111], v[112:115], v[48:51]
  ds_read_b64 v[88:89], v223 offset:34816
  ds_read_b64 v[90:91], v223 offset:35840
  v_mfma_f32_16x16x32_bf16 v[52:55], v[108:111], v[116:119], v[52:55]
  ds_read_b64 v[92:93], v223 offset:34824
  ds_read_b64 v[94:95], v223 offset:35848
  v_mfma_f32_16x16x32_bf16 v[36:39], v[104:107], v[116:119], v[36:39]
  ds_read_b64_tr_b16 v[68:69], v217 offset:32768
  ds_read_b64_tr_b16 v[70:71], v217 offset:34816
  v_mfma_f32_16x16x32_bf16 v[20:23], v[100:103], v[116:119], v[20:23]
  ds_read_b64_tr_b16 v[72:73], v219 offset:32768
  ds_read_b64_tr_b16 v[74:75], v219 offset:34816
  v_mfma_f32_16x16x32_bf16 v[4:7], v[96:99], v[116:119], v[4:7]
  ds_read_b64_tr_b16 v[76:77], v221 offset:32768
  ds_read_b64_tr_b16 v[78:79], v221 offset:34816
  v_mfma_f32_16x16x32_bf16 v[8:11], v[96:99], v[120:123], v[8:11]
  ds_read_b64_tr_b16 v[128:129], v215 offset:40960
  ds_read_b64_tr_b16 v[130:131], v215 offset:43008
  v_mfma_f32_16x16x32_bf16 v[24:27], v[100:103], v[120:123], v[24:27]
  ds_read_b64 v[144:145], v223 offset:40960
  ds_read_b64 v[146:147], v223 offset:41984
  v_mfma_f32_16x16x32_bf16 v[40:43], v[104:107], v[120:123], v[40:43]
  ds_read_b64 v[148:149], v223 offset:40968
  ds_read_b64 v[150:151], v223 offset:41992
  v_mfma_f32_16x16x32_bf16 v[56:59], v[108:111], v[120:123], v[56:59]
  ds_read_b64 v[152:153], v223 offset:43008
  ds_read_b64 v[154:155], v223 offset:44032
  v_mfma_f32_16x16x32_bf16 v[60:63], v[108:111], v[124:127], v[60:63]
  ds_read_b64 v[156:157], v223 offset:43016
  ds_read_b64 v[158:159], v223 offset:44040
  v_mfma_f32_16x16x32_bf16 v[44:47], v[104:107], v[124:127], v[44:47]
  ds_read_b64_tr_b16 v[132:133], v217 offset:40960
  ds_read_b64_tr_b16 v[134:135], v217 offset:43008
  v_mfma_f32_16x16x32_bf16 v[28:31], v[100:103], v[124:127], v[28:31]
  ds_read_b64_tr_b16 v[136:137], v219 offset:40960
  ds_read_b64_tr_b16 v[138:139], v219 offset:43008
  v_mfma_f32_16x16x32_bf16 v[12:15], v[96:99], v[124:127], v[12:15]
  ds_read_b64_tr_b16 v[140:141], v221 offset:40960
  ds_read_b64_tr_b16 v[142:143], v221 offset:43008
  s_waitcnt lgkmcnt(0)
  v_mfma_f32_16x16x32_bf16 v[0:3], v[64:67], v[80:83], v[0:3]
  v_mfma_f32_16x16x32_bf16 v[16:19], v[68:71], v[80:83], v[16:19]
  v_mfma_f32_16x16x32_bf16 v[32:35], v[72:75], v[80:83], v[32:35]
  v_mfma_f32_16x16x32_bf16 v[48:51], v[76:79], v[80:83], v[48:51]
  v_mfma_f32_16x16x32_bf16 v[0:3], v[128:131], v[144:147], v[0:3]
  v_mfma_f32_16x16x32_bf16 v[16:19], v[132:135], v[144:147], v[16:19]
  v_mfma_f32_16x16x32_bf16 v[32:35], v[136:139], v[144:147], v[32:35]
  v_mfma_f32_16x16x32_bf16 v[48:51], v[140:143], v[144:147], v[48:51]
  v_mfma_f32_16x16x32_bf16 v[4:7], v[64:67], v[84:87], v[4:7]
  v_mfma_f32_16x16x32_bf16 v[20:23], v[68:71], v[84:87], v[20:23]
  v_mfma_f32_16x16x32_bf16 v[36:39], v[72:75], v[84:87], v[36:39]
  v_mfma_f32_16x16x32_bf16 v[52:55], v[76:79], v[84:87], v[52:55]
  s_nop 0
  v_cvt_pk_bf16_f32 v160, v0, v1
  v_cvt_pk_bf16_f32 v161, v2, v3
  v_mfma_f32_16x16x32_bf16 v[4:7], v[128:131], v[148:151], v[4:7]
  v_cvt_pk_bf16_f32 v162, v16, v17
  v_cvt_pk_bf16_f32 v163, v18, v19
  v_mfma_f32_16x16x32_bf16 v[20:23], v[132:135], v[148:151], v[20:23]
  buffer_store_dwordx4 v[160:163], v236, s[40:43], 0 offen offset:0 sc0 sc1
  v_cvt_pk_bf16_f32 v164, v32, v33
  v_mfma_f32_16x16x32_bf16 v[36:39], v[136:139], v[148:151], v[36:39]
  v_cvt_pk_bf16_f32 v165, v34, v35
  v_cvt_pk_bf16_f32 v166, v48, v49
  v_mfma_f32_16x16x32_bf16 v[52:55], v[140:143], v[148:151], v[52:55]
  v_cvt_pk_bf16_f32 v167, v50, v51
  buffer_store_dwordx4 v[164:167], v236, s[40:43], s30 offen offset:0 sc0 sc1
  v_mfma_f32_16x16x32_bf16 v[8:11], v[64:67], v[88:91], v[8:11]
  v_mfma_f32_16x16x32_bf16 v[24:27], v[68:71], v[88:91], v[24:27]
  v_mfma_f32_16x16x32_bf16 v[40:43], v[72:75], v[88:91], v[40:43]
  v_mfma_f32_16x16x32_bf16 v[56:59], v[76:79], v[88:91], v[56:59]
  v_cvt_pk_bf16_f32 v168, v4, v5
  v_cvt_pk_bf16_f32 v169, v6, v7
  v_mfma_f32_16x16x32_bf16 v[8:11], v[128:131], v[152:155], v[8:11]
  v_cvt_pk_bf16_f32 v170, v20, v21
  v_cvt_pk_bf16_f32 v171, v22, v23
  v_mfma_f32_16x16x32_bf16 v[24:27], v[132:135], v[152:155], v[24:27]
  buffer_store_dwordx4 v[168:171], v236, s[40:43], 0 offen offset:1024 sc0 sc1
  v_cvt_pk_bf16_f32 v172, v36, v37
  v_mfma_f32_16x16x32_bf16 v[40:43], v[136:139], v[152:155], v[40:43]
  v_cvt_pk_bf16_f32 v173, v38, v39
  v_cvt_pk_bf16_f32 v174, v52, v53
  v_mfma_f32_16x16x32_bf16 v[56:59], v[140:143], v[152:155], v[56:59]
  v_cvt_pk_bf16_f32 v175, v54, v55
  buffer_store_dwordx4 v[172:175], v236, s[40:43], s30 offen offset:1024 sc0 sc1
  v_mfma_f32_16x16x32_bf16 v[12:15], v[64:67], v[92:95], v[12:15]
  v_mfma_f32_16x16x32_bf16 v[28:31], v[68:71], v[92:95], v[28:31]
  v_mfma_f32_16x16x32_bf16 v[44:47], v[72:75], v[92:95], v[44:47]
  v_mfma_f32_16x16x32_bf16 v[60:63], v[76:79], v[92:95], v[60:63]
  v_cvt_pk_bf16_f32 v176, v8, v9
  v_cvt_pk_bf16_f32 v177, v10, v11
  v_mfma_f32_16x16x32_bf16 v[12:15], v[128:131], v[156:159], v[12:15]
  v_cvt_pk_bf16_f32 v178, v24, v25
  v_cvt_pk_bf16_f32 v179, v26, v27
  v_mfma_f32_16x16x32_bf16 v[28:31], v[132:135], v[156:159], v[28:31]
  buffer_store_dwordx4 v[176:179], v236, s[40:43], 0 offen offset:2048 sc0 sc1
  v_cvt_pk_bf16_f32 v180, v40, v41
  v_mfma_f32_16x16x32_bf16 v[44:47], v[136:139], v[156:159], v[44:47]
  v_cvt_pk_bf16_f32 v181, v42, v43
  v_cvt_pk_bf16_f32 v182, v56, v57
  v_mfma_f32_16x16x32_bf16 v[60:63], v[140:143], v[156:159], v[60:63]
  v_cvt_pk_bf16_f32 v183, v58, v59
  buffer_store_dwordx4 v[180:183], v236, s[40:43], s30 offen offset:2048 sc0 sc1
  v_cvt_pk_bf16_f32 v184, v12, v13
  v_cvt_pk_bf16_f32 v185, v14, v15
  v_cvt_pk_bf16_f32 v186, v28, v29
  v_cvt_pk_bf16_f32 v187, v30, v31
  buffer_store_dwordx4 v[184:187], v236, s[40:43], 0 offen offset:3072 sc0 sc1
  v_cvt_pk_bf16_f32 v188, v44, v45
  v_cvt_pk_bf16_f32 v189, v46, v47
  v_cvt_pk_bf16_f32 v190, v60, v61
  v_cvt_pk_bf16_f32 v191, v62, v63
  buffer_store_dwordx4 v[188:191], v236, s[40:43], s30 offen offset:3072 sc0 sc1
  s_barrier
  s_waitcnt vmcnt(0)
  s_barrier
  s_endpgm
L_mlp_end:
  s_endpgm
.p2align 8
.type tab_inv,@object
tab_inv:
.long 0x80003b00,0x80003b00,0x80003b00,0x80003b00,0x80003b00,0xb9c83afb,0xba443aed,0xba8e3ad5
.long 0x80003b00,0xba443aed,0xbab53ab5,0xbaed3a44,0x80003b00,0xba8e3ad5,0xbaed3a44,0xbafbb9c8
.long 0x80003b00,0xbb000000,0x8000bb00,0x3b000000,0x80003b00,0xbafbb9c8,0x3a44baed,0x3ad53a8e
.long 0x80003b00,0xbaedba44,0x3ab5bab5,0x3a443aed,0x80003b00,0xbad5ba8e,0x3aedba44,0xb9c83afb
.long 0x80003b00,0x8000bb00,0x80003b00,0x8000bb00,0x80003b00,0x39c8bafb,0xba443aed,0x3a8ebad5
.long 0x80003b00,0x3a44baed,0xbab53ab5,0x3aedba44,0x80003b00,0x3a8ebad5,0xbaed3a44,0x3afb39c8
.long 0x80003b00,0x3b000000,0x8000bb00,0xbb000000,0x80003b00,0x3afb39c8,0x3a44baed,0xbad5ba8e
.long 0x80003b00,0x3aed3a44,0x3ab5bab5,0xba44baed,0x80003b00,0x3ad53a8e,0x3aedba44,0x39c8bafb
.long 0x80003b00,0xbab53ab5,0xbb000000,0xbab5bab5,0x80003b00,0xbad53a8e,0xbaedba44,0xb9c8bafb
.long 0x80003b00,0xbaed3a44,0xbab5bab5,0x3a44baed,0x80003b00,0xbafb39c8,0xba44baed,0x3ad5ba8e
.long 0x80003b00,0xbab5bab5,0x3b000000,0xbab53ab5,0x80003b00,0xba8ebad5,0x3aed3a44,0xbafb39c8
.long 0x80003b00,0xba44baed,0x3ab53ab5,0xbaedba44,0x80003b00,0xb9c8bafb,0x3a443aed,0xba8ebad5
.long 0x80003b00,0x3ab5bab5,0xbb000000,0x3ab53ab5,0x80003b00,0x3ad5ba8e,0xbaedba44,0x39c83afb
.long 0x80003b00,0x3aedba44,0xbab5bab5,0xba443aed,0x80003b00,0x3afbb9c8,0xba44baed,0xbad53a8e
.long 0x80003b00,0x3ab53ab5,0x3b000000,0x3ab5bab5,0x80003b00,0x3a8e3ad5,0x3aed3a44,0x3afbb9c8
.long 0x80003b00,0x3a443aed,0x3ab53ab5,0x3aed3a44,0x80003b00,0x39c83afb,0x3a443aed,0x3a8e3ad5
.long 0x80003b00,0x80003b00,0x80003b00,0x80003b00,0xbab53ab5,0xbad53a8e,0xbaed3a44,0xbafb39c8
.long 0xbb000000,0xbaedba44,0xbab5bab5,0xba44baed,0xbab5bab5,0xb9c8bafb,0x3a44baed,0x3ad5ba8e
.long 0x80003b00,0xbb000000,0x8000bb00,0x3b000000,0xbab53ab5,0xba8ebad5,0x3aedba44,0x39c83afb
.long 0xbb000000,0x3a44baed,0x3ab53ab5,0xbaed3a44,0xbab5bab5,0x3afbb9c8,0xba443aed,0xba8ebad5
.long 0x80003b00,0x8000bb00,0x80003b00,0x8000bb00,0xbab53ab5,0x3ad5ba8e,0xbaed3a44,0x3afbb9c8
.long 0xbb000000,0x3aed3a44,0xbab5bab5,0x3a443aed,0xbab5bab5,0x39c83afb,0x3a44baed,0xbad53a8e
.long 0x80003b00,0x3b000000,0x8000bb00,0xbb000000,0xbab53ab5,0x3a8e3ad5,0x3aedba44,0xb9c8bafb
.long 0xbb000000,0xba443aed,0x3ab53ab5,0x3aedba44,0xbab5bab5,0xbafb39c8,0xba443aed,0x3a8e3ad5
.long 0x8000bb00,0x3ab5bab5,0x3b000000,0x3ab53ab5,0x3ab5bab5,0x3afb39c8,0x3a443aed,0xba8e3ad5
.long 0x3b000000,0x3a443aed,0xbab53ab5,0xbaedba44,0x3ab53ab5,0xba8e3ad5,0xbaedba44,0x39c8bafb
.long 0x8000bb00,0x3ab53ab5,0xbb000000,0x3ab5bab5,0x3ab5bab5,0xb9c83afb,0xba44baed,0x3ad53a8e
.long 0x3b000000,0xbaed3a44,0x3ab5bab5,0xba443aed,0x3ab53ab5,0xbad5ba8e,0x3aed3a44,0xbafbb9c8
.long 0x8000bb00,0xbab53ab5,0x3b000000,0xbab5bab5,0x3ab5bab5,0xbafbb9c8,0x3a443aed,0x3a8ebad5
.long 0x3b000000,0xba44baed,0xbab53ab5,0x3aed3a44,0x3ab53ab5,0x3a8ebad5,0xbaedba44,0xb9c83afb
.long 0x8000bb00,0xbab5bab5,0xbb000000,0xbab53ab5,0x3ab5bab5,0x39c8bafb,0xba44baed,0xbad5ba8e
.long 0x3b000000,0x3aedba44,0x3ab5bab5,0x3a44baed,0x3ab53ab5,0x3ad53a8e,0x3aed3a44,0x3afb39c8
.long 0x80003b00,0x80003b00,0x80003b00,0x80003b00,0xbb000000,0xbafbb9c8,0xbaedba44,0xbad5ba8e
.long 0x8000bb00,0x3a44baed,0x3ab5bab5,0x3aedba44,0x3b000000,0x3ad53a8e,0x3a443aed,0xb9c83afb
.long 0x80003b00,0xbb000000,0x8000bb00,0x3b000000,0xbb000000,0x39c8bafb,0x3aed3a44,0xba8e3ad5
.long 0x8000bb00,0x3aed3a44,0xbab53ab5,0xba44baed,0x3b000000,0xba8e3ad5,0xba44baed,0x3afb39c8
.long 0x80003b00,0x8000bb00,0x80003b00,0x8000bb00,0xbb000000,0x3afb39c8,0xbaedba44,0x3ad53a8e
.long 0x8000bb00,0xba443aed,0x3ab5bab5,0xbaed3a44,0x3b000000,0xbad5ba8e,0x3a443aed,0x39c8bafb
.long 0x80003b00,0x3b000000,0x8000bb00,0xbb000000,0xbb000000,0xb9c83afb,0x3aed3a44,0x3a8ebad5
.long 0x8000bb00,0xbaedba44,0xbab53ab5,0x3a443aed,0x3b000000,0x3a8ebad5,0xba44baed,0xbafbb9c8
.long 0x80003b00,0xbab53ab5,0xbb000000,0xbab5bab5,0xbb000000,0xba8ebad5,0x3a44baed,0x3afbb9c8
.long 0x8000bb00,0x3aedba44,0x3ab53ab5,0xba443aed,0x3b000000,0x39c83afb,0xbaed3a44,0xba8ebad5
.long 0x80003b00,0xbab5bab5,0x3b000000,0xbab53ab5,0xbb000000,0x3ad5ba8e,0xba443aed,0xb9c8bafb
.long 0x8000bb00,0x3a443aed,0xbab5bab5,0x3aed3a44,0x3b000000,0xbafb39c8,0x3aedba44,0xbad53a8e
.long 0x80003b00,0x3ab5bab5,0xbb000000,0x3ab53ab5,0xbb000000,0x3a8e3ad5,0x3a44baed,0xbafb39c8
.long 0x8000bb00,0xbaed3a44,0x3ab53ab5,0x3a44baed,0x3b000000,0xb9c8bafb,0xbaed3a44,0x3a8e3ad5
.long 0x80003b00,0x3ab53ab5,0x3b000000,0x3ab5bab5,0xbb000000,0xbad53a8e,0xba443aed,0x39c83afb
.long 0x8000bb00,0xba44baed,0xbab5bab5,0xbaedba44,0x3b000000,0x3afbb9c8,0x3aedba44,0x3ad5ba8e
.long 0x80003b00,0x80003b00,0x80003b00,0x80003b00,0xbab5bab5,0xba8ebad5,0xba44baed,0xb9c8bafb
.long 0x3b000000,0x3aed3a44,0x3ab53ab5,0x3a443aed,0xbab53ab5,0xbafb39c8,0xbaedba44,0xba8ebad5
.long 0x80003b00,0xbb000000,0x8000bb00,0x3b000000,0xbab5bab5,0x3ad5ba8e,0x3a443aed,0xbafb39c8
.long 0x3b000000,0xba443aed,0xbab5bab5,0x3aedba44,0xbab53ab5,0xb9c8bafb,0x3aed3a44,0xbad53a8e
.long 0x80003b00,0x8000bb00,0x80003b00,0x8000bb00,0xbab5bab5,0x3a8e3ad5,0xba44baed,0x39c83afb
.long 0x3b000000,0xbaedba44,0x3ab53ab5,0xba44baed,0xbab53ab5,0x3afbb9c8,0xbaedba44,0x3a8e3ad5
.long 0x80003b00,0x3b000000,0x8000bb00,0xbb000000,0xbab5bab5,0xbad53a8e,0x3a443aed,0x3afbb9c8
.long 0x3b000000,0x3a44baed,0xbab5bab5,0xbaed3a44,0xbab53ab5,0x39c83afb,0x3aed3a44,0x3ad5ba8e
.long 0x8000bb00,0x3ab5bab5,0x3b000000,0x3ab53ab5,0x3ab53ab5,0xb9c83afb,0xbaed3a44,0xbad5ba8e
.long 0xbb000000,0xba44baed,0x3ab5bab5,0x3aed3a44,0x3ab5bab5,0x3ad53a8e,0xba443aed,0xbafbb9c8
.long 0x8000bb00,0x3ab53ab5,0xbb000000,0x3ab5bab5,0x3ab53ab5,0xbafbb9c8,0x3aedba44,0xba8e3ad5
.long 0xbb000000,0x3aedba44,0xbab53ab5,0x3a44baed,0x3ab5bab5,0xba8e3ad5,0x3a44baed,0xb9c83afb
.long 0x8000bb00,0xbab53ab5,0x3b000000,0xbab5bab5,0x3ab53ab5,0x39c8bafb,0xbaed3a44,0x3ad53a8e
.long 0xbb000000,0x3a443aed,0x3ab5bab5,0xbaedba44,0x3ab5bab5,0xbad5ba8e,0xba443aed,0x3afb39c8
.long 0x8000bb00,0xbab5bab5,0xbb000000,0xbab53ab5,0x3ab53ab5,0x3afb39c8,0x3aedba44,0x3a8ebad5
.long 0xbb000000,0xbaed3a44,0xbab53ab5,0xba443aed,0x3ab5bab5,0x3a8ebad5,0x3a44baed,0x39c8bafb
.long 0x3b000000,0x3b000000,0x3b000000,0x3b000000,0x3b000000,0x3afb39c8,0x3aed3a44,0x3ad53a8e
.long 0x3b000000,0x3aed3a44,0x3ab53ab5,0x3a443aed,0x3b000000,0x3ad53a8e,0x3a443aed,0xb9c83afb
.long 0x3b000000,0x3b00,0xbb000000,0xbb00,0x3b000000,0xb9c83afb,0xbaedba44,0x3a8ebad5
.long 0x3b000000,0xba443aed,0xbab5bab5,0x3aedba44,0x3b000000,0xba8e3ad5,0xba44baed,0x3afb39c8
.long 0x3b000000,0xbb000000,0x3b000000,0xbb000000,0x3b000000,0xbafbb9c8,0x3aed3a44,0xbad5ba8e
.long 0x3b000000,0xbaedba44,0x3ab53ab5,0xba44baed,0x3b000000,0xbad5ba8e,0x3a443aed,0x39c8bafb
.long 0x3b000000,0xbb00,0xbb000000,0x3b00,0x3b000000,0x39c8bafb,0xbaedba44,0xba8e3ad5
.long 0x3b000000,0x3a44baed,0xbab5bab5,0xbaed3a44,0x3b000000,0x3a8ebad5,0xba44baed,0xbafbb9c8
.long 0x3b000000,0x3ab53ab5,0x3b00,0xbab53ab5,0x3b000000,0x3a8e3ad5,0xba443aed,0xbafb39c8
.long 0x3b000000,0x3a443aed,0xbab53ab5,0xbaedba44,0x3b000000,0x39c83afb,0xbaed3a44,0xba8ebad5
.long 0x3b000000,0xbab53ab5,0xbb00,0x3ab53ab5,0x3b000000,0xbad53a8e,0x3a44baed,0x39c83afb
.long 0x3b000000,0xbaed3a44,0x3ab5bab5,0xba443aed,0x3b000000,0xbafb39c8,0x3aedba44,0xbad53a8e
.long 0x3b000000,0xbab5bab5,0x3b00,0x3ab5bab5,0x3b000000,0xba8ebad5,0xba443aed,0x3afbb9c8
.long 0x3b000000,0xba44baed,0xbab53ab5,0x3aed3a44,0x3b000000,0xb9c8bafb,0xbaed3a44,0x3a8e3ad5
.long 0x3b000000,0x3ab5bab5,0xbb00,0xbab5bab5,0x3b000000,0x3ad5ba8e,0x3a44baed,0xb9c8bafb
.long 0x3b000000,0x3aedba44,0x3ab5bab5,0x3a44baed,0x3b000000,0x3afbb9c8,0x3aedba44,0x3ad5ba8e
.long 0x3b000000,0x3b000000,0x3b000000,0x3b000000,0x3ab53ab5,0x3a8e3ad5,0x3a443aed,0x39c83afb
.long 0x3b00,0xba443aed,0xbab53ab5,0xbaed3a44,0xbab53ab5,0xbafb39c8,0xbaedba44,0xba8ebad5
.long 0x3b000000,0x3b00,0xbb000000,0xbb00,0x3ab53ab5,0xbad53a8e,0xba44baed,0x3afbb9c8
.long 0x3b00,0xbaedba44,0x3ab5bab5,0x3a443aed,0xbab53ab5,0xb9c8bafb,0x3aed3a44,0xbad53a8e
.long 0x3b000000,0xbb000000,0x3b000000,0xbb000000,0x3ab53ab5,0xba8ebad5,0x3a443aed,0xb9c8bafb
.long 0x3b00,0x3a44baed,0xbab53ab5,0x3aedba44,0xbab53ab5,0x3afbb9c8,0xbaedba44,0x3a8e3ad5
.long 0x3b000000,0xbb00,0xbb000000,0x3b00,0x3ab53ab5,0x3ad5ba8e,0xba44baed,0xbafb39c8
.long 0x3b00,0x3aed3a44,0x3ab5bab5,0xba44baed,0xbab53ab5,0x39c83afb,0x3aed3a44,0x3ad5ba8e
.long 0xbb000000,0xbab5bab5,0xbb00,0x3ab5bab5,0xbab5bab5,0x39c8bafb,0x3aedba44,0x3ad53a8e
.long 0xbb00,0x3aedba44,0x3ab53ab5,0xba443aed,0x3ab5bab5,0x3ad53a8e,0xba443aed,0xbafbb9c8
.long 0xbb000000,0x3ab5bab5,0x3b00,0xbab5bab5,0xbab5bab5,0x3afb39c8,0xbaed3a44,0x3a8ebad5
.long 0xbb00,0x3a443aed,0xbab5bab5,0x3aed3a44,0x3ab5bab5,0xba8e3ad5,0x3a44baed,0xb9c83afb
.long 0xbb000000,0x3ab53ab5,0xbb00,0xbab53ab5,0xbab5bab5,0xb9c83afb,0x3aedba44,0xbad5ba8e
.long 0xbb00,0xbaed3a44,0x3ab53ab5,0x3a44baed,0x3ab5bab5,0xbad5ba8e,0xba443aed,0x3afb39c8
.long 0xbb000000,0xbab53ab5,0x3b00,0x3ab53ab5,0xbab5bab5,0xbafbb9c8,0xbaed3a44,0xba8e3ad5
.long 0xbb00,0xba44baed,0xbab5bab5,0xbaedba44,0x3ab5bab5,0x3a8ebad5,0x3a44baed,0x39c8bafb
.long 0x3b000000,0x3b000000,0x3b000000,0x3b000000,0x3b00,0xb9c83afb,0xba443aed,0xba8e3ad5
.long 0xbb000000,0xbaedba44,0xbab5bab5,0xba44baed,0xbb00,0x3a8ebad5,0x3aedba44,0x3afb39c8
.long 0x3b000000,0x3b00,0xbb000000,0xbb00,0x3b00,0xbafbb9c8,0x3a44baed,0x3ad53a8e
.long 0xbb000000,0x3a44baed,0x3ab53ab5,0xbaed3a44,0xbb00,0x3ad53a8e,0xbaed3a44,0x39c8bafb
.long 0x3b000000,0xbb000000,0x3b000000,0xbb000000,0x3b00,0x39c8bafb,0xba443aed,0x3a8ebad5
.long 0xbb000000,0x3aed3a44,0xbab5bab5,0x3a443aed,0xbb00,0xba8e3ad5,0x3aedba44,0xbafbb9c8
.long 0x3b000000,0xbb00,0xbb000000,0x3b00,0x3b00,0x3afb39c8,0x3a44baed,0xbad5ba8e
.long 0xbb000000,0xba443aed,0x3ab53ab5,0x3aedba44,0xbb00,0xbad5ba8e,0xbaed3a44,0xb9c83afb
.long 0x3b000000,0x3ab53ab5,0x3b00,0xbab53ab5,0x3b00,0xbad53a8e,0xbaedba44,0xb9c8bafb
.long 0xbb000000,0xba44baed,0x3ab5bab5,0x3aed3a44,0xbb00,0x3afbb9c8,0x3a443aed,0xbad53a8e
.long 0x3b000000,0xbab53ab5,0xbb00,0x3ab53ab5,0x3b00,0xba8ebad5,0x3aed3a44,0xbafb39c8
.long 0xbb000000,0x3aedba44,0xbab53ab5,0x3a44baed,0xbb00,0x39c83afb,0xba44baed,0x3a8e3ad5
.long 0x3b000000,0xbab5bab5,0x3b00,0x3ab5bab5,0x3b00,0x3ad5ba8e,0xbaedba44,0x39c83afb
.long 0xbb000000,0x3a443aed,0x3ab5bab5,0xbaedba44,0xbb00,0xbafb39c8,0x3a443aed,0x3ad5ba8e
.long 0x3b000000,0x3ab5bab5,0xbb00,0xbab5bab5,0x3b00,0x3a8e3ad5,0x3aed3a44,0x3afbb9c8
.long 0xbb000000,0xbaed3a44,0xbab53ab5,0xba443aed,0xbb00,0xb9c8bafb,0xba44baed,0xba8ebad5
.long 0x3b000000,0x3b000000,0x3b000000,0x3b000000,0xbab53ab5,0xbad53a8e,0xbaed3a44,0xbafb39c8
.long 0xbb00,0x3a44baed,0x3ab5bab5,0x3aedba44,0x3ab53ab5,0x39c83afb,0xba443aed,0xbad53a8e
.long 0x3b000000,0x3b00,0xbb000000,0xbb00,0xbab53ab5,0xba8ebad5,0x3aedba44,0x39c83afb
.long 0xbb00,0x3aed3a44,0xbab53ab5,0xba44baed,0x3ab53ab5,0xbafb39c8,0x3a44baed,0x3a8e3ad5
.long 0x3b000000,0xbb000000,0x3b000000,0xbb000000,0xbab53ab5,0x3ad5ba8e,0xbaed3a44,0x3afbb9c8
.long 0xbb00,0xba443aed,0x3ab5bab5,0xbaed3a44,0x3ab53ab5,0xb9c8bafb,0xba443aed,0x3ad5ba8e
.long 0x3b000000,0xbb00,0xbb000000,0x3b00,0xbab53ab5,0x3a8e3ad5,0x3aedba44,0xb9c8bafb
.long 0xbb00,0xbaedba44,0xbab53ab5,0x3a443aed,0x3ab53ab5,0x3afbb9c8,0x3a44baed,0xba8ebad5
.long 0xbb000000,0xbab5bab5,0xbb00,0x3ab5bab5,0x3ab5bab5,0x3afb39c8,0x3a443aed,0xba8e3ad5
.long 0x3b00,0xbaed3a44,0xbab5bab5,0x3a44baed,0xbab5bab5,0x3a8ebad5,0x3aed3a44,0xb9c83afb
.long 0xbb000000,0x3ab5bab5,0x3b00,0xbab5bab5,0x3ab5bab5,0xb9c83afb,0xba44baed,0x3ad53a8e
.long 0x3b00,0xba44baed,0x3ab53ab5,0xbaedba44,0xbab5bab5,0x3ad53a8e,0xbaedba44,0x3afb39c8
.long 0xbb000000,0x3ab53ab5,0xbb00,0xbab53ab5,0x3ab5bab5,0xbafbb9c8,0x3a443aed,0x3a8ebad5
.long 0x3b00,0x3aedba44,0xbab5bab5,0xba443aed,0xbab5bab5,0xba8e3ad5,0x3aed3a44,0x39c8bafb
.long 0xbb000000,0xbab53ab5,0x3b00,0x3ab53ab5,0x3ab5bab5,0x39c8bafb,0xba44baed,0xbad5ba8e
.long 0x3b00,0x3a443aed,0x3ab53ab5,0x3aed3a44,0xbab5bab5,0xbad5ba8e,0xbaedba44,0xbafbb9c8
.long 0x3f800000,0x3f800000,0x3f800000,0x3f800000,0x3f800000,0x3f7ffec4,0x3f7ffb11,0x3f7ff4e6
.long 0x3f800000,0x3f7ffb11,0x3f7fec43,0x3f7fd397,0x3f800000,0x3f7ff4e6,0x3f7fd397,0x3f7f9c18
.long 0x3f800000,0x3f7fb10f,0x3f7ec46d,0x3f7d3aac,0x3f800000,0x3f7f9c18,0x3f7e70b0,0x3f7c7eb0
.long 0x3f800000,0x3f7f84ab,0x3f7e1324,0x3f7baccd,0x3f800000,0x3f7f6ac7,0x3f7dabcc,0x3f7ac516
.long 0x3f800000,0x3f7ec46d,0x3f7b14be,0x3f74fa0b,0x3f800000,0x3f7e9bc9,0x3f7a7302,0x3f73913f
.long 0x3f800000,0x3f7e70b0,0x3f79c79d,0x3f721352,0x3f800000,0x3f7e4323,0x3f791298,0x3f708066
.long 0x3f800000,0x3f7d3aac,0x3f74fa0b,0x3f676bd8,0x3f800000,0x3f7cfe73,0x3f740bdd,0x3f655e0b
.long 0x3f800000,0x3f7cbfc9,0x3f731447,0x3f633c5a,0x3f800000,0x3f7c7eb0,0x3f721352,0x3f6106f2
.long 0x3f800000,0x3f7fec43,0x3f7fb10f,0x3f7f4e6d,0x3f800000,0x3f7fe129,0x3f7f84ab,0x3f7eea9d
.long 0x3f800000,0x3f7fd397,0x3f7f4e6d,0x3f7e70b0,0x3f800000,0x3f7fc38f,0x3f7f0e58,0x3f7de0b1
.long 0x3f800000,0x3f7f4e6d,0x3f7d3aac,0x3f79c79d,0x3f800000,0x3f7f2f9d,0x3f7cbfc9,0x3f78b47b
.long 0x3f800000,0x3f7f0e58,0x3f7c3b28,0x3f778bc5,0x3f800000,0x3f7eea9d,0x3f7baccd,0x3f764d97
.long 0x3f800000,0x3f7e1324,0x3f7853f8,0x3f6ed89e,0x3f800000,0x3f7de0b1,0x3f778bc5,0x3f6d1c1d
.long 0x3f800000,0x3f7dabcc,0x3f76ba07,0x3f6b4b0c,0x3f800000,0x3f7d7474,0x3f75dec6,0x3f696591
.long 0x3f800000,0x3f7c3b28,0x3f710908,0x3f5ebe05,0x3f800000,0x3f7bf531,0x3f6ff573,0x3f5c61c7
.long 0x3f800000,0x3f7baccd,0x3f6ed89e,0x3f59f26a,0x3f800000,0x3f7b61fc,0x3f6db293,0x3f577026
.long 0x3f800000,0x3f800000,0x3f800000,0x3f800000,0x3f7fec43,0x3f7fe129,0x3f7fd397,0x3f7fc38f
.long 0x3f7fb10f,0x3f7f84ab,0x3f7f4e6d,0x3f7f0e58,0x3f7f4e6d,0x3f7eea9d,0x3f7e70b0,0x3f7de0b1
.long 0x3f7b14be,0x3f7853f8,0x3f74fa0b,0x3f710908,0x3f79c79d,0x3f764d97,0x3f721352,0x3f6d1c1d
.long 0x3f7853f8,0x3f740bdd,0x3f6ed89e,0x3f68bf3c,0x3f76ba07,0x3f718f57,0x3f6b4b0c,0x3f63f473
.long 0x3f6c835e,0x3f61c598,0x3f54db31,0x3f45e403,0x3f6a09a7,0x3f5df6be,0x3f4f7a1f,0x3f3ebc1b
.long 0x3f676bd8,0x3f59f26a,0x3f49d112,0x3f373a23,0x3f64aa59,0x3f55b993,0x3f43e200,0x3f2f61a5
.long 0x3f54db31,0x3f3daef9,0x3f226799,0x3f039c3d,0x3f514d3d,0x3f385216,0x3f1b02c6,0x3ef41f07
.long 0x3f4d9f02,0x3f32c8c9,0x3f13682a,0x3ee0924f,0x3f49d112,0x3f2d1469,0x3f0b9a6b,0x3ecc9b8b
.long 0x3f7ec46d,0x3f7e1324,0x3f7d3aac,0x3f7c3b28,0x3f7e1324,0x3f7cfe73,0x3f7baccd,0x3f7a1e84
.long 0x3f7d3aac,0x3f7baccd,0x3f79c79d,0x3f778bc5,0x3f7c3b28,0x3f7a1e84,0x3f778bc5,0x3f748422
.long 0x3f74fa0b,0x3f6ed89e,0x3f676bd8,0x3f5ebe05,0x3f731447,0x3f6be858,0x3f633c5a,0x3f591e6a
.long 0x3f710908,0x3f68bf3c,0x3f5ebe05,0x3f531849,0x3f6ed89e,0x3f655e0b,0x3f59f26a,0x3f4cae79
.long 0x3f61c598,0x3f514d3d,0x3f3daef9,0x3f273656,0x3f5ebe05,0x3f4cae79,0x3f373a23,0x3f1ebc12
.long 0x3f5b941a,0x3f47de65,0x3f3085bb,0x3f15f6d9,0x3f584853,0x3f42de29,0x3f299415,0x3f0cead0
.long 0x3f45e403,0x3f273656,0x3f039c3d,0x3eb8442a,0x3f41d870,0x3f212ff9,0x3ef6e0cb,0x3ea395c5
.long 0x3f3daef9,0x3f1b02c6,0x3ee63375,0x3e8e9a22,0x3f396842,0x3f14b039,0x3ed53641,0x3e72b651
.long 0x3f800000,0x3f800000,0x3f800000,0x3f800000,0x3f7fb10f,0x3f7f9c18,0x3f7f84ab,0x3f7f6ac7
.long 0x3f7ec46d,0x3f7e70b0,0x3f7e1324,0x3f7dabcc,0x3f7d3aac,0x3f7c7eb0,0x3f7baccd,0x3f7ac516
.long 0x3f6c835e,0x3f676bd8,0x3f61c598,0x3f5b941a,0x3f676bd8,0x3f6106f2,0x3f59f26a,0x3f5233c6
.long 0x3f61c598,0x3f59f26a,0x3f514d3d,0x3f47de65,0x3f5b941a,0x3f5233c6,0x3f47de65,0x3f3ca003
.long 0x3f3504f3,0x3f226799,0x3f0e39da,0x3ef15aea,0x3f2beb4a,0x3f173c07,0x3f00e7e4,0x3ed25a09
.long 0x3f226799,0x3f0b9a6b,0x3ee63375,0x3eb263ef,0x3f187fc0,0x3eff17b2,0x3ec9b953,0x3e919ddd
.long 0x3ec3ef15,0x3e78cfcc,0x3dc8bd36,0xbd48fb30,0x3eac7cd4,0x3e419b37,0x3d16c32c,0xbdee3876
.long 0x3e94a031,0x3e09cf86,0xbcc90ab0,0xbe3b6ecf,0x3e78cfcc,0x3da3308c,0xbdafb680,0xbe7ee6e1
.long 0x3f7b14be,0x3f79c79d,0x3f7853f8,0x3f76ba07,0x3f7853f8,0x3f764d97,0x3f740bdd,0x3f718f57
.long 0x3f74fa0b,0x3f721352,0x3f6ed89e,0x3f6b4b0c,0x3f710908,0x3f6d1c1d,0x3f68bf3c,0x3f63f473
.long 0x3f54db31,0x3f49d112,0x3f3daef9,0x3f3085bb,0x3f4d9f02,0x3f40d0da,0x3f32c8c9,0x3f239da9
.long 0x3f45e403,0x3f373a23,0x3f273656,0x3f15f6d9,0x3f3daef9,0x3f2d1469,0x3f1b02c6,0x3f07a136
.long 0x3f0e39da,0x3ee63375,0x3eac7cd4,0x3e605c13,0x3f039c3d,0x3ecc9b8b,0x3e8e9a22,0x3e1c76de
.long 0x3ef15aea,0x3eb263ef,0x3e605c13,0x3dafb680,0x3edae880,0x3e97a117,0x3e22abb6,0x3c96c9b6
.long 0x3e47c5c2,0x3cc90ab0,0xbe164083,0xbea09ae5,0x3e164083,0xbcfb49ba,0xbe541501,0xbec1071e
.long 0x3dc8bd36,0xbdafb680,0xbe888e93,0xbee0924f,0x3d48fb30,0xbe1008b7,0xbea68f12,0xbeff17b2
.long 0x3f800000,0x3f800000,0x3f800000,0x3f800000,0x3f7f4e6d,0x3f7f2f9d,0x3f7f0e58,0x3f7eea9d
.long 0x3f7d3aac,0x3f7cbfc9,0x3f7c3b28,0x3f7baccd,0x3f79c79d,0x3f78b47b,0x3f778bc5,0x3f764d97
.long 0x3f54db31,0x3f4d9f02,0x3f45e403,0x3f3daef9,0x3f49d112,0x3f40d0da,0x3f373a23,0x3f2d1469
.long 0x3f3daef9,0x3f32c8c9,0x3f273656,0x3f1b02c6,0x3f3085bb,0x3f239da9,0x3f15f6d9,0x3f07a136
.long 0x3ec3ef15,0x3e94a031,0x3e47c5c2,0x3dc8bd36,0x3ea09ae5,0x3e5a3997,0x3de1bc2e,0x3bc90f88
.long 0x3e78cfcc,0x3e09cf86,0x3cc90ab0,0xbdafb680,0x3e2f10a2,0x3d621469,0xbd7b2b74,0xbe354098
.long 0xbe47c5c2,0xbeac7cd4,0xbef15aea,0xbf187fc0,0xbe888e93,0xbed25a09,0xbf0b9a6b,0xbf2ac082
.long 0xbeac7cd4,0xbef6e0cb,0xbf1d7fd1,0xbf3b8f3b,0xbecf7bca,0xbf0cead0,0xbf2e3bde,0xbf4ac77f
.long 0x3f74fa0b,0x3f731447,0x3f710908,0x3f6ed89e,0x3f6ed89e,0x3f6be858,0x3f68bf3c,0x3f655e0b
.long 0x3f676bd8,0x3f633c5a,0x3f5ebe05,0x3f59f26a,0x3f5ebe05,0x3f591e6a,0x3f531849,0x3f4cae79
.long 0x3f226799,0x3f13682a,0x3f039c3d,0x3ee63375,0x3f13682a,0x3f0242b1,0x3ee0924f,0x3ebb31a0
.long 0x3f039c3d,0x3ee0924f,0x3eb8442a,0x3e8e9a22,0x3ee63375,0x3ebb31a0,0x3e8e9a22,0x3e419b37
.long 0x3dc8bd36,0xbcc90ab0,0xbe164083,0xbe888e93,0x3cc90ab0,0xbdd53db9,0xbe6c9a7f,0xbeb554ec
.long 0xbd48fb30,0xbe3b6ecf,0xbea09ae5,0xbee0924f,0xbdfab273,0xbe8586ce,0xbec9b953,0xbf04f484
.long 0xbef15aea,0xbf1d7fd1,0xbf3daef9,0xbf584853,0xbf08f59b,0xbf2d1469,0xbf4bbbf8,0xbf63f473
.long 0xbf187fc0,0xbf3b8f3b,0xbf584853,0xbf6db293,0xbf273656,0xbf48d8b3,0xbf633c5a,0xbf756d97
.long 0x3f800000,0x3f800000,0x3f800000,0x3f800000,0x3f7ec46d,0x3f7e9bc9,0x3f7e70b0,0x3f7e4323
.long 0x3f7b14be,0x3f7a7302,0x3f79c79d,0x3f791298,0x3f74fa0b,0x3f73913f,0x3f721352,0x3f708066
.long 0x3f3504f3,0x3f2beb4a,0x3f226799,0x3f187fc0,0x3f226799,0x3f173c07,0x3f0b9a6b,0x3eff17b2
.long 0x3f0e39da,0x3f00e7e4,0x3ee63375,0x3ec9b953,0x3ef15aea,0x3ed25a09,0x3eb263ef,0x3e919ddd
.long 0x0,0xbdc8bd36,0xbe47c5c2,0xbe94a031,0xbdc8bd36,0xbe4dee60,0xbe9aa086,0xbecc9b8b
.long 0xbe47c5c2,0xbe9aa086,0xbecf7bca,0xbf00e7e4,0xbe94a031,0xbecc9b8b,0xbf00e7e4,0xbf19c200
.long 0xbf3504f3,0xbf4d9f02,0xbf61c598,0xbf710908,0xbf45e403,0xbf5c61c7,0xbf6db293,0xbf796e4e
.long 0xbf54db31,0xbf68bf3c,0xbf76ba07,0xbf7e70b0,0xbf61c598,0xbf7294f8,0xbf7cbfc9,0xbf7ffec4
.long 0x3f6c835e,0x3f6a09a7,0x3f676bd8,0x3f64aa59,0x3f61c598,0x3f5df6be,0x3f59f26a,0x3f55b993
.long 0x3f54db31,0x3f4f7a1f,0x3f49d112,0x3f43e200,0x3f45e403,0x3f3ebc1b,0x3f373a23,0x3f2f61a5
.long 0x3ec3ef15,0x3ea09ae5,0x3e78cfcc,0x3e2f10a2,0x3e94a031,0x3e5a3997,0x3e09cf86,0x3d621469
.long 0x3e47c5c2,0x3de1bc2e,0x3cc90ab0,0xbd7b2b74,0x3dc8bd36,0x3bc90f88,0xbdafb680,0xbe354098
.long 0xbec3ef15,0xbefc5d27,0xbf187fc0,0xbf3085bb,0xbef15aea,0xbf14b039,0xbf2e3bde,0xbf44e3f5
.long 0xbf0e39da,0xbf299415,0xbf41d870,0xbf5695e5,0xbf226799,0xbf3ca003,0xbf531849,0xbf655e0b
.long 0xbf6c835e,0xbf79c79d,0xbf7fb10f,0xbf7e1324,0xbf74fa0b,0xbf7e4323,0xbf7f84ab,0xbf78b47b
.long 0xbf7b14be,0xbf7ffb11,0xbf7c3b28,0xbf6ff573,0xbf7ec46d,0xbf7eea9d,0xbf75dec6,0xbf63f473
.long 0x3f800000,0x3f800000,0x3f800000,0x3f800000,0x3f7e1324,0x3f7de0b1,0x3f7dabcc,0x3f7d7474
.long 0x3f7853f8,0x3f778bc5,0x3f76ba07,0x3f75dec6,0x3f6ed89e,0x3f6d1c1d,0x3f6b4b0c,0x3f696591
.long 0x3f0e39da,0x3f039c3d,0x3ef15aea,0x3edae880,0x3ee63375,0x3ecc9b8b,0x3eb263ef,0x3e97a117
.long 0x3eac7cd4,0x3e8e9a22,0x3e605c13,0x3e22abb6,0x3e605c13,0x3e1c76de,0x3dafb680,0x3c96c9b6
.long 0xbec3ef15,0xbef15aea,0xbf0e39da,0xbf226799,0xbefc5d27,0xbf14b039,0xbf299415,0xbf3ca003
.long 0xbf187fc0,0xbf2e3bde,0xbf41d870,0xbf531849,0xbf3085bb,0xbf44e3f5,0xbf5695e5,0xbf655e0b
.long 0xbf7b14be,0xbf7fb10f,0xbf7ec46d,0xbf7853f8,0xbf7f4e6d,0xbf7f2f9d,0xbf791298,0xbf6d1c1d
.long 0xbf7fb10f,0xbf7a7302,0xbf6ed89e,0xbf5d2d53,0xbf7c3b28,0xbf718f57,0xbf604621,0xbf48d8b3
.long 0x3f61c598,0x3f5ebe05,0x3f5b941a,0x3f584853,0x3f514d3d,0x3f4cae79,0x3f47de65,0x3f42de29
.long 0x3f3daef9,0x3f373a23,0x3f3085bb,0x3f299415,0x3f273656,0x3f1ebc12,0x3f15f6d9,0x3f0cead0
.long 0x3dc8bd36,0x3cc90ab0,0xbd48fb30,0xbdfab273,0xbcc90ab0,0xbdd53db9,0xbe3b6ecf,0xbe8586ce
.long 0xbe164083,0xbe6c9a7f,0xbea09ae5,0xbec9b953,0xbe888e93,0xbeb554ec,0xbee0924f,0xbf04f484
.long 0xbf45e403,0xbf584853,0xbf676bd8,0xbf731447,0xbf584853,0xbf6816a8,0xbf740bdd,0xbf7bf531
.long 0xbf676bd8,0xbf740bdd,0xbf7c3b28,0xbf7fd397,0xbf731447,0xbf7bf531,0xbf7fd397,0xbf7e9bc9
.long 0xbf74fa0b,0xbf64aa59,0xbf4d9f02,0xbf3085bb,0xbf6a09a7,0xbf53fac3,0xbf373a23,0xbf14b039
.long 0xbf5b941a,0xbf3fc767,0xbf1d7fd1,0xbeebcbbb,0xbf49d112,0xbf286605,0xbf00e7e4,0xbea986c4
.long 0x3f800000,0x3f800000,0x3f800000,0x3f800000,0x3f7d3aac,0x3f7cfe73,0x3f7cbfc9,0x3f7c7eb0
.long 0x3f74fa0b,0x3f740bdd,0x3f731447,0x3f721352,0x3f676bd8,0x3f655e0b,0x3f633c5a,0x3f6106f2
.long 0x3ec3ef15,0x3eac7cd4,0x3e94a031,0x3e78cfcc,0x3e78cfcc,0x3e419b37,0x3e09cf86,0x3da3308c
.long 0x3dc8bd36,0x3d16c32c,0xbcc90ab0,0xbdafb680,0xbd48fb30,0xbdee3876,0xbe3b6ecf,0xbe7ee6e1
.long 0xbf3504f3,0xbf45e403,0xbf54db31,0xbf61c598,0xbf4d9f02,0xbf5c61c7,0xbf68bf3c,0xbf7294f8
.long 0xbf61c598,0xbf6db293,0xbf76ba07,0xbf7cbfc9,0xbf710908,0xbf796e4e,0xbf7e70b0,0xbf7ffec4
.long 0xbf6c835e,0xbf5b941a,0xbf45e403,0xbf2beb4a,0xbf5b941a,0xbf44e3f5,0xbf299415,0xbf0a48ad
.long 0xbf45e403,0xbf299415,0xbf08f59b,0xbec9b953,0xbf2beb4a,0xbf0a48ad,0xbec9b953,0xbe72b651
.long 0x3f54db31,0x3f514d3d,0x3f4d9f02,0x3f49d112,0x3f3daef9,0x3f385216,0x3f32c8c9,0x3f2d1469
.long 0x3f226799,0x3f1b02c6,0x3f13682a,0x3f0b9a6b,0x3f039c3d,0x3ef41f07,0x3ee0924f,0x3ecc9b8b
.long 0xbe47c5c2,0xbe888e93,0xbeac7cd4,0xbecf7bca,0xbeac7cd4,0xbed25a09,0xbef6e0cb,0xbf0cead0
.long 0xbef15aea,0xbf0b9a6b,0xbf1d7fd1,0xbf2e3bde,0xbf187fc0,0xbf2ac082,0xbf3b8f3b,0xbf4ac77f
.long 0xbf7b14be,0xbf7f4e6d,0xbf7fb10f,0xbf7c3b28,0xbf7fb10f,0xbf7f2f9d,0xbf7a7302,0xbf718f57
.long 0xbf7ec46d,0xbf791298,0xbf6ed89e,0xbf604621,0xbf7853f8,0xbf6d1c1d,0xbf5d2d53,0xbf48d8b3
.long 0xbf0e39da,0xbecf7bca,0xbe78cfcc,0xbd96a905,0xbedae880,0xbe8586ce,0xbdafb680,0x3dbc3ac3
.long 0xbe94a031,0xbde1bc2e,0x3d96a905,0x3e827dc0,0xbe164083,0x3d2fe007,0x3e6c9a7f,0x3ed25a09
.long 0x3f800000,0x3f800000,0x3f800000,0x3f800000,0x3f7c3b28,0x3f7bf531,0x3f7baccd,0x3f7b61fc
.long 0x3f710908,0x3f6ff573,0x3f6ed89e,0x3f6db293,0x3f5ebe05,0x3f5c61c7,0x3f59f26a,0x3f577026
.long 0x3e47c5c2,0x3e164083,0x3dc8bd36,0x3d48fb30,0x3cc90ab0,0xbcfb49ba,0xbdafb680,0xbe1008b7
.long 0xbe164083,0xbe541501,0xbe888e93,0xbea68f12,0xbea09ae5,0xbec1071e,0xbee0924f,0xbeff17b2
.long 0xbf6c835e,0xbf74fa0b,0xbf7b14be,0xbf7ec46d,0xbf79c79d,0xbf7e4323,0xbf7ffb11,0xbf7eea9d
.long 0xbf7fb10f,0xbf7f84ab,0xbf7c3b28,0xbf75dec6,0xbf7e1324,0xbf78b47b,0xbf6ff573,0xbf63f473
.long 0xbf0e39da,0xbedae880,0xbe94a031,0xbe164083,0xbecf7bca,0xbe8586ce,0xbde1bc2e,0x3d2fe007
.long 0xbe78cfcc,0xbdafb680,0x3d96a905,0x3e6c9a7f,0xbd96a905,0x3dbc3ac3,0x3e827dc0,0x3ed25a09
.long 0x3f45e403,0x3f41d870,0x3f3daef9,0x3f396842,0x3f273656,0x3f212ff9,0x3f1b02c6,0x3f14b039
.long 0x3f039c3d,0x3ef6e0cb,0x3ee63375,0x3ed53641,0x3eb8442a,0x3ea395c5,0x3e8e9a22,0x3e72b651
.long 0xbef15aea,0xbf08f59b,0xbf187fc0,0xbf273656,0xbf1d7fd1,0xbf2d1469,0xbf3b8f3b,0xbf48d8b3
.long 0xbf3daef9,0xbf4bbbf8,0xbf584853,0xbf633c5a,0xbf584853,0xbf63f473,0xbf6db293,0xbf756d97
.long 0xbf74fa0b,0xbf6a09a7,0xbf5b941a,0xbf49d112,0xbf64aa59,0xbf53fac3,0xbf3fc767,0xbf286605
.long 0xbf4d9f02,0xbf373a23,0xbf1d7fd1,0xbf00e7e4,0xbf3085bb,0xbf14b039,0xbeebcbbb,0xbea986c4
.long 0x3dc8bd36,0x3e888e93,0x3edae880,0x3f13682a,0x3e888e93,0x3eddbe79,0x3f15f6d9,0x3f385216
.long 0x3edae880,0x3f15f6d9,0x3f396842,0x3f5695e5,0x3f13682a,0x3f385216,0x3f5695e5,0x3f6d1c1d
.long 0x0,0x0,0x0,0x0,0x0,0x3bc90f88,0x3c490e90,0x3c96c9b6
.long 0x0,0x3c490e90,0x3cc90ab0,0x3d16c32c,0x0,0x3c96c9b6,0x3d16c32c,0x3d621469
.long 0x0,0x3d48fb30,0x3dc8bd36,0x3e164083,0x0,0x3d621469,0x3de1bc2e,0x3e28defc
.long 0x0,0x3d7b2b74,0x3dfab273,0x3e3b6ecf,0x0,0x3d8a200a,0x3e09cf86,0x3e4dee60
.long 0x0,0x3dc8bd36,0x3e47c5c2,0x3e94a031,0x0,0x3dd53db9,0x3e541501,0x3e9d9e78
.long 0x0,0x3de1bc2e,0x3e605c13,0x3ea68f12,0x0,0x3dee3876,0x3e6c9a7f,0x3eaf713a
.long 0x0,0x3e164083,0x3e94a031,0x3edae880,0x0,0x3e1c76de,0x3e9aa086,0x3ee363fa
.long 0x0,0x3e22abb6,0x3ea09ae5,0x3eebcbbb,0x0,0x3e28defc,0x3ea68f12,0x3ef41f07
.long 0x0,0x3cc90ab0,0x3d48fb30,0x3d96a905,0x0,0x3cfb49ba,0x3d7b2b74,0x3dbc3ac3
.long 0x0,0x3d16c32c,0x3d96a905,0x3de1bc2e,0x0,0x3d2fe007,0x3dafb680,0x3e039502
.long 0x0,0x3d96a905,0x3e164083,0x3e605c13,0x0,0x3da3308c,0x3e22abb6,0x3e72b651
.long 0x0,0x3dafb680,0x3e2f10a2,0x3e827dc0,0x0,0x3dbc3ac3,0x3e3b6ecf,0x3e8b9507
.long 0x0,0x3dfab273,0x3e78cfcc,0x3eb8442a,0x0,0x3e039502,0x3e827dc0,0x3ec1071e
.long 0x0,0x3e09cf86,0x3e888e93,0x3ec9b953,0x0,0x3e1008b7,0x3e8e9a22,0x3ed25a09
.long 0x0,0x3e2f10a2,0x3eac7cd4,0x3efc5d27,0x0,0x3e354098,0x3eb263ef,0x3f0242b1
.long 0x0,0x3e3b6ecf,0x3eb8442a,0x3f064b82,0x0,0x3e419b37,0x3ebe1d4a,0x3f0a48ad
.long 0x0,0x0,0x0,0x0,0x3cc90ab0,0x3cfb49ba,0x3d16c32c,0x3d2fe007
.long 0x3d48fb30,0x3d7b2b74,0x3d96a905,0x3dafb680,0x3d96a905,0x3dbc3ac3,0x3de1bc2e,0x3e039502
.long 0x3e47c5c2,0x3e78cfcc,0x3e94a031,0x3eac7cd4,0x3e605c13,0x3e8b9507,0x3ea68f12,0x3ec1071e
.long 0x3e78cfcc,0x3e9aa086,0x3eb8442a,0x3ed53641,0x3e888e93,0x3ea986c4,0x3ec9b953,0x3ee900b7
.long 0x3ec3ef15,0x3ef15aea,0x3f0e39da,0x3f226799,0x3ecf7bca,0x3eff17b2,0x3f15f6d9,0x3f2ac082
.long 0x3edae880,0x3f064b82,0x3f1d7fd1,0x3f32c8c9,0x3ee63375,0x3f0cead0,0x3f24d225,0x3f3a7ca4
.long 0x3f0e39da,0x3f2beb4a,0x3f45e403,0x3f5b941a,0x3f13682a,0x3f31a81d,0x3f4bbbf8,0x3f6106f2
.long 0x3f187fc0,0x3f373a23,0x3f514d3d,0x3f660f88,0x3f1d7fd1,0x3f3ca003,0x3f5695e5,0x3f6aab7b
.long 0x3dc8bd36,0x3dfab273,0x3e164083,0x3e2f10a2,0x3dfab273,0x3e1c76de,0x3e3b6ecf,0x3e5a3997
.long 0x3e164083,0x3e3b6ecf,0x3e605c13,0x3e827dc0,0x3e2f10a2,0x3e5a3997,0x3e827dc0,0x3e97a117
.long 0x3e94a031,0x3eb8442a,0x3edae880,0x3efc5d27,0x3ea09ae5,0x3ec6d529,0x3eebcbbb,0x3f07a136
.long 0x3eac7cd4,0x3ed53641,0x3efc5d27,0x3f10d3cd,0x3eb8442a,0x3ee363fa,0x3f064b82,0x3f19c200
.long 0x3ef15aea,0x3f13682a,0x3f2beb4a,0x3f41d870,0x3efc5d27,0x3f19c200,0x3f32c8c9,0x3f48d8b3
.long 0x3f039c3d,0x3f1ff6cb,0x3f396842,0x3f4f7a1f,0x3f08f59b,0x3f26050a,0x3f3fc767,0x3f55b993
.long 0x3f226799,0x3f41d870,0x3f5b941a,0x3f6ed89e,0x3f273656,0x3f46e22a,0x3f604621,0x3f7294f8
.long 0x3f2beb4a,0x3f4bbbf8,0x3f64aa59,0x3f75dec6,0x3f3085bb,0x3f5064af,0x3f68bf3c,0x3f78b47b
.long 0x0,0x0,0x0,0x0,0x3d48fb30,0x3d621469,0x3d7b2b74,0x3d8a200a
.long 0x3dc8bd36,0x3de1bc2e,0x3dfab273,0x3e09cf86,0x3e164083,0x3e28defc,0x3e3b6ecf,0x3e4dee60
.long 0x3ec3ef15,0x3edae880,0x3ef15aea,0x3f039c3d,0x3edae880,0x3ef41f07,0x3f064b82,0x3f121eb0
.long 0x3ef15aea,0x3f064b82,0x3f13682a,0x3f1ff6cb,0x3f039c3d,0x3f121eb0,0x3f1ff6cb,0x3f2d1469
.long 0x3f3504f3,0x3f45e403,0x3f54db31,0x3f61c598,0x3f3daef9,0x3f4e8d90,0x3f5d2d53,0x3f696591
.long 0x3f45e403,0x3f5695e5,0x3f64aa59,0x3f6ff573,0x3f4d9f02,0x3f5df6be,0x3f6b4b0c,0x3f756d97
.long 0x3f6c835e,0x3f7853f8,0x3f7ec46d,0x3f7fb10f,0x3f710908,0x3f7b61fc,0x3f7fd397,0x3f7e4323
.long 0x3f74fa0b,0x3f7dabcc,0x3f7fec43,0x3f7baccd,0x3f7853f8,0x3f7f2f9d,0x3f7f0e58,0x3f77f110
.long 0x3e47c5c2,0x3e605c13,0x3e78cfcc,0x3e888e93,0x3e78cfcc,0x3e8b9507,0x3e9aa086,0x3ea986c4
.long 0x3e94a031,0x3ea68f12,0x3eb8442a,0x3ec9b953,0x3eac7cd4,0x3ec1071e,0x3ed53641,0x3ee900b7
.long 0x3f0e39da,0x3f1d7fd1,0x3f2beb4a,0x3f396842,0x3f187fc0,0x3f286605,0x3f373a23,0x3f44e3f5
.long 0x3f226799,0x3f32c8c9,0x3f41d870,0x3f4f7a1f,0x3f2beb4a,0x3f3ca003,0x3f4bbbf8,0x3f591e6a
.long 0x3f54db31,0x3f64aa59,0x3f710908,0x3f79c79d,0x3f5b941a,0x3f6aab7b,0x3f75dec6,0x3f7cfe73
.long 0x3f61c598,0x3f6ff573,0x3f79c79d,0x3f7f0e58,0x3f676bd8,0x3f748422,0x3f7cbfc9,0x3f7ff4e6
.long 0x3f7b14be,0x3f7fec43,0x3f7d3aac,0x3f731447,0x3f7d3aac,0x3f7fe129,0x3f7a7302,0x3f6d1c1d
.long 0x3f7ec46d,0x3f7f0e58,0x3f76ba07,0x3f660f88,0x3f7fb10f,0x3f7d7474,0x3f721352,0x3f5df6be
.long 0x0,0x0,0x0,0x0,0x3d96a905,0x3da3308c,0x3dafb680,0x3dbc3ac3
.long 0x3e164083,0x3e22abb6,0x3e2f10a2,0x3e3b6ecf,0x3e605c13,0x3e72b651,0x3e827dc0,0x3e8b9507
.long 0x3f0e39da,0x3f187fc0,0x3f226799,0x3f2beb4a,0x3f1d7fd1,0x3f286605,0x3f32c8c9,0x3f3ca003
.long 0x3f2beb4a,0x3f373a23,0x3f41d870,0x3f4bbbf8,0x3f396842,0x3f44e3f5,0x3f4f7a1f,0x3f591e6a
.long 0x3f6c835e,0x3f74fa0b,0x3f7b14be,0x3f7ec46d,0x3f731447,0x3f7a1e84,0x3f7e70b0,0x3f7ffec4
.long 0x3f7853f8,0x3f7dabcc,0x3f7fec43,0x3f7f0e58,0x3f7c3b28,0x3f7f9c18,0x3f7f84ab,0x3f7bf531
.long 0x3f7b14be,0x3f710908,0x3f61c598,0x3f4d9f02,0x3f76ba07,0x3f696591,0x3f5695e5,0x3f3ebc1b
.long 0x3f710908,0x3f604621,0x3f49d112,0x3f2e3bde,0x3f6a09a7,0x3f55b993,0x3f3b8f3b,0x3f1c420c
.long 0x3e94a031,0x3ea09ae5,0x3eac7cd4,0x3eb8442a,0x3eb8442a,0x3ec6d529,0x3ed53641,0x3ee363fa
.long 0x3edae880,0x3eebcbbb,0x3efc5d27,0x3f064b82,0x3efc5d27,0x3f07a136,0x3f10d3cd,0x3f19c200
.long 0x3f45e403,0x3f514d3d,0x3f5b941a,0x3f64aa59,0x3f514d3d,0x3f5c61c7,0x3f660f88,0x3f6e46be
.long 0x3f5b941a,0x3f660f88,0x3f6ed89e,0x3f75dec6,0x3f64aa59,0x3f6e46be,0x3f75dec6,0x3f7b61fc
.long 0x3f7ec46d,0x3f7fec43,0x3f7d3aac,0x3f76ba07,0x3f7fec43,0x3f7e9bc9,0x3f791298,0x3f6f6830
.long 0x3f7fb10f,0x3f7baccd,0x3f731447,0x3f660f88,0x3f7e1324,0x3f772417,0x3f6b4b0c,0x3f5ac450
.long 0x3f61c598,0x3f49d112,0x3f2beb4a,0x3f08f59b,0x3f584853,0x3f3ca003,0x3f1b02c6,0x3ee900b7
.long 0x3f4d9f02,0x3f2e3bde,0x3f08f59b,0x3ebe1d4a,0x3f41d870,0x3f1ebc12,0x3eebcbbb,0x3e919ddd
.long 0x0,0x0,0x0,0x0,0x3dc8bd36,0x3dd53db9,0x3de1bc2e,0x3dee3876
.long 0x3e47c5c2,0x3e541501,0x3e605c13,0x3e6c9a7f,0x3e94a031,0x3e9d9e78,0x3ea68f12,0x3eaf713a
.long 0x3f3504f3,0x3f3daef9,0x3f45e403,0x3f4d9f02,0x3f45e403,0x3f4e8d90,0x3f5695e5,0x3f5df6be
.long 0x3f54db31,0x3f5d2d53,0x3f64aa59,0x3f6b4b0c,0x3f61c598,0x3f696591,0x3f6ff573,0x3f756d97
.long 0x3f800000,0x3f7ec46d,0x3f7b14be,0x3f74fa0b,0x3f7ec46d,0x3f7ac516,0x3f740bdd,0x3f6aab7b
.long 0x3f7b14be,0x3f740bdd,0x3f6a09a7,0x3f5d2d53,0x3f74fa0b,0x3f6aab7b,0x3f5d2d53,0x3f4cae79
.long 0x3f3504f3,0x3f187fc0,0x3ef15aea,0x3eac7cd4,0x3f226799,0x3f0242b1,0x3ebe1d4a,0x3e667c66
.long 0x3f0e39da,0x3ed53641,0x3e888e93,0x3de1bc2e,0x3ef15aea,0x3ea395c5,0x3e22abb6,0xbbc90f88
.long 0x3ec3ef15,0x3ecf7bca,0x3edae880,0x3ee63375,0x3ef15aea,0x3eff17b2,0x3f064b82,0x3f0cead0
.long 0x3f0e39da,0x3f15f6d9,0x3f1d7fd1,0x3f24d225,0x3f226799,0x3f2ac082,0x3f32c8c9,0x3f3a7ca4
.long 0x3f6c835e,0x3f731447,0x3f7853f8,0x3f7c3b28,0x3f74fa0b,0x3f7a1e84,0x3f7dabcc,0x3f7f9c18
.long 0x3f7b14be,0x3f7e70b0,0x3f7fec43,0x3f7f84ab,0x3f7ec46d,0x3f7ffec4,0x3f7f0e58,0x3f7bf531
.long 0x3f6c835e,0x3f5ebe05,0x3f4d9f02,0x3f396842,0x3f61c598,0x3f5064af,0x3f3b8f3b,0x3f239da9
.long 0x3f54db31,0x3f3fc767,0x3f273656,0x3f0b9a6b,0x3f45e403,0x3f2d1469,0x3f10d3cd,0x3ee363fa
.long 0x3ec3ef15,0x3e605c13,0x3d48fb30,0xbdfab273,0x3e94a031,0x3dee3876,0xbd7b2b74,0xbe72b651
.long 0x3e47c5c2,0x3c490e90,0xbe2f10a2,0xbeb263ef,0x3dc8bd36,0xbdbc3ac3,0xbe8e9a22,0xbee900b7
.long 0x0,0x0,0x0,0x0,0x3dfab273,0x3e039502,0x3e09cf86,0x3e1008b7
.long 0x3e78cfcc,0x3e827dc0,0x3e888e93,0x3e8e9a22,0x3eb8442a,0x3ec1071e,0x3ec9b953,0x3ed25a09
.long 0x3f54db31,0x3f5b941a,0x3f61c598,0x3f676bd8,0x3f64aa59,0x3f6aab7b,0x3f6ff573,0x3f748422
.long 0x3f710908,0x3f75dec6,0x3f79c79d,0x3f7cbfc9,0x3f79c79d,0x3f7cfe73,0x3f7f0e58,0x3f7ff4e6
.long 0x3f6c835e,0x3f61c598,0x3f54db31,0x3f45e403,0x3f5ebe05,0x3f5064af,0x3f3fc767,0x3f2d1469
.long 0x3f4d9f02,0x3f3b8f3b,0x3f273656,0x3f10d3cd,0x3f396842,0x3f239da9,0x3f0b9a6b,0x3ee363fa
.long 0x3e47c5c2,0x3d48fb30,0xbdc8bd36,0xbe78cfcc,0x3d96a905,0xbda3308c,0xbe6c9a7f,0xbec1071e
.long 0xbd48fb30,0xbe541501,0xbeb8442a,0xbf00e7e4,0xbe2f10a2,0xbea986c4,0xbef6e0cb,0xbf1ebc12
.long 0x3ef15aea,0x3efc5d27,0x3f039c3d,0x3f08f59b,0x3f13682a,0x3f19c200,0x3f1ff6cb,0x3f26050a
.long 0x3f2beb4a,0x3f32c8c9,0x3f396842,0x3f3fc767,0x3f41d870,0x3f48d8b3,0x3f4f7a1f,0x3f55b993
.long 0x3f7ec46d,0x3f7fec43,0x3f7fb10f,0x3f7e1324,0x3f7fec43,0x3f7e9bc9,0x3f7baccd,0x3f772417
.long 0x3f7d3aac,0x3f791298,0x3f731447,0x3f6b4b0c,0x3f76ba07,0x3f6f6830,0x3f660f88,0x3f5ac450
.long 0x3f226799,0x3f08f59b,0x3edae880,0x3ea09ae5,0x3f08f59b,0x3ed8106b,0x3e9aa086,0x3e354098
.long 0x3edae880,0x3e9aa086,0x3e2f10a2,0x3d16c32c,0x3ea09ae5,0x3e354098,0x3d16c32c,0xbdd53db9
.long 0xbe94a031,0xbee63375,0xbf187fc0,0xbf396842,0xbecf7bca,0xbf0f8784,0xbf32c8c9,0xbf5064af
.long 0xbf039c3d,0xbf299415,0xbf49d112,0xbf633c5a,0xbf1d7fd1,0xbf40d0da,0xbf5d2d53,0xbf718f57
.long 0x0,0x0,0x0,0x0,0x3e164083,0x3e1c76de,0x3e22abb6,0x3e28defc
.long 0x3e94a031,0x3e9aa086,0x3ea09ae5,0x3ea68f12,0x3edae880,0x3ee363fa,0x3eebcbbb,0x3ef41f07
.long 0x3f6c835e,0x3f710908,0x3f74fa0b,0x3f7853f8,0x3f7853f8,0x3f7b61fc,0x3f7dabcc,0x3f7f2f9d
.long 0x3f7ec46d,0x3f7fd397,0x3f7fec43,0x3f7f0e58,0x3f7fb10f,0x3f7e4323,0x3f7baccd,0x3f77f110
.long 0x3f3504f3,0x3f226799,0x3f0e39da,0x3ef15aea,0x3f187fc0,0x3f0242b1,0x3ed53641,0x3ea395c5
.long 0x3ef15aea,0x3ebe1d4a,0x3e888e93,0x3e22abb6,0x3eac7cd4,0x3e667c66,0x3de1bc2e,0xbbc90f88
.long 0xbec3ef15,0xbf039c3d,0xbf226799,0xbf3daef9,0xbf039c3d,0xbf239da9,0xbf3fc767,0xbf577026
.long 0xbf226799,0xbf3fc767,0xbf584853,0xbf6b4b0c,0xbf3daef9,0xbf577026,0xbf6b4b0c,0xbf78b47b
.long 0x3f0e39da,0x3f13682a,0x3f187fc0,0x3f1d7fd1,0x3f2beb4a,0x3f31a81d,0x3f373a23,0x3f3ca003
.long 0x3f45e403,0x3f4bbbf8,0x3f514d3d,0x3f5695e5,0x3f5b941a,0x3f6106f2,0x3f660f88,0x3f6aab7b
.long 0x3f7b14be,0x3f76ba07,0x3f710908,0x3f6a09a7,0x3f710908,0x3f696591,0x3f604621,0x3f55b993
.long 0x3f61c598,0x3f5695e5,0x3f49d112,0x3f3b8f3b,0x3f4d9f02,0x3f3ebc1b,0x3f2e3bde,0x3f1c420c
.long 0x3e47c5c2,0x3d96a905,0xbd48fb30,0xbe2f10a2,0x3d48fb30,0xbda3308c,0xbe541501,0xbea986c4
.long 0xbdc8bd36,0xbe6c9a7f,0xbeb8442a,0xbef6e0cb,0xbe78cfcc,0xbec1071e,0xbf00e7e4,0xbf1ebc12
.long 0xbf54db31,0xbf6a09a7,0xbf7853f8,0xbf7f4e6d,0xbf676bd8,0xbf772417,0xbf7f0e58,0xbf7eea9d
.long 0xbf74fa0b,0xbf7e70b0,0xbf7f4e6d,0xbf778bc5,0xbf7d3aac,0xbf7fc38f,0xbf791298,0xbf696591
.long 0x0,0x0,0x0,0x0,0x3e2f10a2,0x3e354098,0x3e3b6ecf,0x3e419b37
.long 0x3eac7cd4,0x3eb263ef,0x3eb8442a,0x3ebe1d4a,0x3efc5d27,0x3f0242b1,0x3f064b82,0x3f0a48ad
.long 0x3f7b14be,0x3f7d3aac,0x3f7ec46d,0x3f7fb10f,0x3f7fec43,0x3f7fe129,0x3f7f0e58,0x3f7d7474
.long 0x3f7d3aac,0x3f7a7302,0x3f76ba07,0x3f721352,0x3f731447,0x3f6d1c1d,0x3f660f88,0x3f5df6be
.long 0x3ec3ef15,0x3e94a031,0x3e47c5c2,0x3dc8bd36,0x3e605c13,0x3dee3876,0x3c490e90,0xbdbc3ac3
.long 0x3d48fb30,0xbd7b2b74,0xbe2f10a2,0xbe8e9a22,0xbdfab273,0xbe72b651,0xbeb263ef,0xbee900b7
.long 0xbf54db31,0xbf676bd8,0xbf74fa0b,0xbf7d3aac,0xbf6a09a7,0xbf772417,0xbf7e70b0,0xbf7fc38f
.long 0xbf7853f8,0xbf7f0e58,0xbf7f4e6d,0xbf791298,0xbf7f4e6d,0xbf7eea9d,0xbf778bc5,0xbf696591
.long 0x3f226799,0x3f273656,0x3f2beb4a,0x3f3085bb,0x3f41d870,0x3f46e22a,0x3f4bbbf8,0x3f5064af
.long 0x3f5b941a,0x3f604621,0x3f64aa59,0x3f68bf3c,0x3f6ed89e,0x3f7294f8,0x3f75dec6,0x3f78b47b
.long 0x3f61c598,0x3f584853,0x3f4d9f02,0x3f41d870,0x3f49d112,0x3f3ca003,0x3f2e3bde,0x3f1ebc12
.long 0x3f2beb4a,0x3f1b02c6,0x3f08f59b,0x3eebcbbb,0x3f08f59b,0x3ee900b7,0x3ebe1d4a,0x3e919ddd
.long 0xbe94a031,0xbecf7bca,0xbf039c3d,0xbf1d7fd1,0xbee63375,0xbf0f8784,0xbf299415,0xbf40d0da
.long 0xbf187fc0,0xbf32c8c9,0xbf49d112,0xbf5d2d53,0xbf396842,0xbf5064af,0xbf633c5a,0xbf718f57
.long 0xbf7ec46d,0xbf76ba07,0xbf676bd8,0xbf514d3d,0xbf76ba07,0xbf66becc,0xbf4f7a1f,0xbf31a81d
.long 0xbf676bd8,0xbf4f7a1f,0xbf3085bb,0xbf0b9a6b,0xbf514d3d,0xbf31a81d,0xbf0b9a6b,0xbec1071e
.long 0x80003f80,0x80003f80,0x80003f80,0x80003f80,0x80003f80,0xbe483f7b,0xbec43f6d,0xbf0e3f55
.long 0x80003f80,0xbec43f6d,0xbf353f35,0xbf6d3ec4,0x80003f80,0xbf0e3f55,0xbf6d3ec4,0xbf7bbe48
.long 0x80003f80,0xbf353f35,0xbf800000,0xbf35bf35,0x80003f80,0xbf553f0e,0xbf6dbec4,0xbe48bf7b
.long 0x80003f80,0xbf6d3ec4,0xbf35bf35,0x3ec4bf6d,0x80003f80,0xbf7b3e48,0xbec4bf6d,0x3f55bf0e
.long 0x80003f80,0xbf800000,0x8000bf80,0x3f800000,0x80003f80,0xbf7bbe48,0x3ec4bf6d,0x3f553f0e
.long 0x80003f80,0xbf6dbec4,0x3f35bf35,0x3ec43f6d,0x80003f80,0xbf55bf0e,0x3f6dbec4,0xbe483f7b
.long 0x80003f80,0xbf35bf35,0x3f800000,0xbf353f35,0x80003f80,0xbf0ebf55,0x3f6d3ec4,0xbf7b3e48
.long 0x80003f80,0xbec4bf6d,0x3f353f35,0xbf6dbec4,0x80003f80,0xbe48bf7b,0x3ec43f6d,0xbf0ebf55
.long 0x80003f80,0x8000bf80,0x80003f80,0x8000bf80,0x80003f80,0x3e48bf7b,0xbec43f6d,0x3f0ebf55
.long 0x80003f80,0x3ec4bf6d,0xbf353f35,0x3f6dbec4,0x80003f80,0x3f0ebf55,0xbf6d3ec4,0x3f7b3e48
.long 0x80003f80,0x3f35bf35,0xbf800000,0x3f353f35,0x80003f80,0x3f55bf0e,0xbf6dbec4,0x3e483f7b
.long 0x80003f80,0x3f6dbec4,0xbf35bf35,0xbec43f6d,0x80003f80,0x3f7bbe48,0xbec4bf6d,0xbf553f0e
.long 0x80003f80,0x3f800000,0x8000bf80,0xbf800000,0x80003f80,0x3f7b3e48,0x3ec4bf6d,0xbf55bf0e
.long 0x80003f80,0x3f6d3ec4,0x3f35bf35,0xbec4bf6d,0x80003f80,0x3f553f0e,0x3f6dbec4,0x3e48bf7b
.long 0x80003f80,0x3f353f35,0x3f800000,0x3f35bf35,0x80003f80,0x3f0e3f55,0x3f6d3ec4,0x3f7bbe48
.long 0x80003f80,0x3ec43f6d,0x3f353f35,0x3f6d3ec4,0x80003f80,0x3e483f7b,0x3ec43f6d,0x3f0e3f55
.long 0x80003f80,0x80003f80,0x80003f80,0x80003f80,0xbf353f35,0xbf553f0e,0xbf6d3ec4,0xbf7b3e48
.long 0xbf800000,0xbf6dbec4,0xbf35bf35,0xbec4bf6d,0xbf35bf35,0xbe48bf7b,0x3ec4bf6d,0x3f55bf0e
.long 0x8000bf80,0x3f35bf35,0x3f800000,0x3f353f35,0x3f35bf35,0x3f7b3e48,0x3ec43f6d,0xbf0e3f55
.long 0x3f800000,0x3ec43f6d,0xbf353f35,0xbf6dbec4,0x3f353f35,0xbf0e3f55,0xbf6dbec4,0x3e48bf7b
.long 0x80003f80,0xbf800000,0x8000bf80,0x3f800000,0xbf353f35,0xbf0ebf55,0x3f6dbec4,0x3e483f7b
.long 0xbf800000,0x3ec4bf6d,0x3f353f35,0xbf6d3ec4,0xbf35bf35,0x3f7bbe48,0xbec43f6d,0xbf0ebf55
.long 0x8000bf80,0x3f353f35,0xbf800000,0x3f35bf35,0x3f35bf35,0xbe483f7b,0xbec4bf6d,0x3f553f0e
.long 0x3f800000,0xbf6d3ec4,0x3f35bf35,0xbec43f6d,0x3f353f35,0xbf55bf0e,0x3f6d3ec4,0xbf7bbe48
.long 0x80003f80,0x8000bf80,0x80003f80,0x8000bf80,0xbf353f35,0x3f55bf0e,0xbf6d3ec4,0x3f7bbe48
.long 0xbf800000,0x3f6d3ec4,0xbf35bf35,0x3ec43f6d,0xbf35bf35,0x3e483f7b,0x3ec4bf6d,0xbf553f0e
.long 0x8000bf80,0xbf353f35,0x3f800000,0xbf35bf35,0x3f35bf35,0xbf7bbe48,0x3ec43f6d,0x3f0ebf55
.long 0x3f800000,0xbec4bf6d,0xbf353f35,0x3f6d3ec4,0x3f353f35,0x3f0ebf55,0xbf6dbec4,0xbe483f7b
.long 0x80003f80,0x3f800000,0x8000bf80,0xbf800000,0xbf353f35,0x3f0e3f55,0x3f6dbec4,0xbe48bf7b
.long 0xbf800000,0xbec43f6d,0x3f353f35,0x3f6dbec4,0xbf35bf35,0xbf7b3e48,0xbec43f6d,0x3f0e3f55
.long 0x8000bf80,0xbf35bf35,0xbf800000,0xbf353f35,0x3f35bf35,0x3e48bf7b,0xbec4bf6d,0xbf55bf0e
.long 0x3f800000,0x3f6dbec4,0x3f35bf35,0x3ec4bf6d,0x3f353f35,0x3f553f0e,0x3f6d3ec4,0x3f7b3e48
.long 0x80003f80,0x80003f80,0x80003f80,0x80003f80,0xbf800000,0xbf7bbe48,0xbf6dbec4,0xbf55bf0e
.long 0x8000bf80,0x3ec4bf6d,0x3f35bf35,0x3f6dbec4,0x3f800000,0x3f553f0e,0x3ec43f6d,0xbe483f7b
.long 0x80003f80,0xbf353f35,0xbf800000,0xbf35bf35,0xbf800000,0xbf0ebf55,0x3ec4bf6d,0x3f7bbe48
.long 0x8000bf80,0x3f6dbec4,0x3f353f35,0xbec43f6d,0x3f800000,0x3e483f7b,0xbf6d3ec4,0xbf0ebf55
.long 0x80003f80,0xbf800000,0x8000bf80,0x3f800000,0xbf800000,0x3e48bf7b,0x3f6d3ec4,0xbf0e3f55
.long 0x8000bf80,0x3f6d3ec4,0xbf353f35,0xbec4bf6d,0x3f800000,0xbf0e3f55,0xbec4bf6d,0x3f7b3e48
.long 0x80003f80,0xbf35bf35,0x3f800000,0xbf353f35,0xbf800000,0x3f55bf0e,0xbec43f6d,0xbe48bf7b
.long 0x8000bf80,0x3ec43f6d,0xbf35bf35,0x3f6d3ec4,0x3f800000,0xbf7b3e48,0x3f6dbec4,0xbf553f0e
.long 0x80003f80,0x8000bf80,0x80003f80,0x8000bf80,0xbf800000,0x3f7b3e48,0xbf6dbec4,0x3f553f0e
.long 0x8000bf80,0xbec43f6d,0x3f35bf35,0xbf6d3ec4,0x3f800000,0xbf55bf0e,0x3ec43f6d,0x3e48bf7b
.long 0x80003f80,0x3f35bf35,0xbf800000,0x3f353f35,0xbf800000,0x3f0e3f55,0x3ec4bf6d,0xbf7b3e48
.long 0x8000bf80,0xbf6d3ec4,0x3f353f35,0x3ec4bf6d,0x3f800000,0xbe48bf7b,0xbf6d3ec4,0x3f0e3f55
.long 0x80003f80,0x3f800000,0x8000bf80,0xbf800000,0xbf800000,0xbe483f7b,0x3f6d3ec4,0x3f0ebf55
.long 0x8000bf80,0xbf6dbec4,0xbf353f35,0x3ec43f6d,0x3f800000,0x3f0ebf55,0xbec4bf6d,0xbf7bbe48
.long 0x80003f80,0x3f353f35,0x3f800000,0x3f35bf35,0xbf800000,0xbf553f0e,0xbec43f6d,0x3e483f7b
.long 0x8000bf80,0xbec4bf6d,0xbf35bf35,0xbf6dbec4,0x3f800000,0x3f7bbe48,0x3f6dbec4,0x3f55bf0e
.long 0x80003f80,0x80003f80,0x80003f80,0x80003f80,0xbf35bf35,0xbf0ebf55,0xbec4bf6d,0xbe48bf7b
.long 0x3f800000,0x3f6d3ec4,0x3f353f35,0x3ec43f6d,0xbf353f35,0xbf7b3e48,0xbf6dbec4,0xbf0ebf55
.long 0x8000bf80,0x3f35bf35,0x3f800000,0x3f353f35,0x3f353f35,0xbe483f7b,0xbf6d3ec4,0xbf55bf0e
.long 0xbf800000,0xbec4bf6d,0x3f35bf35,0x3f6d3ec4,0x3f35bf35,0x3f553f0e,0xbec43f6d,0xbf7bbe48
.long 0x80003f80,0xbf800000,0x8000bf80,0x3f800000,0xbf35bf35,0x3f55bf0e,0x3ec43f6d,0xbf7b3e48
.long 0x3f800000,0xbec43f6d,0xbf35bf35,0x3f6dbec4,0xbf353f35,0xbe48bf7b,0x3f6d3ec4,0xbf553f0e
.long 0x8000bf80,0x3f353f35,0xbf800000,0x3f35bf35,0x3f353f35,0xbf7bbe48,0x3f6dbec4,0xbf0e3f55
.long 0xbf800000,0x3f6dbec4,0xbf353f35,0x3ec4bf6d,0x3f35bf35,0xbf0e3f55,0x3ec4bf6d,0xbe483f7b
.long 0x80003f80,0x8000bf80,0x80003f80,0x8000bf80,0xbf35bf35,0x3f0e3f55,0xbec4bf6d,0x3e483f7b
.long 0x3f800000,0xbf6dbec4,0x3f353f35,0xbec4bf6d,0xbf353f35,0x3f7bbe48,0xbf6dbec4,0x3f0e3f55
.long 0x8000bf80,0xbf353f35,0x3f800000,0xbf35bf35,0x3f353f35,0x3e48bf7b,0xbf6d3ec4,0x3f553f0e
.long 0xbf800000,0x3ec43f6d,0x3f35bf35,0xbf6dbec4,0x3f35bf35,0xbf55bf0e,0xbec43f6d,0x3f7b3e48
.long 0x80003f80,0x3f800000,0x8000bf80,0xbf800000,0xbf35bf35,0xbf553f0e,0x3ec43f6d,0x3f7bbe48
.long 0x3f800000,0x3ec4bf6d,0xbf35bf35,0xbf6d3ec4,0xbf353f35,0x3e483f7b,0x3f6d3ec4,0x3f55bf0e
.long 0x8000bf80,0xbf35bf35,0xbf800000,0xbf353f35,0x3f353f35,0x3f7b3e48,0x3f6dbec4,0x3f0ebf55
.long 0xbf800000,0xbf6d3ec4,0xbf353f35,0xbec43f6d,0x3f35bf35,0x3f0ebf55,0x3ec4bf6d,0x3e48bf7b
.long 0x80003f80,0x80003f80,0x80003f80,0x80003f80,0x8000bf80,0x3e48bf7b,0x3ec4bf6d,0x3f0ebf55
.long 0x80003f80,0xbec43f6d,0xbf353f35,0xbf6d3ec4,0x8000bf80,0x3f0ebf55,0x3f6dbec4,0x3f7b3e48
.long 0x80003f80,0xbf353f35,0xbf800000,0xbf35bf35,0x8000bf80,0x3f55bf0e,0x3f6d3ec4,0x3e483f7b
.long 0x80003f80,0xbf6d3ec4,0xbf35bf35,0x3ec4bf6d,0x8000bf80,0x3f7bbe48,0x3ec43f6d,0xbf553f0e
.long 0x80003f80,0xbf800000,0x8000bf80,0x3f800000,0x8000bf80,0x3f7b3e48,0xbec43f6d,0xbf55bf0e
.long 0x80003f80,0xbf6dbec4,0x3f35bf35,0x3ec43f6d,0x8000bf80,0x3f553f0e,0xbf6d3ec4,0x3e48bf7b
.long 0x80003f80,0xbf35bf35,0x3f800000,0xbf353f35,0x8000bf80,0x3f0e3f55,0xbf6dbec4,0x3f7bbe48
.long 0x80003f80,0xbec4bf6d,0x3f353f35,0xbf6dbec4,0x8000bf80,0x3e483f7b,0xbec4bf6d,0x3f0e3f55
.long 0x80003f80,0x8000bf80,0x80003f80,0x8000bf80,0x8000bf80,0xbe483f7b,0x3ec4bf6d,0xbf0e3f55
.long 0x80003f80,0x3ec4bf6d,0xbf353f35,0x3f6dbec4,0x8000bf80,0xbf0e3f55,0x3f6dbec4,0xbf7bbe48
.long 0x80003f80,0x3f35bf35,0xbf800000,0x3f353f35,0x8000bf80,0xbf553f0e,0x3f6d3ec4,0xbe48bf7b
.long 0x80003f80,0x3f6dbec4,0xbf35bf35,0xbec43f6d,0x8000bf80,0xbf7b3e48,0x3ec43f6d,0x3f55bf0e
.long 0x80003f80,0x3f800000,0x8000bf80,0xbf800000,0x8000bf80,0xbf7bbe48,0xbec43f6d,0x3f553f0e
.long 0x80003f80,0x3f6d3ec4,0x3f35bf35,0xbec4bf6d,0x8000bf80,0xbf55bf0e,0xbf6d3ec4,0xbe483f7b
.long 0x80003f80,0x3f353f35,0x3f800000,0x3f35bf35,0x8000bf80,0xbf0ebf55,0xbf6dbec4,0xbf7b3e48
.long 0x80003f80,0x3ec43f6d,0x3f353f35,0x3f6d3ec4,0x8000bf80,0xbe48bf7b,0xbec4bf6d,0xbf0ebf55
.long 0x80003f80,0x80003f80,0x80003f80,0x80003f80,0x3f35bf35,0x3f55bf0e,0x3f6dbec4,0x3f7bbe48
.long 0xbf800000,0xbf6dbec4,0xbf35bf35,0xbec4bf6d,0x3f353f35,0x3e483f7b,0xbec43f6d,0xbf553f0e
.long 0x8000bf80,0x3f35bf35,0x3f800000,0x3f353f35,0xbf353f35,0xbf7bbe48,0xbec4bf6d,0x3f0ebf55
.long 0x3f800000,0x3ec43f6d,0xbf353f35,0xbf6dbec4,0xbf35bf35,0x3f0ebf55,0x3f6d3ec4,0xbe483f7b
.long 0x80003f80,0xbf800000,0x8000bf80,0x3f800000,0x3f35bf35,0x3f0e3f55,0xbf6d3ec4,0xbe48bf7b
.long 0xbf800000,0x3ec4bf6d,0x3f353f35,0xbf6d3ec4,0x3f353f35,0xbf7b3e48,0x3ec4bf6d,0x3f0e3f55
.long 0x8000bf80,0x3f353f35,0xbf800000,0x3f35bf35,0xbf353f35,0x3e48bf7b,0x3ec43f6d,0xbf55bf0e
.long 0x3f800000,0xbf6d3ec4,0x3f35bf35,0xbec43f6d,0xbf35bf35,0x3f553f0e,0xbf6dbec4,0x3f7b3e48
.long 0x80003f80,0x8000bf80,0x80003f80,0x8000bf80,0x3f35bf35,0xbf553f0e,0x3f6dbec4,0xbf7b3e48
.long 0xbf800000,0x3f6d3ec4,0xbf35bf35,0x3ec43f6d,0x3f353f35,0xbe48bf7b,0xbec43f6d,0x3f55bf0e
.long 0x8000bf80,0xbf353f35,0x3f800000,0xbf35bf35,0xbf353f35,0x3f7b3e48,0xbec4bf6d,0xbf0e3f55
.long 0x3f800000,0xbec4bf6d,0xbf353f35,0x3f6d3ec4,0xbf35bf35,0xbf0e3f55,0x3f6d3ec4,0x3e48bf7b
.long 0x80003f80,0x3f800000,0x8000bf80,0xbf800000,0x3f35bf35,0xbf0ebf55,0xbf6d3ec4,0x3e483f7b
.long 0xbf800000,0xbec43f6d,0x3f353f35,0x3f6dbec4,0x3f353f35,0x3f7bbe48,0x3ec4bf6d,0xbf0ebf55
.long 0x8000bf80,0xbf35bf35,0xbf800000,0xbf353f35,0xbf353f35,0xbe483f7b,0x3ec43f6d,0x3f553f0e
.long 0x3f800000,0x3f6dbec4,0x3f35bf35,0x3ec4bf6d,0xbf35bf35,0xbf55bf0e,0xbf6dbec4,0xbf7bbe48
.long 0x80003f80,0x80003f80,0x80003f80,0x80003f80,0x3f800000,0x3f7b3e48,0x3f6d3ec4,0x3f553f0e
.long 0x8000bf80,0x3ec4bf6d,0x3f35bf35,0x3f6dbec4,0xbf800000,0xbf55bf0e,0xbec4bf6d,0x3e48bf7b
.long 0x80003f80,0xbf353f35,0xbf800000,0xbf35bf35,0x3f800000,0x3f0e3f55,0xbec43f6d,0xbf7b3e48
.long 0x8000bf80,0x3f6dbec4,0x3f353f35,0xbec43f6d,0xbf800000,0xbe48bf7b,0x3f6dbec4,0x3f0e3f55
.long 0x80003f80,0xbf800000,0x8000bf80,0x3f800000,0x3f800000,0xbe483f7b,0xbf6dbec4,0x3f0ebf55
.long 0x8000bf80,0x3f6d3ec4,0xbf353f35,0xbec4bf6d,0xbf800000,0x3f0ebf55,0x3ec43f6d,0xbf7bbe48
.long 0x80003f80,0xbf35bf35,0x3f800000,0xbf353f35,0x3f800000,0xbf553f0e,0x3ec4bf6d,0x3e483f7b
.long 0x8000bf80,0x3ec43f6d,0xbf35bf35,0x3f6d3ec4,0xbf800000,0x3f7bbe48,0xbf6d3ec4,0x3f55bf0e
.long 0x80003f80,0x8000bf80,0x80003f80,0x8000bf80,0x3f800000,0xbf7bbe48,0x3f6d3ec4,0xbf55bf0e
.long 0x8000bf80,0xbec43f6d,0x3f35bf35,0xbf6d3ec4,0xbf800000,0x3f553f0e,0xbec4bf6d,0xbe483f7b
.long 0x80003f80,0x3f35bf35,0xbf800000,0x3f353f35,0x3f800000,0xbf0ebf55,0xbec43f6d,0x3f7bbe48
.long 0x8000bf80,0xbf6d3ec4,0x3f353f35,0x3ec4bf6d,0xbf800000,0x3e483f7b,0x3f6dbec4,0xbf0ebf55
.long 0x80003f80,0x3f800000,0x8000bf80,0xbf800000,0x3f800000,0x3e48bf7b,0xbf6dbec4,0xbf0e3f55
.long 0x8000bf80,0xbf6dbec4,0xbf353f35,0x3ec43f6d,0xbf800000,0xbf0e3f55,0x3ec43f6d,0x3f7b3e48
.long 0x80003f80,0x3f353f35,0x3f800000,0x3f35bf35,0x3f800000,0x3f55bf0e,0x3ec4bf6d,0xbe48bf7b
.long 0x8000bf80,0xbec4bf6d,0xbf35bf35,0xbf6dbec4,0xbf800000,0xbf7b3e48,0xbf6d3ec4,0xbf553f0e
.long 0x80003f80,0x80003f80,0x80003f80,0x80003f80,0x3f353f35,0x3f0e3f55,0x3ec43f6d,0x3e483f7b
.long 0x3f800000,0x3f6d3ec4,0x3f353f35,0x3ec43f6d,0x3f35bf35,0x3f7bbe48,0x3f6d3ec4,0x3f0e3f55
.long 0x8000bf80,0x3f35bf35,0x3f800000,0x3f353f35,0xbf35bf35,0x3e48bf7b,0x3f6dbec4,0x3f553f0e
.long 0xbf800000,0xbec4bf6d,0x3f35bf35,0x3f6d3ec4,0xbf353f35,0xbf55bf0e,0x3ec4bf6d,0x3f7b3e48
.long 0x80003f80,0xbf800000,0x8000bf80,0x3f800000,0x3f353f35,0xbf553f0e,0xbec4bf6d,0x3f7bbe48
.long 0x3f800000,0xbec43f6d,0xbf35bf35,0x3f6dbec4,0x3f35bf35,0x3e483f7b,0xbf6dbec4,0x3f55bf0e
.long 0x8000bf80,0x3f353f35,0xbf800000,0x3f35bf35,0xbf35bf35,0x3f7b3e48,0xbf6d3ec4,0x3f0ebf55
.long 0xbf800000,0x3f6dbec4,0xbf353f35,0x3ec4bf6d,0xbf353f35,0x3f0ebf55,0xbec43f6d,0x3e48bf7b
.long 0x80003f80,0x8000bf80,0x80003f80,0x8000bf80,0x3f353f35,0xbf0ebf55,0x3ec43f6d,0xbe48bf7b
.long 0x3f800000,0xbf6dbec4,0x3f353f35,0xbec4bf6d,0x3f35bf35,0xbf7b3e48,0x3f6d3ec4,0xbf0ebf55
.long 0x8000bf80,0xbf353f35,0x3f800000,0xbf35bf35,0xbf35bf35,0xbe483f7b,0x3f6dbec4,0xbf55bf0e
.long 0xbf800000,0x3ec43f6d,0x3f35bf35,0xbf6dbec4,0xbf353f35,0x3f553f0e,0x3ec4bf6d,0xbf7bbe48
.long 0x80003f80,0x3f800000,0x8000bf80,0xbf800000,0x3f353f35,0x3f55bf0e,0xbec4bf6d,0xbf7b3e48
.long 0x3f800000,0x3ec4bf6d,0xbf35bf35,0xbf6d3ec4,0x3f35bf35,0xbe48bf7b,0xbf6dbec4,0xbf553f0e
.long 0x8000bf80,0xbf35bf35,0xbf800000,0xbf353f35,0xbf35bf35,0xbf7bbe48,0xbf6d3ec4,0xbf0e3f55
.long 0xbf800000,0xbf6d3ec4,0xbf353f35,0xbec43f6d,0xbf353f35,0xbf0e3f55,0xbec43f6d,0xbe483f7b
.size tab_inv, 16384
.p2align 8
.type tab_f2,@object
tab_f2:
.long 0x3f803f80,0x3f803f80,0x3f803f80,0x3f803f80,0x3f7b3f80,0x3f553f6d,0x3f0e3f35,0x3e483ec4
.long 0x3f6d3f80,0x3ec43f35,0xbec40000,0xbf6dbf35,0x3f553f80,0xbe483ec4,0xbf7bbf35,0xbf0ebf6d
.long 0x3f353f80,0xbf350000,0xbf35bf80,0x3f350000,0x3f0e3f80,0xbf7bbec4,0x3e48bf35,0x3f553f6d
.long 0x3ec43f80,0xbf6dbf35,0x3f6d0000,0xbec43f35,0x3e483f80,0xbf0ebf6d,0x3f553f35,0xbf7bbec4
.long 0x3f80,0xbf80,0x3f80,0xbf80,0xbe483f80,0x3f0ebf6d,0xbf553f35,0x3f7bbec4
.long 0xbec43f80,0x3f6dbf35,0xbf6d0000,0x3ec43f35,0xbf0e3f80,0x3f7bbec4,0xbe48bf35,0xbf553f6d
.long 0xbf353f80,0x3f350000,0x3f35bf80,0xbf350000,0xbf553f80,0x3e483ec4,0x3f7bbf35,0x3f0ebf6d
.long 0xbf6d3f80,0xbec43f35,0x3ec40000,0x3f6dbf35,0xbf7b3f80,0xbf553f6d,0xbf0e3f35,0xbe483ec4
.long 0xbf803f80,0xbf803f80,0xbf803f80,0xbf803f80,0xbf7b3f80,0xbf553f6d,0xbf0e3f35,0xbe483ec4
.long 0xbf6d3f80,0xbec43f35,0x3ec40000,0x3f6dbf35,0xbf553f80,0x3e483ec4,0x3f7bbf35,0x3f0ebf6d
.long 0xbf353f80,0x3f350000,0x3f35bf80,0xbf350000,0xbf0e3f80,0x3f7bbec4,0xbe48bf35,0xbf553f6d
.long 0xbec43f80,0x3f6dbf35,0xbf6d0000,0x3ec43f35,0xbe483f80,0x3f0ebf6d,0xbf553f35,0x3f7bbec4
.long 0x3f80,0xbf80,0x3f80,0xbf80,0x3e483f80,0xbf0ebf6d,0x3f553f35,0xbf7bbec4
.long 0x3ec43f80,0xbf6dbf35,0x3f6d0000,0xbec43f35,0x3f0e3f80,0xbf7bbec4,0x3e48bf35,0x3f553f6d
.long 0x3f353f80,0xbf350000,0xbf35bf80,0x3f350000,0x3f553f80,0xbe483ec4,0xbf7bbf35,0xbf0ebf6d
.long 0x3f6d3f80,0x3ec43f35,0xbec40000,0xbf6dbf35,0x3f7b3f80,0x3f553f6d,0x3f0e3f35,0x3e483ec4
.long 0x3f803f80,0x3f803f80,0x3f803f80,0x3f803f80,0xbe480000,0xbf0ebec4,0xbf55bf35,0xbf7bbf6d
.long 0xbf6dbf80,0xbec4bf35,0x3ec40000,0x3f6d3f35,0x3f0e0000,0x3f7b3f6d,0x3e483f35,0xbf55bec4
.long 0x3f353f80,0xbf350000,0xbf35bf80,0x3f350000,0xbf550000,0xbe48bf6d,0x3f7b3f35,0xbf0e3ec4
.long 0xbec4bf80,0x3f6d3f35,0xbf6d0000,0x3ec4bf35,0x3f7b0000,0xbf553ec4,0x3f0ebf35,0xbe483f6d
.long 0x3f80,0xbf80,0x3f80,0xbf80,0xbf7b0000,0x3f553ec4,0xbf0ebf35,0x3e483f6d
.long 0x3ec4bf80,0xbf6d3f35,0x3f6d0000,0xbec4bf35,0x3f550000,0x3e48bf6d,0xbf7b3f35,0x3f0e3ec4
.long 0xbf353f80,0x3f350000,0x3f35bf80,0xbf350000,0xbf0e0000,0xbf7b3f6d,0xbe483f35,0x3f55bec4
.long 0x3f6dbf80,0x3ec4bf35,0xbec40000,0xbf6d3f35,0x3e480000,0x3f0ebec4,0x3f55bf35,0x3f7bbf6d
.long 0xbf803f80,0xbf803f80,0xbf803f80,0xbf803f80,0x3e480000,0x3f0ebec4,0x3f55bf35,0x3f7bbf6d
.long 0x3f6dbf80,0x3ec4bf35,0xbec40000,0xbf6d3f35,0xbf0e0000,0xbf7b3f6d,0xbe483f35,0x3f55bec4
.long 0xbf353f80,0x3f350000,0x3f35bf80,0xbf350000,0x3f550000,0x3e48bf6d,0xbf7b3f35,0x3f0e3ec4
.long 0x3ec4bf80,0xbf6d3f35,0x3f6d0000,0xbec4bf35,0xbf7b0000,0x3f553ec4,0xbf0ebf35,0x3e483f6d
.long 0x3f80,0xbf80,0x3f80,0xbf80,0x3f7b0000,0xbf553ec4,0x3f0ebf35,0xbe483f6d
.long 0xbec4bf80,0x3f6d3f35,0xbf6d0000,0x3ec4bf35,0xbf550000,0xbe48bf6d,0x3f7b3f35,0xbf0e3ec4
.long 0x3f353f80,0xbf350000,0xbf35bf80,0x3f350000,0x3f0e0000,0x3f7b3f6d,0x3e483f35,0xbf55bec4
.long 0xbf6dbf80,0xbec4bf35,0x3ec40000,0x3f6d3f35,0xbe480000,0xbf0ebec4,0xbf55bf35,0xbf7bbf6d
.long 0x3f803f80,0x3f803f80,0x3f803f80,0x3f803f80,0xbf7bbf80,0xbf55bf6d,0xbf0ebf35,0xbe48bec4
.long 0x3f6d3f80,0x3ec43f35,0xbec40000,0xbf6dbf35,0xbf55bf80,0x3e48bec4,0x3f7b3f35,0x3f0e3f6d
.long 0x3f353f80,0xbf350000,0xbf35bf80,0x3f350000,0xbf0ebf80,0x3f7b3ec4,0xbe483f35,0xbf55bf6d
.long 0x3ec43f80,0xbf6dbf35,0x3f6d0000,0xbec43f35,0xbe48bf80,0x3f0e3f6d,0xbf55bf35,0x3f7b3ec4
.long 0x3f80,0xbf80,0x3f80,0xbf80,0x3e48bf80,0xbf0e3f6d,0x3f55bf35,0xbf7b3ec4
.long 0xbec43f80,0x3f6dbf35,0xbf6d0000,0x3ec43f35,0x3f0ebf80,0xbf7b3ec4,0x3e483f35,0x3f55bf6d
.long 0xbf353f80,0x3f350000,0x3f35bf80,0xbf350000,0x3f55bf80,0xbe48bec4,0xbf7b3f35,0xbf0e3f6d
.long 0xbf6d3f80,0xbec43f35,0x3ec40000,0x3f6dbf35,0x3f7bbf80,0x3f55bf6d,0x3f0ebf35,0x3e48bec4
.long 0xbf803f80,0xbf803f80,0xbf803f80,0xbf803f80,0x3f7bbf80,0x3f55bf6d,0x3f0ebf35,0x3e48bec4
.long 0xbf6d3f80,0xbec43f35,0x3ec40000,0x3f6dbf35,0x3f55bf80,0xbe48bec4,0xbf7b3f35,0xbf0e3f6d
.long 0xbf353f80,0x3f350000,0x3f35bf80,0xbf350000,0x3f0ebf80,0xbf7b3ec4,0x3e483f35,0x3f55bf6d
.long 0xbec43f80,0x3f6dbf35,0xbf6d0000,0x3ec43f35,0x3e48bf80,0xbf0e3f6d,0x3f55bf35,0xbf7b3ec4
.long 0x3f80,0xbf80,0x3f80,0xbf80,0xbe48bf80,0x3f0e3f6d,0xbf55bf35,0x3f7b3ec4
.long 0x3ec43f80,0xbf6dbf35,0x3f6d0000,0xbec43f35,0xbf0ebf80,0x3f7b3ec4,0xbe483f35,0xbf55bf6d
.long 0x3f353f80,0xbf350000,0xbf35bf80,0x3f350000,0xbf55bf80,0x3e48bec4,0x3f7b3f35,0x3f0e3f6d
.long 0x3f6d3f80,0x3ec43f35,0xbec40000,0xbf6dbf35,0xbf7bbf80,0xbf55bf6d,0xbf0ebf35,0xbe48bec4
.long 0x3f803f80,0x3f803f80,0x3f803f80,0x3f803f80,0x3e480000,0x3f0e3ec4,0x3f553f35,0x3f7b3f6d
.long 0xbf6dbf80,0xbec4bf35,0x3ec40000,0x3f6d3f35,0xbf0e0000,0xbf7bbf6d,0xbe48bf35,0x3f553ec4
.long 0x3f353f80,0xbf350000,0xbf35bf80,0x3f350000,0x3f550000,0x3e483f6d,0xbf7bbf35,0x3f0ebec4
.long 0xbec4bf80,0x3f6d3f35,0xbf6d0000,0x3ec4bf35,0xbf7b0000,0x3f55bec4,0xbf0e3f35,0x3e48bf6d
.long 0x3f80,0xbf80,0x3f80,0xbf80,0x3f7b0000,0xbf55bec4,0x3f0e3f35,0xbe48bf6d
.long 0x3ec4bf80,0xbf6d3f35,0x3f6d0000,0xbec4bf35,0xbf550000,0xbe483f6d,0x3f7bbf35,0xbf0ebec4
.long 0xbf353f80,0x3f350000,0x3f35bf80,0xbf350000,0x3f0e0000,0x3f7bbf6d,0x3e48bf35,0xbf553ec4
.long 0x3f6dbf80,0x3ec4bf35,0xbec40000,0xbf6d3f35,0xbe480000,0xbf0e3ec4,0xbf553f35,0xbf7b3f6d
.long 0xbf803f80,0xbf803f80,0xbf803f80,0xbf803f80,0xbe480000,0xbf0e3ec4,0xbf553f35,0xbf7b3f6d
.long 0x3f6dbf80,0x3ec4bf35,0xbec40000,0xbf6d3f35,0x3f0e0000,0x3f7bbf6d,0x3e48bf35,0xbf553ec4
.long 0xbf353f80,0x3f350000,0x3f35bf80,0xbf350000,0xbf550000,0xbe483f6d,0x3f7bbf35,0xbf0ebec4
.long 0x3ec4bf80,0xbf6d3f35,0x3f6d0000,0xbec4bf35,0x3f7b0000,0xbf55bec4,0x3f0e3f35,0xbe48bf6d
.long 0x3f80,0xbf80,0x3f80,0xbf80,0xbf7b0000,0x3f55bec4,0xbf0e3f35,0x3e48bf6d
.long 0xbec4bf80,0x3f6d3f35,0xbf6d0000,0x3ec4bf35,0x3f550000,0x3e483f6d,0xbf7bbf35,0x3f0ebec4
.long 0x3f353f80,0xbf350000,0xbf35bf80,0x3f350000,0xbf0e0000,0xbf7bbf6d,0xbe48bf35,0x3f553ec4
.long 0xbf6dbf80,0xbec4bf35,0x3ec40000,0x3f6d3f35,0x3e480000,0x3f0e3ec4,0x3f553f35,0x3f7b3f6d
.long 0x80008000,0x80008000,0x80008000,0x80008000,0xbe488000,0xbf0ebec4,0xbf55bf35,0xbf7bbf6d
.long 0xbec48000,0xbf6dbf35,0xbf6dbf80,0xbec4bf35,0xbf0e8000,0xbf7bbf6d,0xbe48bf35,0x3f553ec4
.long 0xbf358000,0xbf35bf80,0x3f358000,0x3f353f80,0xbf558000,0xbe48bf6d,0x3f7b3f35,0xbf0e3ec4
.long 0xbf6d8000,0x3ec4bf35,0x3ec43f80,0xbf6dbf35,0xbf7b8000,0x3f55bec4,0xbf0e3f35,0x3e48bf6d
.long 0xbf808000,0x3f808000,0xbf808000,0x3f808000,0xbf7b8000,0x3f553ec4,0xbf0ebf35,0x3e483f6d
.long 0xbf6d8000,0x3ec43f35,0x3ec4bf80,0xbf6d3f35,0xbf558000,0xbe483f6d,0x3f7bbf35,0xbf0ebec4
.long 0xbf358000,0xbf353f80,0x3f358000,0x3f35bf80,0xbf0e8000,0xbf7b3f6d,0xbe483f35,0x3f55bec4
.long 0xbec48000,0xbf6d3f35,0xbf6d3f80,0xbec43f35,0xbe488000,0xbf0e3ec4,0xbf553f35,0xbf7b3f6d
.long 0x80008000,0x80008000,0x80008000,0x80008000,0x3e488000,0x3f0ebec4,0x3f55bf35,0x3f7bbf6d
.long 0x3ec48000,0x3f6dbf35,0x3f6dbf80,0x3ec4bf35,0x3f0e8000,0x3f7bbf6d,0x3e48bf35,0xbf553ec4
.long 0x3f358000,0x3f35bf80,0xbf358000,0xbf353f80,0x3f558000,0x3e48bf6d,0xbf7b3f35,0x3f0e3ec4
.long 0x3f6d8000,0xbec4bf35,0xbec43f80,0x3f6dbf35,0x3f7b8000,0xbf55bec4,0x3f0e3f35,0xbe48bf6d
.long 0x3f808000,0xbf808000,0x3f808000,0xbf808000,0x3f7b8000,0xbf553ec4,0x3f0ebf35,0xbe483f6d
.long 0x3f6d8000,0xbec43f35,0xbec4bf80,0x3f6d3f35,0x3f558000,0x3e483f6d,0xbf7bbf35,0x3f0ebec4
.long 0x3f358000,0x3f353f80,0xbf358000,0xbf35bf80,0x3f0e8000,0x3f7b3f6d,0x3e483f35,0xbf55bec4
.long 0x3ec48000,0x3f6d3f35,0x3f6d3f80,0x3ec43f35,0x3e488000,0x3f0e3ec4,0x3f553f35,0x3f7b3f6d
.long 0x80008000,0x80008000,0x80008000,0x80008000,0xbf7bbf80,0xbf55bf6d,0xbf0ebf35,0xbe48bec4
.long 0x3ec48000,0x3f6d3f35,0x3f6d3f80,0x3ec43f35,0x3f553f80,0xbe483ec4,0xbf7bbf35,0xbf0ebf6d
.long 0xbf358000,0xbf35bf80,0x3f358000,0x3f353f80,0xbf0ebf80,0x3f7b3ec4,0xbe483f35,0xbf55bf6d
.long 0x3f6d8000,0xbec43f35,0xbec4bf80,0x3f6d3f35,0x3e483f80,0xbf0ebf6d,0x3f553f35,0xbf7bbec4
.long 0xbf808000,0x3f808000,0xbf808000,0x3f808000,0x3e48bf80,0xbf0e3f6d,0x3f55bf35,0xbf7b3ec4
.long 0x3f6d8000,0xbec4bf35,0xbec43f80,0x3f6dbf35,0xbf0e3f80,0x3f7bbec4,0xbe48bf35,0xbf553f6d
.long 0xbf358000,0xbf353f80,0x3f358000,0x3f35bf80,0x3f55bf80,0xbe48bec4,0xbf7b3f35,0xbf0e3f6d
.long 0x3ec48000,0x3f6dbf35,0x3f6dbf80,0x3ec4bf35,0xbf7b3f80,0xbf553f6d,0xbf0e3f35,0xbe483ec4
.long 0x80008000,0x80008000,0x80008000,0x80008000,0x3f7bbf80,0x3f55bf6d,0x3f0ebf35,0x3e48bec4
.long 0xbec48000,0xbf6d3f35,0xbf6d3f80,0xbec43f35,0xbf553f80,0x3e483ec4,0x3f7bbf35,0x3f0ebf6d
.long 0x3f358000,0x3f35bf80,0xbf358000,0xbf353f80,0x3f0ebf80,0xbf7b3ec4,0x3e483f35,0x3f55bf6d
.long 0xbf6d8000,0x3ec43f35,0x3ec4bf80,0xbf6d3f35,0xbe483f80,0x3f0ebf6d,0xbf553f35,0x3f7bbec4
.long 0x3f808000,0xbf808000,0x3f808000,0xbf808000,0xbe48bf80,0x3f0e3f6d,0xbf55bf35,0x3f7b3ec4
.long 0xbf6d8000,0x3ec4bf35,0x3ec43f80,0xbf6dbf35,0x3f0e3f80,0xbf7bbec4,0x3e48bf35,0x3f553f6d
.long 0x3f358000,0x3f353f80,0xbf358000,0xbf35bf80,0xbf55bf80,0x3e48bec4,0x3f7b3f35,0x3f0e3f6d
.long 0xbec48000,0xbf6dbf35,0xbf6dbf80,0xbec4bf35,0x3f7b3f80,0x3f553f6d,0x3f0e3f35,0x3e483ec4
.long 0x80008000,0x80008000,0x80008000,0x80008000,0x3e488000,0x3f0e3ec4,0x3f553f35,0x3f7b3f6d
.long 0xbec48000,0xbf6dbf35,0xbf6dbf80,0xbec4bf35,0x3f0e8000,0x3f7b3f6d,0x3e483f35,0xbf55bec4
.long 0xbf358000,0xbf35bf80,0x3f358000,0x3f353f80,0x3f558000,0x3e483f6d,0xbf7bbf35,0x3f0ebec4
.long 0xbf6d8000,0x3ec4bf35,0x3ec43f80,0xbf6dbf35,0x3f7b8000,0xbf553ec4,0x3f0ebf35,0xbe483f6d
.long 0xbf808000,0x3f808000,0xbf808000,0x3f808000,0x3f7b8000,0xbf55bec4,0x3f0e3f35,0xbe48bf6d
.long 0xbf6d8000,0x3ec43f35,0x3ec4bf80,0xbf6d3f35,0x3f558000,0x3e48bf6d,0xbf7b3f35,0x3f0e3ec4
.long 0xbf358000,0xbf353f80,0x3f358000,0x3f35bf80,0x3f0e8000,0x3f7bbf6d,0x3e48bf35,0xbf553ec4
.long 0xbec48000,0xbf6d3f35,0xbf6d3f80,0xbec43f35,0x3e488000,0x3f0ebec4,0x3f55bf35,0x3f7bbf6d
.long 0x80008000,0x80008000,0x80008000,0x80008000,0xbe488000,0xbf0e3ec4,0xbf553f35,0xbf7b3f6d
.long 0x3ec48000,0x3f6dbf35,0x3f6dbf80,0x3ec4bf35,0xbf0e8000,0xbf7b3f6d,0xbe483f35,0x3f55bec4
.long 0x3f358000,0x3f35bf80,0xbf358000,0xbf353f80,0xbf558000,0xbe483f6d,0x3f7bbf35,0xbf0ebec4
.long 0x3f6d8000,0xbec4bf35,0xbec43f80,0x3f6dbf35,0xbf7b8000,0x3f553ec4,0xbf0ebf35,0x3e483f6d
.long 0x3f808000,0xbf808000,0x3f808000,0xbf808000,0xbf7b8000,0x3f55bec4,0xbf0e3f35,0x3e48bf6d
.long 0x3f6d8000,0xbec43f35,0xbec4bf80,0x3f6d3f35,0xbf558000,0xbe48bf6d,0x3f7b3f35,0xbf0e3ec4
.long 0x3f358000,0x3f353f80,0xbf358000,0xbf35bf80,0xbf0e8000,0xbf7bbf6d,0xbe48bf35,0x3f553ec4
.long 0x3ec48000,0x3f6d3f35,0x3f6d3f80,0x3ec43f35,0xbe488000,0xbf0ebec4,0xbf55bf35,0xbf7bbf6d
.long 0x80008000,0x80008000,0x80008000,0x80008000,0x3f7b3f80,0x3f553f6d,0x3f0e3f35,0x3e483ec4
.long 0x3ec48000,0x3f6d3f35,0x3f6d3f80,0x3ec43f35,0xbf55bf80,0x3e48bec4,0x3f7b3f35,0x3f0e3f6d
.long 0xbf358000,0xbf35bf80,0x3f358000,0x3f353f80,0x3f0e3f80,0xbf7bbec4,0x3e48bf35,0x3f553f6d
.long 0x3f6d8000,0xbec43f35,0xbec4bf80,0x3f6d3f35,0xbe48bf80,0x3f0e3f6d,0xbf55bf35,0x3f7b3ec4
.long 0xbf808000,0x3f808000,0xbf808000,0x3f808000,0xbe483f80,0x3f0ebf6d,0xbf553f35,0x3f7bbec4
.long 0x3f6d8000,0xbec4bf35,0xbec43f80,0x3f6dbf35,0x3f0ebf80,0xbf7b3ec4,0x3e483f35,0x3f55bf6d
.long 0xbf358000,0xbf353f80,0x3f358000,0x3f35bf80,0xbf553f80,0x3e483ec4,0x3f7bbf35,0x3f0ebf6d
.long 0x3ec48000,0x3f6dbf35,0x3f6dbf80,0x3ec4bf35,0x3f7bbf80,0x3f55bf6d,0x3f0ebf35,0x3e48bec4
.long 0x80008000,0x80008000,0x80008000,0x80008000,0xbf7b3f80,0xbf553f6d,0xbf0e3f35,0xbe483ec4
.long 0xbec48000,0xbf6d3f35,0xbf6d3f80,0xbec43f35,0x3f55bf80,0xbe48bec4,0xbf7b3f35,0xbf0e3f6d
.long 0x3f358000,0x3f35bf80,0xbf358000,0xbf353f80,0xbf0e3f80,0x3f7bbec4,0xbe48bf35,0xbf553f6d
.long 0xbf6d8000,0x3ec43f35,0x3ec4bf80,0xbf6d3f35,0x3e48bf80,0xbf0e3f6d,0x3f55bf35,0xbf7b3ec4
.long 0x3f808000,0xbf808000,0x3f808000,0xbf808000,0x3e483f80,0xbf0ebf6d,0x3f553f35,0xbf7bbec4
.long 0xbf6d8000,0x3ec4bf35,0x3ec43f80,0xbf6dbf35,0xbf0ebf80,0x3f7b3ec4,0xbe483f35,0xbf55bf6d
.long 0x3f358000,0x3f353f80,0xbf358000,0xbf35bf80,0x3f553f80,0xbe483ec4,0xbf7bbf35,0xbf0ebf6d
.long 0xbec48000,0xbf6dbf35,0xbf6dbf80,0xbec4bf35,0xbf7bbf80,0xbf55bf6d,0xbf0ebf35,0xbe48bec4
.long 0x3f800000,0x3f800000,0x3f800000,0x3f800000,0x3f800000,0x3f7ffec4,0x3f7ffb11,0x3f7ff4e6
.long 0x3f800000,0x3f7ffb11,0x3f7fec43,0x3f7fd397,0x3f800000,0x3f7ff4e6,0x3f7fd397,0x3f7f9c18
.long 0x3f800000,0x3f7fec43,0x3f7fb10f,0x3f7f4e6d,0x3f800000,0x3f7fe129,0x3f7f84ab,0x3f7eea9d
.long 0x3f800000,0x3f7fd397,0x3f7f4e6d,0x3f7e70b0,0x3f800000,0x3f7fc38f,0x3f7f0e58,0x3f7de0b1
.long 0x3f800000,0x3f7fb10f,0x3f7ec46d,0x3f7d3aac,0x3f800000,0x3f7f9c18,0x3f7e70b0,0x3f7c7eb0
.long 0x3f800000,0x3f7f84ab,0x3f7e1324,0x3f7baccd,0x3f800000,0x3f7f6ac7,0x3f7dabcc,0x3f7ac516
.long 0x3f800000,0x3f7f4e6d,0x3f7d3aac,0x3f79c79d,0x3f800000,0x3f7f2f9d,0x3f7cbfc9,0x3f78b47b
.long 0x3f800000,0x3f7f0e58,0x3f7c3b28,0x3f778bc5,0x3f800000,0x3f7eea9d,0x3f7baccd,0x3f764d97
.long 0x3f800000,0x3f7ec46d,0x3f7b14be,0x3f74fa0b,0x3f800000,0x3f7e9bc9,0x3f7a7302,0x3f73913f
.long 0x3f800000,0x3f7e70b0,0x3f79c79d,0x3f721352,0x3f800000,0x3f7e4323,0x3f791298,0x3f708066
.long 0x3f800000,0x3f7e1324,0x3f7853f8,0x3f6ed89e,0x3f800000,0x3f7de0b1,0x3f778bc5,0x3f6d1c1d
.long 0x3f800000,0x3f7dabcc,0x3f76ba07,0x3f6b4b0c,0x3f800000,0x3f7d7474,0x3f75dec6,0x3f696591
.long 0x3f800000,0x3f7d3aac,0x3f74fa0b,0x3f676bd8,0x3f800000,0x3f7cfe73,0x3f740bdd,0x3f655e0b
.long 0x3f800000,0x3f7cbfc9,0x3f731447,0x3f633c5a,0x3f800000,0x3f7c7eb0,0x3f721352,0x3f6106f2
.long 0x3f800000,0x3f7c3b28,0x3f710908,0x3f5ebe05,0x3f800000,0x3f7bf531,0x3f6ff573,0x3f5c61c7
.long 0x3f800000,0x3f7baccd,0x3f6ed89e,0x3f59f26a,0x3f800000,0x3f7b61fc,0x3f6db293,0x3f577026
.long 0x3f800000,0x3f800000,0x3f800000,0x3f800000,0x3f7fec43,0x3f7fe129,0x3f7fd397,0x3f7fc38f
.long 0x3f7fb10f,0x3f7f84ab,0x3f7f4e6d,0x3f7f0e58,0x3f7f4e6d,0x3f7eea9d,0x3f7e70b0,0x3f7de0b1
.long 0x3f7ec46d,0x3f7e1324,0x3f7d3aac,0x3f7c3b28,0x3f7e1324,0x3f7cfe73,0x3f7baccd,0x3f7a1e84
.long 0x3f7d3aac,0x3f7baccd,0x3f79c79d,0x3f778bc5,0x3f7c3b28,0x3f7a1e84,0x3f778bc5,0x3f748422
.long 0x3f7b14be,0x3f7853f8,0x3f74fa0b,0x3f710908,0x3f79c79d,0x3f764d97,0x3f721352,0x3f6d1c1d
.long 0x3f7853f8,0x3f740bdd,0x3f6ed89e,0x3f68bf3c,0x3f76ba07,0x3f718f57,0x3f6b4b0c,0x3f63f473
.long 0x3f74fa0b,0x3f6ed89e,0x3f676bd8,0x3f5ebe05,0x3f731447,0x3f6be858,0x3f633c5a,0x3f591e6a
.long 0x3f710908,0x3f68bf3c,0x3f5ebe05,0x3f531849,0x3f6ed89e,0x3f655e0b,0x3f59f26a,0x3f4cae79
.long 0x3f6c835e,0x3f61c598,0x3f54db31,0x3f45e403,0x3f6a09a7,0x3f5df6be,0x3f4f7a1f,0x3f3ebc1b
.long 0x3f676bd8,0x3f59f26a,0x3f49d112,0x3f373a23,0x3f64aa59,0x3f55b993,0x3f43e200,0x3f2f61a5
.long 0x3f61c598,0x3f514d3d,0x3f3daef9,0x3f273656,0x3f5ebe05,0x3f4cae79,0x3f373a23,0x3f1ebc12
.long 0x3f5b941a,0x3f47de65,0x3f3085bb,0x3f15f6d9,0x3f584853,0x3f42de29,0x3f299415,0x3f0cead0
.long 0x3f54db31,0x3f3daef9,0x3f226799,0x3f039c3d,0x3f514d3d,0x3f385216,0x3f1b02c6,0x3ef41f07
.long 0x3f4d9f02,0x3f32c8c9,0x3f13682a,0x3ee0924f,0x3f49d112,0x3f2d1469,0x3f0b9a6b,0x3ecc9b8b
.long 0x3f45e403,0x3f273656,0x3f039c3d,0x3eb8442a,0x3f41d870,0x3f212ff9,0x3ef6e0cb,0x3ea395c5
.long 0x3f3daef9,0x3f1b02c6,0x3ee63375,0x3e8e9a22,0x3f396842,0x3f14b039,0x3ed53641,0x3e72b651
.long 0x3f800000,0x3f800000,0x3f800000,0x3f800000,0x3f7fb10f,0x3f7f9c18,0x3f7f84ab,0x3f7f6ac7
.long 0x3f7ec46d,0x3f7e70b0,0x3f7e1324,0x3f7dabcc,0x3f7d3aac,0x3f7c7eb0,0x3f7baccd,0x3f7ac516
.long 0x3f7b14be,0x3f79c79d,0x3f7853f8,0x3f76ba07,0x3f7853f8,0x3f764d97,0x3f740bdd,0x3f718f57
.long 0x3f74fa0b,0x3f721352,0x3f6ed89e,0x3f6b4b0c,0x3f710908,0x3f6d1c1d,0x3f68bf3c,0x3f63f473
.long 0x3f6c835e,0x3f676bd8,0x3f61c598,0x3f5b941a,0x3f676bd8,0x3f6106f2,0x3f59f26a,0x3f5233c6
.long 0x3f61c598,0x3f59f26a,0x3f514d3d,0x3f47de65,0x3f5b941a,0x3f5233c6,0x3f47de65,0x3f3ca003
.long 0x3f54db31,0x3f49d112,0x3f3daef9,0x3f3085bb,0x3f4d9f02,0x3f40d0da,0x3f32c8c9,0x3f239da9
.long 0x3f45e403,0x3f373a23,0x3f273656,0x3f15f6d9,0x3f3daef9,0x3f2d1469,0x3f1b02c6,0x3f07a136
.long 0x3f3504f3,0x3f226799,0x3f0e39da,0x3ef15aea,0x3f2beb4a,0x3f173c07,0x3f00e7e4,0x3ed25a09
.long 0x3f226799,0x3f0b9a6b,0x3ee63375,0x3eb263ef,0x3f187fc0,0x3eff17b2,0x3ec9b953,0x3e919ddd
.long 0x3f0e39da,0x3ee63375,0x3eac7cd4,0x3e605c13,0x3f039c3d,0x3ecc9b8b,0x3e8e9a22,0x3e1c76de
.long 0x3ef15aea,0x3eb263ef,0x3e605c13,0x3dafb680,0x3edae880,0x3e97a117,0x3e22abb6,0x3c96c9b6
.long 0x3ec3ef15,0x3e78cfcc,0x3dc8bd36,0xbd48fb30,0x3eac7cd4,0x3e419b37,0x3d16c32c,0xbdee3876
.long 0x3e94a031,0x3e09cf86,0xbcc90ab0,0xbe3b6ecf,0x3e78cfcc,0x3da3308c,0xbdafb680,0xbe7ee6e1
.long 0x3e47c5c2,0x3cc90ab0,0xbe164083,0xbea09ae5,0x3e164083,0xbcfb49ba,0xbe541501,0xbec1071e
.long 0x3dc8bd36,0xbdafb680,0xbe888e93,0xbee0924f,0x3d48fb30,0xbe1008b7,0xbea68f12,0xbeff17b2
.long 0x3f800000,0x3f800000,0x3f800000,0x3f800000,0x3f7f4e6d,0x3f7f2f9d,0x3f7f0e58,0x3f7eea9d
.long 0x3f7d3aac,0x3f7cbfc9,0x3f7c3b28,0x3f7baccd,0x3f79c79d,0x3f78b47b,0x3f778bc5,0x3f764d97
.long 0x3f74fa0b,0x3f731447,0x3f710908,0x3f6ed89e,0x3f6ed89e,0x3f6be858,0x3f68bf3c,0x3f655e0b
.long 0x3f676bd8,0x3f633c5a,0x3f5ebe05,0x3f59f26a,0x3f5ebe05,0x3f591e6a,0x3f531849,0x3f4cae79
.long 0x3f54db31,0x3f4d9f02,0x3f45e403,0x3f3daef9,0x3f49d112,0x3f40d0da,0x3f373a23,0x3f2d1469
.long 0x3f3daef9,0x3f32c8c9,0x3f273656,0x3f1b02c6,0x3f3085bb,0x3f239da9,0x3f15f6d9,0x3f07a136
.long 0x3f226799,0x3f13682a,0x3f039c3d,0x3ee63375,0x3f13682a,0x3f0242b1,0x3ee0924f,0x3ebb31a0
.long 0x3f039c3d,0x3ee0924f,0x3eb8442a,0x3e8e9a22,0x3ee63375,0x3ebb31a0,0x3e8e9a22,0x3e419b37
.long 0x3ec3ef15,0x3e94a031,0x3e47c5c2,0x3dc8bd36,0x3ea09ae5,0x3e5a3997,0x3de1bc2e,0x3bc90f88
.long 0x3e78cfcc,0x3e09cf86,0x3cc90ab0,0xbdafb680,0x3e2f10a2,0x3d621469,0xbd7b2b74,0xbe354098
.long 0x3dc8bd36,0xbcc90ab0,0xbe164083,0xbe888e93,0x3cc90ab0,0xbdd53db9,0xbe6c9a7f,0xbeb554ec
.long 0xbd48fb30,0xbe3b6ecf,0xbea09ae5,0xbee0924f,0xbdfab273,0xbe8586ce,0xbec9b953,0xbf04f484
.long 0xbe47c5c2,0xbeac7cd4,0xbef15aea,0xbf187fc0,0xbe888e93,0xbed25a09,0xbf0b9a6b,0xbf2ac082
.long 0xbeac7cd4,0xbef6e0cb,0xbf1d7fd1,0xbf3b8f3b,0xbecf7bca,0xbf0cead0,0xbf2e3bde,0xbf4ac77f
.long 0xbef15aea,0xbf1d7fd1,0xbf3daef9,0xbf584853,0xbf08f59b,0xbf2d1469,0xbf4bbbf8,0xbf63f473
.long 0xbf187fc0,0xbf3b8f3b,0xbf584853,0xbf6db293,0xbf273656,0xbf48d8b3,0xbf633c5a,0xbf756d97
.long 0x3f800000,0x3f800000,0x3f800000,0x3f800000,0x3f7ec46d,0x3f7e9bc9,0x3f7e70b0,0x3f7e4323
.long 0x3f7b14be,0x3f7a7302,0x3f79c79d,0x3f791298,0x3f74fa0b,0x3f73913f,0x3f721352,0x3f708066
.long 0x3f6c835e,0x3f6a09a7,0x3f676bd8,0x3f64aa59,0x3f61c598,0x3f5df6be,0x3f59f26a,0x3f55b993
.long 0x3f54db31,0x3f4f7a1f,0x3f49d112,0x3f43e200,0x3f45e403,0x3f3ebc1b,0x3f373a23,0x3f2f61a5
.long 0x3f3504f3,0x3f2beb4a,0x3f226799,0x3f187fc0,0x3f226799,0x3f173c07,0x3f0b9a6b,0x3eff17b2
.long 0x3f0e39da,0x3f00e7e4,0x3ee63375,0x3ec9b953,0x3ef15aea,0x3ed25a09,0x3eb263ef,0x3e919ddd
.long 0x3ec3ef15,0x3ea09ae5,0x3e78cfcc,0x3e2f10a2,0x3e94a031,0x3e5a3997,0x3e09cf86,0x3d621469
.long 0x3e47c5c2,0x3de1bc2e,0x3cc90ab0,0xbd7b2b74,0x3dc8bd36,0x3bc90f88,0xbdafb680,0xbe354098
.long 0x0,0xbdc8bd36,0xbe47c5c2,0xbe94a031,0xbdc8bd36,0xbe4dee60,0xbe9aa086,0xbecc9b8b
.long 0xbe47c5c2,0xbe9aa086,0xbecf7bca,0xbf00e7e4,0xbe94a031,0xbecc9b8b,0xbf00e7e4,0xbf19c200
.long 0xbec3ef15,0xbefc5d27,0xbf187fc0,0xbf3085bb,0xbef15aea,0xbf14b039,0xbf2e3bde,0xbf44e3f5
.long 0xbf0e39da,0xbf299415,0xbf41d870,0xbf5695e5,0xbf226799,0xbf3ca003,0xbf531849,0xbf655e0b
.long 0xbf3504f3,0xbf4d9f02,0xbf61c598,0xbf710908,0xbf45e403,0xbf5c61c7,0xbf6db293,0xbf796e4e
.long 0xbf54db31,0xbf68bf3c,0xbf76ba07,0xbf7e70b0,0xbf61c598,0xbf7294f8,0xbf7cbfc9,0xbf7ffec4
.long 0xbf6c835e,0xbf79c79d,0xbf7fb10f,0xbf7e1324,0xbf74fa0b,0xbf7e4323,0xbf7f84ab,0xbf78b47b
.long 0xbf7b14be,0xbf7ffb11,0xbf7c3b28,0xbf6ff573,0xbf7ec46d,0xbf7eea9d,0xbf75dec6,0xbf63f473
.long 0x3f800000,0x3f800000,0x3f800000,0x3f800000,0x3f7e1324,0x3f7de0b1,0x3f7dabcc,0x3f7d7474
.long 0x3f7853f8,0x3f778bc5,0x3f76ba07,0x3f75dec6,0x3f6ed89e,0x3f6d1c1d,0x3f6b4b0c,0x3f696591
.long 0x3f61c598,0x3f5ebe05,0x3f5b941a,0x3f584853,0x3f514d3d,0x3f4cae79,0x3f47de65,0x3f42de29
.long 0x3f3daef9,0x3f373a23,0x3f3085bb,0x3f299415,0x3f273656,0x3f1ebc12,0x3f15f6d9,0x3f0cead0
.long 0x3f0e39da,0x3f039c3d,0x3ef15aea,0x3edae880,0x3ee63375,0x3ecc9b8b,0x3eb263ef,0x3e97a117
.long 0x3eac7cd4,0x3e8e9a22,0x3e605c13,0x3e22abb6,0x3e605c13,0x3e1c76de,0x3dafb680,0x3c96c9b6
.long 0x3dc8bd36,0x3cc90ab0,0xbd48fb30,0xbdfab273,0xbcc90ab0,0xbdd53db9,0xbe3b6ecf,0xbe8586ce
.long 0xbe164083,0xbe6c9a7f,0xbea09ae5,0xbec9b953,0xbe888e93,0xbeb554ec,0xbee0924f,0xbf04f484
.long 0xbec3ef15,0xbef15aea,0xbf0e39da,0xbf226799,0xbefc5d27,0xbf14b039,0xbf299415,0xbf3ca003
.long 0xbf187fc0,0xbf2e3bde,0xbf41d870,0xbf531849,0xbf3085bb,0xbf44e3f5,0xbf5695e5,0xbf655e0b
.long 0xbf45e403,0xbf584853,0xbf676bd8,0xbf731447,0xbf584853,0xbf6816a8,0xbf740bdd,0xbf7bf531
.long 0xbf676bd8,0xbf740bdd,0xbf7c3b28,0xbf7fd397,0xbf731447,0xbf7bf531,0xbf7fd397,0xbf7e9bc9
.long 0xbf7b14be,0xbf7fb10f,0xbf7ec46d,0xbf7853f8,0xbf7f4e6d,0xbf7f2f9d,0xbf791298,0xbf6d1c1d
.long 0xbf7fb10f,0xbf7a7302,0xbf6ed89e,0xbf5d2d53,0xbf7c3b28,0xbf718f57,0xbf604621,0xbf48d8b3
.long 0xbf74fa0b,0xbf64aa59,0xbf4d9f02,0xbf3085bb,0xbf6a09a7,0xbf53fac3,0xbf373a23,0xbf14b039
.long 0xbf5b941a,0xbf3fc767,0xbf1d7fd1,0xbeebcbbb,0xbf49d112,0xbf286605,0xbf00e7e4,0xbea986c4
.long 0x3f800000,0x3f800000,0x3f800000,0x3f800000,0x3f7d3aac,0x3f7cfe73,0x3f7cbfc9,0x3f7c7eb0
.long 0x3f74fa0b,0x3f740bdd,0x3f731447,0x3f721352,0x3f676bd8,0x3f655e0b,0x3f633c5a,0x3f6106f2
.long 0x3f54db31,0x3f514d3d,0x3f4d9f02,0x3f49d112,0x3f3daef9,0x3f385216,0x3f32c8c9,0x3f2d1469
.long 0x3f226799,0x3f1b02c6,0x3f13682a,0x3f0b9a6b,0x3f039c3d,0x3ef41f07,0x3ee0924f,0x3ecc9b8b
.long 0x3ec3ef15,0x3eac7cd4,0x3e94a031,0x3e78cfcc,0x3e78cfcc,0x3e419b37,0x3e09cf86,0x3da3308c
.long 0x3dc8bd36,0x3d16c32c,0xbcc90ab0,0xbdafb680,0xbd48fb30,0xbdee3876,0xbe3b6ecf,0xbe7ee6e1
.long 0xbe47c5c2,0xbe888e93,0xbeac7cd4,0xbecf7bca,0xbeac7cd4,0xbed25a09,0xbef6e0cb,0xbf0cead0
.long 0xbef15aea,0xbf0b9a6b,0xbf1d7fd1,0xbf2e3bde,0xbf187fc0,0xbf2ac082,0xbf3b8f3b,0xbf4ac77f
.long 0xbf3504f3,0xbf45e403,0xbf54db31,0xbf61c598,0xbf4d9f02,0xbf5c61c7,0xbf68bf3c,0xbf7294f8
.long 0xbf61c598,0xbf6db293,0xbf76ba07,0xbf7cbfc9,0xbf710908,0xbf796e4e,0xbf7e70b0,0xbf7ffec4
.long 0xbf7b14be,0xbf7f4e6d,0xbf7fb10f,0xbf7c3b28,0xbf7fb10f,0xbf7f2f9d,0xbf7a7302,0xbf718f57
.long 0xbf7ec46d,0xbf791298,0xbf6ed89e,0xbf604621,0xbf7853f8,0xbf6d1c1d,0xbf5d2d53,0xbf48d8b3
.long 0xbf6c835e,0xbf5b941a,0xbf45e403,0xbf2beb4a,0xbf5b941a,0xbf44e3f5,0xbf299415,0xbf0a48ad
.long 0xbf45e403,0xbf299415,0xbf08f59b,0xbec9b953,0xbf2beb4a,0xbf0a48ad,0xbec9b953,0xbe72b651
.long 0xbf0e39da,0xbecf7bca,0xbe78cfcc,0xbd96a905,0xbedae880,0xbe8586ce,0xbdafb680,0x3dbc3ac3
.long 0xbe94a031,0xbde1bc2e,0x3d96a905,0x3e827dc0,0xbe164083,0x3d2fe007,0x3e6c9a7f,0x3ed25a09
.long 0x3f800000,0x3f800000,0x3f800000,0x3f800000,0x3f7c3b28,0x3f7bf531,0x3f7baccd,0x3f7b61fc
.long 0x3f710908,0x3f6ff573,0x3f6ed89e,0x3f6db293,0x3f5ebe05,0x3f5c61c7,0x3f59f26a,0x3f577026
.long 0x3f45e403,0x3f41d870,0x3f3daef9,0x3f396842,0x3f273656,0x3f212ff9,0x3f1b02c6,0x3f14b039
.long 0x3f039c3d,0x3ef6e0cb,0x3ee63375,0x3ed53641,0x3eb8442a,0x3ea395c5,0x3e8e9a22,0x3e72b651
.long 0x3e47c5c2,0x3e164083,0x3dc8bd36,0x3d48fb30,0x3cc90ab0,0xbcfb49ba,0xbdafb680,0xbe1008b7
.long 0xbe164083,0xbe541501,0xbe888e93,0xbea68f12,0xbea09ae5,0xbec1071e,0xbee0924f,0xbeff17b2
.long 0xbef15aea,0xbf08f59b,0xbf187fc0,0xbf273656,0xbf1d7fd1,0xbf2d1469,0xbf3b8f3b,0xbf48d8b3
.long 0xbf3daef9,0xbf4bbbf8,0xbf584853,0xbf633c5a,0xbf584853,0xbf63f473,0xbf6db293,0xbf756d97
.long 0xbf6c835e,0xbf74fa0b,0xbf7b14be,0xbf7ec46d,0xbf79c79d,0xbf7e4323,0xbf7ffb11,0xbf7eea9d
.long 0xbf7fb10f,0xbf7f84ab,0xbf7c3b28,0xbf75dec6,0xbf7e1324,0xbf78b47b,0xbf6ff573,0xbf63f473
.long 0xbf74fa0b,0xbf6a09a7,0xbf5b941a,0xbf49d112,0xbf64aa59,0xbf53fac3,0xbf3fc767,0xbf286605
.long 0xbf4d9f02,0xbf373a23,0xbf1d7fd1,0xbf00e7e4,0xbf3085bb,0xbf14b039,0xbeebcbbb,0xbea986c4
.long 0xbf0e39da,0xbedae880,0xbe94a031,0xbe164083,0xbecf7bca,0xbe8586ce,0xbde1bc2e,0x3d2fe007
.long 0xbe78cfcc,0xbdafb680,0x3d96a905,0x3e6c9a7f,0xbd96a905,0x3dbc3ac3,0x3e827dc0,0x3ed25a09
.long 0x3dc8bd36,0x3e888e93,0x3edae880,0x3f13682a,0x3e888e93,0x3eddbe79,0x3f15f6d9,0x3f385216
.long 0x3edae880,0x3f15f6d9,0x3f396842,0x3f5695e5,0x3f13682a,0x3f385216,0x3f5695e5,0x3f6d1c1d
.long 0x0,0x0,0x0,0x0,0x0,0x3bc90f88,0x3c490e90,0x3c96c9b6
.long 0x0,0x3c490e90,0x3cc90ab0,0x3d16c32c,0x0,0x3c96c9b6,0x3d16c32c,0x3d621469
.long 0x0,0x3cc90ab0,0x3d48fb30,0x3d96a905,0x0,0x3cfb49ba,0x3d7b2b74,0x3dbc3ac3
.long 0x0,0x3d16c32c,0x3d96a905,0x3de1bc2e,0x0,0x3d2fe007,0x3dafb680,0x3e039502
.long 0x0,0x3d48fb30,0x3dc8bd36,0x3e164083,0x0,0x3d621469,0x3de1bc2e,0x3e28defc
.long 0x0,0x3d7b2b74,0x3dfab273,0x3e3b6ecf,0x0,0x3d8a200a,0x3e09cf86,0x3e4dee60
.long 0x0,0x3d96a905,0x3e164083,0x3e605c13,0x0,0x3da3308c,0x3e22abb6,0x3e72b651
.long 0x0,0x3dafb680,0x3e2f10a2,0x3e827dc0,0x0,0x3dbc3ac3,0x3e3b6ecf,0x3e8b9507
.long 0x0,0x3dc8bd36,0x3e47c5c2,0x3e94a031,0x0,0x3dd53db9,0x3e541501,0x3e9d9e78
.long 0x0,0x3de1bc2e,0x3e605c13,0x3ea68f12,0x0,0x3dee3876,0x3e6c9a7f,0x3eaf713a
.long 0x0,0x3dfab273,0x3e78cfcc,0x3eb8442a,0x0,0x3e039502,0x3e827dc0,0x3ec1071e
.long 0x0,0x3e09cf86,0x3e888e93,0x3ec9b953,0x0,0x3e1008b7,0x3e8e9a22,0x3ed25a09
.long 0x0,0x3e164083,0x3e94a031,0x3edae880,0x0,0x3e1c76de,0x3e9aa086,0x3ee363fa
.long 0x0,0x3e22abb6,0x3ea09ae5,0x3eebcbbb,0x0,0x3e28defc,0x3ea68f12,0x3ef41f07
.long 0x0,0x3e2f10a2,0x3eac7cd4,0x3efc5d27,0x0,0x3e354098,0x3eb263ef,0x3f0242b1
.long 0x0,0x3e3b6ecf,0x3eb8442a,0x3f064b82,0x0,0x3e419b37,0x3ebe1d4a,0x3f0a48ad
.long 0x0,0x0,0x0,0x0,0x3cc90ab0,0x3cfb49ba,0x3d16c32c,0x3d2fe007
.long 0x3d48fb30,0x3d7b2b74,0x3d96a905,0x3dafb680,0x3d96a905,0x3dbc3ac3,0x3de1bc2e,0x3e039502
.long 0x3dc8bd36,0x3dfab273,0x3e164083,0x3e2f10a2,0x3dfab273,0x3e1c76de,0x3e3b6ecf,0x3e5a3997
.long 0x3e164083,0x3e3b6ecf,0x3e605c13,0x3e827dc0,0x3e2f10a2,0x3e5a3997,0x3e827dc0,0x3e97a117
.long 0x3e47c5c2,0x3e78cfcc,0x3e94a031,0x3eac7cd4,0x3e605c13,0x3e8b9507,0x3ea68f12,0x3ec1071e
.long 0x3e78cfcc,0x3e9aa086,0x3eb8442a,0x3ed53641,0x3e888e93,0x3ea986c4,0x3ec9b953,0x3ee900b7
.long 0x3e94a031,0x3eb8442a,0x3edae880,0x3efc5d27,0x3ea09ae5,0x3ec6d529,0x3eebcbbb,0x3f07a136
.long 0x3eac7cd4,0x3ed53641,0x3efc5d27,0x3f10d3cd,0x3eb8442a,0x3ee363fa,0x3f064b82,0x3f19c200
.long 0x3ec3ef15,0x3ef15aea,0x3f0e39da,0x3f226799,0x3ecf7bca,0x3eff17b2,0x3f15f6d9,0x3f2ac082
.long 0x3edae880,0x3f064b82,0x3f1d7fd1,0x3f32c8c9,0x3ee63375,0x3f0cead0,0x3f24d225,0x3f3a7ca4
.long 0x3ef15aea,0x3f13682a,0x3f2beb4a,0x3f41d870,0x3efc5d27,0x3f19c200,0x3f32c8c9,0x3f48d8b3
.long 0x3f039c3d,0x3f1ff6cb,0x3f396842,0x3f4f7a1f,0x3f08f59b,0x3f26050a,0x3f3fc767,0x3f55b993
.long 0x3f0e39da,0x3f2beb4a,0x3f45e403,0x3f5b941a,0x3f13682a,0x3f31a81d,0x3f4bbbf8,0x3f6106f2
.long 0x3f187fc0,0x3f373a23,0x3f514d3d,0x3f660f88,0x3f1d7fd1,0x3f3ca003,0x3f5695e5,0x3f6aab7b
.long 0x3f226799,0x3f41d870,0x3f5b941a,0x3f6ed89e,0x3f273656,0x3f46e22a,0x3f604621,0x3f7294f8
.long 0x3f2beb4a,0x3f4bbbf8,0x3f64aa59,0x3f75dec6,0x3f3085bb,0x3f5064af,0x3f68bf3c,0x3f78b47b
.long 0x0,0x0,0x0,0x0,0x3d48fb30,0x3d621469,0x3d7b2b74,0x3d8a200a
.long 0x3dc8bd36,0x3de1bc2e,0x3dfab273,0x3e09cf86,0x3e164083,0x3e28defc,0x3e3b6ecf,0x3e4dee60
.long 0x3e47c5c2,0x3e605c13,0x3e78cfcc,0x3e888e93,0x3e78cfcc,0x3e8b9507,0x3e9aa086,0x3ea986c4
.long 0x3e94a031,0x3ea68f12,0x3eb8442a,0x3ec9b953,0x3eac7cd4,0x3ec1071e,0x3ed53641,0x3ee900b7
.long 0x3ec3ef15,0x3edae880,0x3ef15aea,0x3f039c3d,0x3edae880,0x3ef41f07,0x3f064b82,0x3f121eb0
.long 0x3ef15aea,0x3f064b82,0x3f13682a,0x3f1ff6cb,0x3f039c3d,0x3f121eb0,0x3f1ff6cb,0x3f2d1469
.long 0x3f0e39da,0x3f1d7fd1,0x3f2beb4a,0x3f396842,0x3f187fc0,0x3f286605,0x3f373a23,0x3f44e3f5
.long 0x3f226799,0x3f32c8c9,0x3f41d870,0x3f4f7a1f,0x3f2beb4a,0x3f3ca003,0x3f4bbbf8,0x3f591e6a
.long 0x3f3504f3,0x3f45e403,0x3f54db31,0x3f61c598,0x3f3daef9,0x3f4e8d90,0x3f5d2d53,0x3f696591
.long 0x3f45e403,0x3f5695e5,0x3f64aa59,0x3f6ff573,0x3f4d9f02,0x3f5df6be,0x3f6b4b0c,0x3f756d97
.long 0x3f54db31,0x3f64aa59,0x3f710908,0x3f79c79d,0x3f5b941a,0x3f6aab7b,0x3f75dec6,0x3f7cfe73
.long 0x3f61c598,0x3f6ff573,0x3f79c79d,0x3f7f0e58,0x3f676bd8,0x3f748422,0x3f7cbfc9,0x3f7ff4e6
.long 0x3f6c835e,0x3f7853f8,0x3f7ec46d,0x3f7fb10f,0x3f710908,0x3f7b61fc,0x3f7fd397,0x3f7e4323
.long 0x3f74fa0b,0x3f7dabcc,0x3f7fec43,0x3f7baccd,0x3f7853f8,0x3f7f2f9d,0x3f7f0e58,0x3f77f110
.long 0x3f7b14be,0x3f7fec43,0x3f7d3aac,0x3f731447,0x3f7d3aac,0x3f7fe129,0x3f7a7302,0x3f6d1c1d
.long 0x3f7ec46d,0x3f7f0e58,0x3f76ba07,0x3f660f88,0x3f7fb10f,0x3f7d7474,0x3f721352,0x3f5df6be
.long 0x0,0x0,0x0,0x0,0x3d96a905,0x3da3308c,0x3dafb680,0x3dbc3ac3
.long 0x3e164083,0x3e22abb6,0x3e2f10a2,0x3e3b6ecf,0x3e605c13,0x3e72b651,0x3e827dc0,0x3e8b9507
.long 0x3e94a031,0x3ea09ae5,0x3eac7cd4,0x3eb8442a,0x3eb8442a,0x3ec6d529,0x3ed53641,0x3ee363fa
.long 0x3edae880,0x3eebcbbb,0x3efc5d27,0x3f064b82,0x3efc5d27,0x3f07a136,0x3f10d3cd,0x3f19c200
.long 0x3f0e39da,0x3f187fc0,0x3f226799,0x3f2beb4a,0x3f1d7fd1,0x3f286605,0x3f32c8c9,0x3f3ca003
.long 0x3f2beb4a,0x3f373a23,0x3f41d870,0x3f4bbbf8,0x3f396842,0x3f44e3f5,0x3f4f7a1f,0x3f591e6a
.long 0x3f45e403,0x3f514d3d,0x3f5b941a,0x3f64aa59,0x3f514d3d,0x3f5c61c7,0x3f660f88,0x3f6e46be
.long 0x3f5b941a,0x3f660f88,0x3f6ed89e,0x3f75dec6,0x3f64aa59,0x3f6e46be,0x3f75dec6,0x3f7b61fc
.long 0x3f6c835e,0x3f74fa0b,0x3f7b14be,0x3f7ec46d,0x3f731447,0x3f7a1e84,0x3f7e70b0,0x3f7ffec4
.long 0x3f7853f8,0x3f7dabcc,0x3f7fec43,0x3f7f0e58,0x3f7c3b28,0x3f7f9c18,0x3f7f84ab,0x3f7bf531
.long 0x3f7ec46d,0x3f7fec43,0x3f7d3aac,0x3f76ba07,0x3f7fec43,0x3f7e9bc9,0x3f791298,0x3f6f6830
.long 0x3f7fb10f,0x3f7baccd,0x3f731447,0x3f660f88,0x3f7e1324,0x3f772417,0x3f6b4b0c,0x3f5ac450
.long 0x3f7b14be,0x3f710908,0x3f61c598,0x3f4d9f02,0x3f76ba07,0x3f696591,0x3f5695e5,0x3f3ebc1b
.long 0x3f710908,0x3f604621,0x3f49d112,0x3f2e3bde,0x3f6a09a7,0x3f55b993,0x3f3b8f3b,0x3f1c420c
.long 0x3f61c598,0x3f49d112,0x3f2beb4a,0x3f08f59b,0x3f584853,0x3f3ca003,0x3f1b02c6,0x3ee900b7
.long 0x3f4d9f02,0x3f2e3bde,0x3f08f59b,0x3ebe1d4a,0x3f41d870,0x3f1ebc12,0x3eebcbbb,0x3e919ddd
.long 0x0,0x0,0x0,0x0,0x3dc8bd36,0x3dd53db9,0x3de1bc2e,0x3dee3876
.long 0x3e47c5c2,0x3e541501,0x3e605c13,0x3e6c9a7f,0x3e94a031,0x3e9d9e78,0x3ea68f12,0x3eaf713a
.long 0x3ec3ef15,0x3ecf7bca,0x3edae880,0x3ee63375,0x3ef15aea,0x3eff17b2,0x3f064b82,0x3f0cead0
.long 0x3f0e39da,0x3f15f6d9,0x3f1d7fd1,0x3f24d225,0x3f226799,0x3f2ac082,0x3f32c8c9,0x3f3a7ca4
.long 0x3f3504f3,0x3f3daef9,0x3f45e403,0x3f4d9f02,0x3f45e403,0x3f4e8d90,0x3f5695e5,0x3f5df6be
.long 0x3f54db31,0x3f5d2d53,0x3f64aa59,0x3f6b4b0c,0x3f61c598,0x3f696591,0x3f6ff573,0x3f756d97
.long 0x3f6c835e,0x3f731447,0x3f7853f8,0x3f7c3b28,0x3f74fa0b,0x3f7a1e84,0x3f7dabcc,0x3f7f9c18
.long 0x3f7b14be,0x3f7e70b0,0x3f7fec43,0x3f7f84ab,0x3f7ec46d,0x3f7ffec4,0x3f7f0e58,0x3f7bf531
.long 0x3f800000,0x3f7ec46d,0x3f7b14be,0x3f74fa0b,0x3f7ec46d,0x3f7ac516,0x3f740bdd,0x3f6aab7b
.long 0x3f7b14be,0x3f740bdd,0x3f6a09a7,0x3f5d2d53,0x3f74fa0b,0x3f6aab7b,0x3f5d2d53,0x3f4cae79
.long 0x3f6c835e,0x3f5ebe05,0x3f4d9f02,0x3f396842,0x3f61c598,0x3f5064af,0x3f3b8f3b,0x3f239da9
.long 0x3f54db31,0x3f3fc767,0x3f273656,0x3f0b9a6b,0x3f45e403,0x3f2d1469,0x3f10d3cd,0x3ee363fa
.long 0x3f3504f3,0x3f187fc0,0x3ef15aea,0x3eac7cd4,0x3f226799,0x3f0242b1,0x3ebe1d4a,0x3e667c66
.long 0x3f0e39da,0x3ed53641,0x3e888e93,0x3de1bc2e,0x3ef15aea,0x3ea395c5,0x3e22abb6,0xbbc90f88
.long 0x3ec3ef15,0x3e605c13,0x3d48fb30,0xbdfab273,0x3e94a031,0x3dee3876,0xbd7b2b74,0xbe72b651
.long 0x3e47c5c2,0x3c490e90,0xbe2f10a2,0xbeb263ef,0x3dc8bd36,0xbdbc3ac3,0xbe8e9a22,0xbee900b7
.long 0x0,0x0,0x0,0x0,0x3dfab273,0x3e039502,0x3e09cf86,0x3e1008b7
.long 0x3e78cfcc,0x3e827dc0,0x3e888e93,0x3e8e9a22,0x3eb8442a,0x3ec1071e,0x3ec9b953,0x3ed25a09
.long 0x3ef15aea,0x3efc5d27,0x3f039c3d,0x3f08f59b,0x3f13682a,0x3f19c200,0x3f1ff6cb,0x3f26050a
.long 0x3f2beb4a,0x3f32c8c9,0x3f396842,0x3f3fc767,0x3f41d870,0x3f48d8b3,0x3f4f7a1f,0x3f55b993
.long 0x3f54db31,0x3f5b941a,0x3f61c598,0x3f676bd8,0x3f64aa59,0x3f6aab7b,0x3f6ff573,0x3f748422
.long 0x3f710908,0x3f75dec6,0x3f79c79d,0x3f7cbfc9,0x3f79c79d,0x3f7cfe73,0x3f7f0e58,0x3f7ff4e6
.long 0x3f7ec46d,0x3f7fec43,0x3f7fb10f,0x3f7e1324,0x3f7fec43,0x3f7e9bc9,0x3f7baccd,0x3f772417
.long 0x3f7d3aac,0x3f791298,0x3f731447,0x3f6b4b0c,0x3f76ba07,0x3f6f6830,0x3f660f88,0x3f5ac450
.long 0x3f6c835e,0x3f61c598,0x3f54db31,0x3f45e403,0x3f5ebe05,0x3f5064af,0x3f3fc767,0x3f2d1469
.long 0x3f4d9f02,0x3f3b8f3b,0x3f273656,0x3f10d3cd,0x3f396842,0x3f239da9,0x3f0b9a6b,0x3ee363fa
.long 0x3f226799,0x3f08f59b,0x3edae880,0x3ea09ae5,0x3f08f59b,0x3ed8106b,0x3e9aa086,0x3e354098
.long 0x3edae880,0x3e9aa086,0x3e2f10a2,0x3d16c32c,0x3ea09ae5,0x3e354098,0x3d16c32c,0xbdd53db9
.long 0x3e47c5c2,0x3d48fb30,0xbdc8bd36,0xbe78cfcc,0x3d96a905,0xbda3308c,0xbe6c9a7f,0xbec1071e
.long 0xbd48fb30,0xbe541501,0xbeb8442a,0xbf00e7e4,0xbe2f10a2,0xbea986c4,0xbef6e0cb,0xbf1ebc12
.long 0xbe94a031,0xbee63375,0xbf187fc0,0xbf396842,0xbecf7bca,0xbf0f8784,0xbf32c8c9,0xbf5064af
.long 0xbf039c3d,0xbf299415,0xbf49d112,0xbf633c5a,0xbf1d7fd1,0xbf40d0da,0xbf5d2d53,0xbf718f57
.long 0x0,0x0,0x0,0x0,0x3e164083,0x3e1c76de,0x3e22abb6,0x3e28defc
.long 0x3e94a031,0x3e9aa086,0x3ea09ae5,0x3ea68f12,0x3edae880,0x3ee363fa,0x3eebcbbb,0x3ef41f07
.long 0x3f0e39da,0x3f13682a,0x3f187fc0,0x3f1d7fd1,0x3f2beb4a,0x3f31a81d,0x3f373a23,0x3f3ca003
.long 0x3f45e403,0x3f4bbbf8,0x3f514d3d,0x3f5695e5,0x3f5b941a,0x3f6106f2,0x3f660f88,0x3f6aab7b
.long 0x3f6c835e,0x3f710908,0x3f74fa0b,0x3f7853f8,0x3f7853f8,0x3f7b61fc,0x3f7dabcc,0x3f7f2f9d
.long 0x3f7ec46d,0x3f7fd397,0x3f7fec43,0x3f7f0e58,0x3f7fb10f,0x3f7e4323,0x3f7baccd,0x3f77f110
.long 0x3f7b14be,0x3f76ba07,0x3f710908,0x3f6a09a7,0x3f710908,0x3f696591,0x3f604621,0x3f55b993
.long 0x3f61c598,0x3f5695e5,0x3f49d112,0x3f3b8f3b,0x3f4d9f02,0x3f3ebc1b,0x3f2e3bde,0x3f1c420c
.long 0x3f3504f3,0x3f226799,0x3f0e39da,0x3ef15aea,0x3f187fc0,0x3f0242b1,0x3ed53641,0x3ea395c5
.long 0x3ef15aea,0x3ebe1d4a,0x3e888e93,0x3e22abb6,0x3eac7cd4,0x3e667c66,0x3de1bc2e,0xbbc90f88
.long 0x3e47c5c2,0x3d96a905,0xbd48fb30,0xbe2f10a2,0x3d48fb30,0xbda3308c,0xbe541501,0xbea986c4
.long 0xbdc8bd36,0xbe6c9a7f,0xbeb8442a,0xbef6e0cb,0xbe78cfcc,0xbec1071e,0xbf00e7e4,0xbf1ebc12
.long 0xbec3ef15,0xbf039c3d,0xbf226799,0xbf3daef9,0xbf039c3d,0xbf239da9,0xbf3fc767,0xbf577026
.long 0xbf226799,0xbf3fc767,0xbf584853,0xbf6b4b0c,0xbf3daef9,0xbf577026,0xbf6b4b0c,0xbf78b47b
.long 0xbf54db31,0xbf6a09a7,0xbf7853f8,0xbf7f4e6d,0xbf676bd8,0xbf772417,0xbf7f0e58,0xbf7eea9d
.long 0xbf74fa0b,0xbf7e70b0,0xbf7f4e6d,0xbf778bc5,0xbf7d3aac,0xbf7fc38f,0xbf791298,0xbf696591
.long 0x0,0x0,0x0,0x0,0x3e2f10a2,0x3e354098,0x3e3b6ecf,0x3e419b37
.long 0x3eac7cd4,0x3eb263ef,0x3eb8442a,0x3ebe1d4a,0x3efc5d27,0x3f0242b1,0x3f064b82,0x3f0a48ad
.long 0x3f226799,0x3f273656,0x3f2beb4a,0x3f3085bb,0x3f41d870,0x3f46e22a,0x3f4bbbf8,0x3f5064af
.long 0x3f5b941a,0x3f604621,0x3f64aa59,0x3f68bf3c,0x3f6ed89e,0x3f7294f8,0x3f75dec6,0x3f78b47b
.long 0x3f7b14be,0x3f7d3aac,0x3f7ec46d,0x3f7fb10f,0x3f7fec43,0x3f7fe129,0x3f7f0e58,0x3f7d7474
.long 0x3f7d3aac,0x3f7a7302,0x3f76ba07,0x3f721352,0x3f731447,0x3f6d1c1d,0x3f660f88,0x3f5df6be
.long 0x3f61c598,0x3f584853,0x3f4d9f02,0x3f41d870,0x3f49d112,0x3f3ca003,0x3f2e3bde,0x3f1ebc12
.long 0x3f2beb4a,0x3f1b02c6,0x3f08f59b,0x3eebcbbb,0x3f08f59b,0x3ee900b7,0x3ebe1d4a,0x3e919ddd
.long 0x3ec3ef15,0x3e94a031,0x3e47c5c2,0x3dc8bd36,0x3e605c13,0x3dee3876,0x3c490e90,0xbdbc3ac3
.long 0x3d48fb30,0xbd7b2b74,0xbe2f10a2,0xbe8e9a22,0xbdfab273,0xbe72b651,0xbeb263ef,0xbee900b7
.long 0xbe94a031,0xbecf7bca,0xbf039c3d,0xbf1d7fd1,0xbee63375,0xbf0f8784,0xbf299415,0xbf40d0da
.long 0xbf187fc0,0xbf32c8c9,0xbf49d112,0xbf5d2d53,0xbf396842,0xbf5064af,0xbf633c5a,0xbf718f57
.long 0xbf54db31,0xbf676bd8,0xbf74fa0b,0xbf7d3aac,0xbf6a09a7,0xbf772417,0xbf7e70b0,0xbf7fc38f
.long 0xbf7853f8,0xbf7f0e58,0xbf7f4e6d,0xbf791298,0xbf7f4e6d,0xbf7eea9d,0xbf778bc5,0xbf696591
.long 0xbf7ec46d,0xbf76ba07,0xbf676bd8,0xbf514d3d,0xbf76ba07,0xbf66becc,0xbf4f7a1f,0xbf31a81d
.long 0xbf676bd8,0xbf4f7a1f,0xbf3085bb,0xbf0b9a6b,0xbf514d3d,0xbf31a81d,0xbf0b9a6b,0xbec1071e
.long 0x3f80,0x3f80,0x3f80,0x3f80,0x3f800000,0x3f800000,0x3f800000,0x3f800000
.long 0x3f80,0x3e483f7b,0x3ec43f6d,0x3f0e3f55,0x3f800000,0x3f7bbe48,0x3f6dbec4,0x3f55bf0e
.long 0x3f80,0x3f353f35,0x3f800000,0x3f35bf35,0x3f800000,0x3f35bf35,0xbf80,0xbf35bf35
.long 0x3f80,0x3f553f0e,0x3f6dbec4,0x3e48bf7b,0x3f800000,0x3f0ebf55,0xbec4bf6d,0xbf7bbe48
.long 0x3f80,0x3ec43f6d,0x3f353f35,0x3f6d3ec4,0x3f800000,0x3f6dbec4,0x3f35bf35,0x3ec4bf6d
.long 0x3f80,0x3f0e3f55,0x3f6d3ec4,0x3f7bbe48,0x3f800000,0x3f55bf0e,0x3ec4bf6d,0xbe48bf7b
.long 0x3f80,0x3f6d3ec4,0x3f35bf35,0xbec4bf6d,0x3f800000,0x3ec4bf6d,0xbf35bf35,0xbf6d3ec4
.long 0x3f80,0x3f7b3e48,0x3ec4bf6d,0xbf55bf0e,0x3f800000,0x3e48bf7b,0xbf6dbec4,0xbf0e3f55
.long 0x3f80,0x3f800000,0xbf80,0xbf800000,0x3f800000,0xbf80,0xbf800000,0x3f80
.long 0x3f80,0x3f7bbe48,0xbec4bf6d,0xbf553f0e,0x3f800000,0xbe48bf7b,0xbf6d3ec4,0x3f0e3f55
.long 0x3f80,0x3f35bf35,0xbf800000,0x3f353f35,0x3f800000,0xbf35bf35,0x3f80,0x3f35bf35
.long 0x3f80,0x3f0ebf55,0xbf6d3ec4,0x3f7b3e48,0x3f800000,0xbf55bf0e,0x3ec43f6d,0x3e48bf7b
.long 0x3f80,0x3f6dbec4,0xbf35bf35,0xbec43f6d,0x3f800000,0xbec4bf6d,0xbf353f35,0x3f6d3ec4
.long 0x3f80,0x3f55bf0e,0xbf6dbec4,0x3e483f7b,0x3f800000,0xbf0ebf55,0xbec43f6d,0x3f7bbe48
.long 0x3f80,0x3ec4bf6d,0xbf353f35,0x3f6dbec4,0x3f800000,0xbf6dbec4,0x3f353f35,0xbec4bf6d
.long 0x3f80,0x3e48bf7b,0xbec43f6d,0x3f0ebf55,0x3f800000,0xbf7bbe48,0x3f6d3ec4,0xbf55bf0e
.long 0x3f80,0x3f80,0x3f80,0x3f80,0x3f800000,0x3f800000,0x3f800000,0x3f800000
.long 0x3f353f35,0x3f553f0e,0x3f6d3ec4,0x3f7b3e48,0x3f35bf35,0x3f0ebf55,0x3ec4bf6d,0x3e48bf7b
.long 0xbf80,0xbf35bf35,0xbf800000,0xbf353f35,0xbf800000,0xbf353f35,0x3f80,0x3f353f35
.long 0xbf35bf35,0xbf7b3e48,0xbec43f6d,0x3f0e3f55,0xbf353f35,0x3e483f7b,0x3f6d3ec4,0x3f55bf0e
.long 0x3f800000,0x3f6dbec4,0x3f35bf35,0x3ec4bf6d,0xbf80,0xbec4bf6d,0xbf35bf35,0xbf6dbec4
.long 0x3f35bf35,0x3e48bf7b,0xbec4bf6d,0xbf55bf0e,0xbf35bf35,0xbf7bbe48,0xbf6d3ec4,0xbf0e3f55
.long 0xbf800000,0xbec43f6d,0x3f353f35,0x3f6dbec4,0x3f80,0x3f6d3ec4,0x3f35bf35,0xbec4bf6d
.long 0xbf353f35,0x3f0e3f55,0x3f6dbec4,0xbe48bf7b,0x3f353f35,0x3f55bf0e,0xbec4bf6d,0xbf7b3e48
.long 0x3f80,0x3f800000,0xbf80,0xbf800000,0x3f800000,0xbf80,0xbf800000,0x3f80
.long 0x3f353f35,0x3f0ebf55,0xbf6dbec4,0xbe483f7b,0x3f35bf35,0xbf55bf0e,0xbec43f6d,0x3f7b3e48
.long 0xbf80,0xbf353f35,0x3f800000,0xbf35bf35,0xbf800000,0x3f353f35,0xbf80,0xbf353f35
.long 0xbf35bf35,0x3e483f7b,0x3ec4bf6d,0xbf553f0e,0xbf353f35,0x3f7bbe48,0xbf6dbec4,0x3f0e3f55
.long 0x3f800000,0xbec4bf6d,0xbf353f35,0x3f6d3ec4,0xbf80,0xbf6d3ec4,0x3f353f35,0x3ec4bf6d
.long 0x3f35bf35,0xbf7bbe48,0x3ec43f6d,0x3f0ebf55,0xbf35bf35,0xbe483f7b,0x3f6dbec4,0xbf55bf0e
.long 0xbf800000,0x3f6d3ec4,0xbf35bf35,0x3ec43f6d,0x3f80,0x3ec4bf6d,0xbf353f35,0x3f6dbec4
.long 0xbf353f35,0x3f55bf0e,0xbf6d3ec4,0x3f7bbe48,0x3f353f35,0xbf0ebf55,0x3ec43f6d,0xbe48bf7b
.long 0x3f80,0x3f80,0x3f80,0x3f80,0x3f800000,0x3f800000,0x3f800000,0x3f800000
.long 0x3f800000,0x3f7bbe48,0x3f6dbec4,0x3f55bf0e,0xbf80,0xbe48bf7b,0xbec4bf6d,0xbf0ebf55
.long 0x3f80,0x3f353f35,0x3f800000,0x3f35bf35,0x3f800000,0x3f35bf35,0xbf80,0xbf35bf35
.long 0x3f800000,0x3f0ebf55,0xbec4bf6d,0xbf7bbe48,0xbf80,0xbf55bf0e,0xbf6d3ec4,0xbe483f7b
.long 0xbf80,0xbec4bf6d,0xbf35bf35,0xbf6dbec4,0xbf800000,0xbf6d3ec4,0xbf353f35,0xbec43f6d
.long 0xbf800000,0xbf553f0e,0xbec43f6d,0x3e483f7b,0x3f80,0x3f0e3f55,0x3f6d3ec4,0x3f7bbe48
.long 0xbf80,0xbf6dbec4,0xbf353f35,0x3ec43f6d,0xbf800000,0xbec43f6d,0x3f353f35,0x3f6dbec4
.long 0xbf800000,0xbe483f7b,0x3f6d3ec4,0x3f0ebf55,0x3f80,0x3f7b3e48,0x3ec4bf6d,0xbf55bf0e
.long 0x3f80,0x3f800000,0xbf80,0xbf800000,0x3f800000,0xbf80,0xbf800000,0x3f80
.long 0x3f800000,0xbe48bf7b,0xbf6d3ec4,0x3f0e3f55,0xbf80,0xbf7b3e48,0x3ec43f6d,0x3f55bf0e
.long 0x3f80,0x3f35bf35,0xbf800000,0x3f353f35,0x3f800000,0xbf35bf35,0x3f80,0x3f35bf35
.long 0x3f800000,0xbf55bf0e,0x3ec43f6d,0x3e48bf7b,0xbf80,0xbf0e3f55,0x3f6dbec4,0xbf7bbe48
.long 0xbf80,0xbf6d3ec4,0x3f353f35,0x3ec4bf6d,0xbf800000,0x3ec43f6d,0x3f35bf35,0xbf6dbec4
.long 0xbf800000,0x3f0e3f55,0x3ec4bf6d,0xbf7b3e48,0x3f80,0x3f55bf0e,0xbf6dbec4,0x3e483f7b
.long 0xbf80,0xbec43f6d,0x3f35bf35,0xbf6d3ec4,0xbf800000,0x3f6d3ec4,0xbf35bf35,0x3ec43f6d
.long 0xbf800000,0x3f7b3e48,0xbf6dbec4,0x3f553f0e,0x3f80,0x3e48bf7b,0xbec43f6d,0x3f0ebf55
.long 0x3f80,0x3f80,0x3f80,0x3f80,0x3f800000,0x3f800000,0x3f800000,0x3f800000
.long 0x3f35bf35,0x3f0ebf55,0x3ec4bf6d,0x3e48bf7b,0xbf35bf35,0xbf55bf0e,0xbf6dbec4,0xbf7bbe48
.long 0xbf80,0xbf35bf35,0xbf800000,0xbf353f35,0xbf800000,0xbf353f35,0x3f80,0x3f353f35
.long 0xbf353f35,0x3e483f7b,0x3f6d3ec4,0x3f55bf0e,0x3f353f35,0x3f7bbe48,0x3ec4bf6d,0xbf0ebf55
.long 0xbf800000,0xbf6d3ec4,0xbf353f35,0xbec43f6d,0x3f80,0x3ec43f6d,0x3f353f35,0x3f6d3ec4
.long 0x3f353f35,0x3f7b3e48,0x3f6dbec4,0x3f0ebf55,0x3f35bf35,0x3e48bf7b,0xbec4bf6d,0xbf55bf0e
.long 0x3f800000,0x3ec4bf6d,0xbf35bf35,0xbf6d3ec4,0xbf80,0xbf6dbec4,0xbf353f35,0x3ec43f6d
.long 0xbf35bf35,0xbf553f0e,0x3ec43f6d,0x3f7bbe48,0xbf353f35,0x3f0e3f55,0x3f6dbec4,0xbe48bf7b
.long 0x3f80,0x3f800000,0xbf80,0xbf800000,0x3f800000,0xbf80,0xbf800000,0x3f80
.long 0x3f35bf35,0xbf55bf0e,0xbec43f6d,0x3f7b3e48,0xbf35bf35,0xbf0e3f55,0x3f6d3ec4,0x3e48bf7b
.long 0xbf80,0xbf353f35,0x3f800000,0xbf35bf35,0xbf800000,0x3f353f35,0xbf80,0xbf353f35
.long 0xbf353f35,0x3f7bbe48,0xbf6dbec4,0x3f0e3f55,0x3f353f35,0xbe48bf7b,0xbec43f6d,0x3f55bf0e
.long 0xbf800000,0x3ec43f6d,0x3f35bf35,0xbf6dbec4,0x3f80,0x3f6dbec4,0xbf35bf35,0xbec43f6d
.long 0x3f353f35,0x3e48bf7b,0xbf6d3ec4,0x3f553f0e,0x3f35bf35,0xbf7bbe48,0x3ec43f6d,0x3f0ebf55
.long 0x3f800000,0xbf6dbec4,0x3f353f35,0xbec4bf6d,0xbf80,0xbec43f6d,0x3f35bf35,0xbf6d3ec4
.long 0xbf35bf35,0x3f0e3f55,0xbec4bf6d,0x3e483f7b,0xbf353f35,0x3f55bf0e,0xbf6d3ec4,0x3f7bbe48
.long 0x3f80,0x3f80,0x3f80,0x3f80,0x3f800000,0x3f800000,0x3f800000,0x3f800000
.long 0xbf80,0xbe48bf7b,0xbec4bf6d,0xbf0ebf55,0xbf800000,0xbf7b3e48,0xbf6d3ec4,0xbf553f0e
.long 0x3f80,0x3f353f35,0x3f800000,0x3f35bf35,0x3f800000,0x3f35bf35,0xbf80,0xbf35bf35
.long 0xbf80,0xbf55bf0e,0xbf6d3ec4,0xbe483f7b,0xbf800000,0xbf0e3f55,0x3ec43f6d,0x3f7b3e48
.long 0x3f80,0x3ec43f6d,0x3f353f35,0x3f6d3ec4,0x3f800000,0x3f6dbec4,0x3f35bf35,0x3ec4bf6d
.long 0xbf80,0xbf0ebf55,0xbf6dbec4,0xbf7b3e48,0xbf800000,0xbf553f0e,0xbec43f6d,0x3e483f7b
.long 0x3f80,0x3f6d3ec4,0x3f35bf35,0xbec4bf6d,0x3f800000,0x3ec4bf6d,0xbf35bf35,0xbf6d3ec4
.long 0xbf80,0xbf7bbe48,0xbec43f6d,0x3f553f0e,0xbf800000,0xbe483f7b,0x3f6d3ec4,0x3f0ebf55
.long 0x3f80,0x3f800000,0xbf80,0xbf800000,0x3f800000,0xbf80,0xbf800000,0x3f80
.long 0xbf80,0xbf7b3e48,0x3ec43f6d,0x3f55bf0e,0xbf800000,0x3e483f7b,0x3f6dbec4,0xbf0ebf55
.long 0x3f80,0x3f35bf35,0xbf800000,0x3f353f35,0x3f800000,0xbf35bf35,0x3f80,0x3f35bf35
.long 0xbf80,0xbf0e3f55,0x3f6dbec4,0xbf7bbe48,0xbf800000,0x3f553f0e,0xbec4bf6d,0xbe483f7b
.long 0x3f80,0x3f6dbec4,0xbf35bf35,0xbec43f6d,0x3f800000,0xbec4bf6d,0xbf353f35,0x3f6d3ec4
.long 0xbf80,0xbf553f0e,0x3f6d3ec4,0xbe48bf7b,0xbf800000,0x3f0e3f55,0x3ec4bf6d,0xbf7b3e48
.long 0x3f80,0x3ec4bf6d,0xbf353f35,0x3f6dbec4,0x3f800000,0xbf6dbec4,0x3f353f35,0xbec4bf6d
.long 0xbf80,0xbe483f7b,0x3ec4bf6d,0xbf0e3f55,0xbf800000,0x3f7b3e48,0xbf6dbec4,0x3f553f0e
.long 0x3f80,0x3f80,0x3f80,0x3f80,0x3f800000,0x3f800000,0x3f800000,0x3f800000
.long 0xbf35bf35,0xbf55bf0e,0xbf6dbec4,0xbf7bbe48,0xbf353f35,0xbf0e3f55,0xbec43f6d,0xbe483f7b
.long 0xbf80,0xbf35bf35,0xbf800000,0xbf353f35,0xbf800000,0xbf353f35,0x3f80,0x3f353f35
.long 0x3f353f35,0x3f7bbe48,0x3ec4bf6d,0xbf0ebf55,0x3f35bf35,0xbe48bf7b,0xbf6dbec4,0xbf553f0e
.long 0x3f800000,0x3f6dbec4,0x3f35bf35,0x3ec4bf6d,0xbf80,0xbec4bf6d,0xbf35bf35,0xbf6dbec4
.long 0xbf353f35,0xbe483f7b,0x3ec43f6d,0x3f553f0e,0x3f353f35,0x3f7b3e48,0x3f6dbec4,0x3f0ebf55
.long 0xbf800000,0xbec43f6d,0x3f353f35,0x3f6dbec4,0x3f80,0x3f6d3ec4,0x3f35bf35,0xbec4bf6d
.long 0x3f35bf35,0xbf0ebf55,0xbf6d3ec4,0x3e483f7b,0xbf35bf35,0xbf553f0e,0x3ec43f6d,0x3f7bbe48
.long 0x3f80,0x3f800000,0xbf80,0xbf800000,0x3f800000,0xbf80,0xbf800000,0x3f80
.long 0xbf35bf35,0xbf0e3f55,0x3f6d3ec4,0x3e48bf7b,0xbf353f35,0x3f553f0e,0x3ec4bf6d,0xbf7bbe48
.long 0xbf80,0xbf353f35,0x3f800000,0xbf35bf35,0xbf800000,0x3f353f35,0xbf80,0xbf353f35
.long 0x3f353f35,0xbe48bf7b,0xbec43f6d,0x3f55bf0e,0x3f35bf35,0xbf7b3e48,0x3f6d3ec4,0xbf0ebf55
.long 0x3f800000,0xbec4bf6d,0xbf353f35,0x3f6d3ec4,0xbf80,0xbf6d3ec4,0x3f353f35,0x3ec4bf6d
.long 0xbf353f35,0x3f7b3e48,0xbec4bf6d,0xbf0e3f55,0x3f353f35,0x3e48bf7b,0xbf6d3ec4,0x3f553f0e
.long 0xbf800000,0x3f6d3ec4,0xbf35bf35,0x3ec43f6d,0x3f80,0x3ec4bf6d,0xbf353f35,0x3f6dbec4
.long 0x3f35bf35,0xbf553f0e,0x3f6dbec4,0xbf7b3e48,0xbf35bf35,0x3f0e3f55,0xbec4bf6d,0x3e483f7b
.long 0x3f80,0x3f80,0x3f80,0x3f80,0x3f800000,0x3f800000,0x3f800000,0x3f800000
.long 0xbf800000,0xbf7b3e48,0xbf6d3ec4,0xbf553f0e,0x3f80,0x3e483f7b,0x3ec43f6d,0x3f0e3f55
.long 0x3f80,0x3f353f35,0x3f800000,0x3f35bf35,0x3f800000,0x3f35bf35,0xbf80,0xbf35bf35
.long 0xbf800000,0xbf0e3f55,0x3ec43f6d,0x3f7b3e48,0x3f80,0x3f553f0e,0x3f6dbec4,0x3e48bf7b
.long 0xbf80,0xbec4bf6d,0xbf35bf35,0xbf6dbec4,0xbf800000,0xbf6d3ec4,0xbf353f35,0xbec43f6d
.long 0x3f800000,0x3f55bf0e,0x3ec4bf6d,0xbe48bf7b,0xbf80,0xbf0ebf55,0xbf6dbec4,0xbf7b3e48
.long 0xbf80,0xbf6dbec4,0xbf353f35,0x3ec43f6d,0xbf800000,0xbec43f6d,0x3f353f35,0x3f6dbec4
.long 0x3f800000,0x3e48bf7b,0xbf6dbec4,0xbf0e3f55,0xbf80,0xbf7bbe48,0xbec43f6d,0x3f553f0e
.long 0x3f80,0x3f800000,0xbf80,0xbf800000,0x3f800000,0xbf80,0xbf800000,0x3f80
.long 0xbf800000,0x3e483f7b,0x3f6dbec4,0xbf0ebf55,0x3f80,0x3f7bbe48,0xbec4bf6d,0xbf553f0e
.long 0x3f80,0x3f35bf35,0xbf800000,0x3f353f35,0x3f800000,0xbf35bf35,0x3f80,0x3f35bf35
.long 0xbf800000,0x3f553f0e,0xbec4bf6d,0xbe483f7b,0x3f80,0x3f0ebf55,0xbf6d3ec4,0x3f7b3e48
.long 0xbf80,0xbf6d3ec4,0x3f353f35,0x3ec4bf6d,0xbf800000,0x3ec43f6d,0x3f35bf35,0xbf6dbec4
.long 0x3f800000,0xbf0ebf55,0xbec43f6d,0x3f7bbe48,0xbf80,0xbf553f0e,0x3f6d3ec4,0xbe48bf7b
.long 0xbf80,0xbec43f6d,0x3f35bf35,0xbf6d3ec4,0xbf800000,0x3f6d3ec4,0xbf35bf35,0x3ec43f6d
.long 0x3f800000,0xbf7bbe48,0x3f6d3ec4,0xbf55bf0e,0xbf80,0xbe483f7b,0x3ec4bf6d,0xbf0e3f55
.long 0x3f80,0x3f80,0x3f80,0x3f80,0x3f800000,0x3f800000,0x3f800000,0x3f800000
.long 0xbf353f35,0xbf0e3f55,0xbec43f6d,0xbe483f7b,0x3f353f35,0x3f553f0e,0x3f6d3ec4,0x3f7b3e48
.long 0xbf80,0xbf35bf35,0xbf800000,0xbf353f35,0xbf800000,0xbf353f35,0x3f80,0x3f353f35
.long 0x3f35bf35,0xbe48bf7b,0xbf6dbec4,0xbf553f0e,0xbf35bf35,0xbf7b3e48,0xbec43f6d,0x3f0e3f55
.long 0xbf800000,0xbf6d3ec4,0xbf353f35,0xbec43f6d,0x3f80,0x3ec43f6d,0x3f353f35,0x3f6d3ec4
.long 0xbf35bf35,0xbf7bbe48,0xbf6d3ec4,0xbf0e3f55,0xbf353f35,0xbe483f7b,0x3ec43f6d,0x3f553f0e
.long 0x3f800000,0x3ec4bf6d,0xbf35bf35,0xbf6d3ec4,0xbf80,0xbf6dbec4,0xbf353f35,0x3ec43f6d
.long 0x3f353f35,0x3f55bf0e,0xbec4bf6d,0xbf7b3e48,0x3f35bf35,0xbf0ebf55,0xbf6d3ec4,0x3e483f7b
.long 0x3f80,0x3f800000,0xbf80,0xbf800000,0x3f800000,0xbf80,0xbf800000,0x3f80
.long 0xbf353f35,0x3f553f0e,0x3ec4bf6d,0xbf7bbe48,0x3f353f35,0x3f0ebf55,0xbf6dbec4,0xbe483f7b
.long 0xbf80,0xbf353f35,0x3f800000,0xbf35bf35,0xbf800000,0x3f353f35,0xbf80,0xbf353f35
.long 0x3f35bf35,0xbf7b3e48,0x3f6d3ec4,0xbf0ebf55,0xbf35bf35,0x3e483f7b,0x3ec4bf6d,0xbf553f0e
.long 0xbf800000,0x3ec43f6d,0x3f35bf35,0xbf6dbec4,0x3f80,0x3f6dbec4,0xbf35bf35,0xbec43f6d
.long 0xbf35bf35,0xbe483f7b,0x3f6dbec4,0xbf55bf0e,0xbf353f35,0x3f7b3e48,0xbec4bf6d,0xbf0e3f55
.long 0x3f800000,0xbf6dbec4,0x3f353f35,0xbec4bf6d,0xbf80,0xbec43f6d,0x3f35bf35,0xbf6d3ec4
.long 0x3f353f35,0xbf0ebf55,0x3ec43f6d,0xbe48bf7b,0x3f35bf35,0xbf553f0e,0x3f6dbec4,0xbf7b3e48
.size tab_f2, 16384
.globl colb_kernel
.p2align 8
.type colb_kernel,@function
colb_kernel:
  s_cmp_ge_u32 s2, 280
  s_cbranch_scc0 col_kernel
  s_endpgm
.globl col_kernel
.p2align 8
.type col_kernel,@function
col_kernel:
  s_cmp_ge_u32 s2, 24
  s_cbranch_scc1 L_col_kernel_r1
  s_sub_u32 s3, s2, 0
  s_cmp_ge_u32 s3, 10
  s_cbranch_scc1 L_col_kernel_nz_1
  s_load_dwordx2 s[4:5], s[0:1], 80
  s_lshl_b32 s20, s3, 12
  v_lshl_add_u32 v1, v0, 4, s20
  v_mov_b32 v4, 0
  v_mov_b32 v5, 0
  v_mov_b32 v6, 0
  v_mov_b32 v7, 0
  s_waitcnt lgkmcnt(0)
  s_add_u32 s8, s4, 0x410000
  s_addc_u32 s9, s5, 0
  s_mov_b32 s10, 0xa000
  s_mov_b32 s11, 0x20000
  buffer_store_dwordx4 v[4:7], v1, s[8:11], 0 offen sc0 sc1
  s_branch L_col_kernel_nb_2
L_col_kernel_nz_1:
  s_load_dwordx2 s[4:5], s[0:1], 80
  s_load_dwordx2 s[6:7], s[0:1], 40
  s_sub_u32 s20, s3, 10
  s_lshl_b32 s20, s20, 8
  v_add_lshl_u32 v1, v0, s20, 1
  s_waitcnt lgkmcnt(0)
  s_mov_b32 s8, s6
  s_mov_b32 s9, s7
  s_mov_b32 s10, 0x1c00
  s_mov_b32 s11, 0x20000
  s_add_u32 s12, s4, 0x408000
  s_addc_u32 s13, s5, 0
  s_mov_b32 s14, 0x3800
  s_mov_b32 s15, 0x20000
  buffer_load_ushort v4, v1, s[8:11], 0 offen
  v_lshlrev_b32 v1, 1, v1
  s_waitcnt vmcnt(0)
  v_lshlrev_b32 v4, 16, v4
  v_mul_f32 v4, 0x3eeff558, v4
  buffer_store_dword v4, v1, s[12:15], 0 offen sc0 sc1
L_col_kernel_nb_2:
  v_readfirstlane_b32 s22, v0
  v_and_b32 v1, 63, v0
  s_lshr_b32 s20, s3, 3
  s_lshr_b32 s22, s22, 6
  s_lshl2_add_u32 s20, s20, s22
  s_cmp_ge_u32 s20, 8
  s_cbranch_scc1 L_col_kernel_pfx_3
  s_getpc_b64 s[50:51]
L_col_kernel_pc_4:
  s_sub_u32 s50, s50, L_col_kernel_pc_4-mlpi_kernel
  s_subb_u32 s51, s51, 0
  s_lshl_b32 s52, s20, 13
  v_lshl_add_u32 v2, v1, 7, s52
  v_min_u32 v2, 61436, v2
  global_load_dword v3, v2, s[50:51]
L_col_kernel_pfx_3:
  s_endpgm
L_col_kernel_r1:
  s_cmp_ge_u32 s2, 280
  s_cbranch_scc1 L_col_kernel_r2
  s_sub_u32 s3, s2, 24
  s_load_dwordx2 s[4:5], s[0:1], 80
  v_readfirstlane_b32 s22, v0
  v_and_b32 v3, 31, v0
  v_lshrrev_b32 v4, 5, v0
  v_lshl_add_u32 v5, v4, 7, v3
  s_lshl_b32 s23, s3, 14
  v_and_b32 v1, 63, v0
  s_lshr_b32 s22, s22, 6
  s_lshl_b32 s24, s22, 11
  s_add_u32 s25, s23, s24
  v_lshl_add_u32 v220, v1, 4, s25
  s_lshl_b32 s24, s22, 10
  v_lshl_add_u32 v221, v1, 3, s24
  s_lshl_b32 s24, s22, 12
  s_add_u32 s25, s23, s24
  v_lshl_add_u32 v222, v1, 4, s25
  s_movk_i32 s26, 0x2000
  s_movk_i32 s27, 0x1000
  s_mov_b32 s14, 4194304
  s_mov_b32 s15, 0x20000
  s_mov_b32 s18, 16384
  s_mov_b32 s19, 0x20000
  s_getpc_b64 s[48:49]
L_col_kernel_pc_5:
  s_add_u32 s48, s48, tab_col-L_col_kernel_pc_5
  s_addc_u32 s49, s49, 0
  s_lshl_b32 s50, s22, 12
  v_and_b32 v224, 63, v0
  v_lshl_add_u32 v224, v224, 4, s50
  s_add_u32 m0, s50, 16384
  s_nop 0
  global_load_lds_dwordx4 v224, s[48:49] offset:0
  global_load_lds_dwordx4 v224, s[48:49] offset:1024
  global_load_lds_dwordx4 v224, s[48:49] offset:2048
  global_load_lds_dwordx4 v224, s[48:49] offset:3072
  s_waitcnt lgkmcnt(0)
  s_mov_b32 s12, s4
  s_mov_b32 s13, s5
  s_add_u32 s16, s4, 4194304
  s_addc_u32 s17, s5, 0
  buffer_load_dwordx4 v[156:159], v220, s[12:15], 0 offen offset:0
  buffer_load_dwordx4 v[164:167], v220, s[12:15], s26 offen offset:0
  buffer_load_dwordx4 v[160:163], v220, s[12:15], 0 offen offset:1024
  buffer_load_dwordx4 v[168:171], v220, s[12:15], s26 offen offset:1024
  buffer_load_dwordx2 v[204:205], v221, s[16:19], 0 offen offset:0
  buffer_load_dwordx2 v[206:207], v221, s[16:19], 0 offen offset:512
  buffer_load_dwordx2 v[208:209], v221, s[16:19], s27 offen offset:0
  buffer_load_dwordx2 v[210:211], v221, s[16:19], s27 offen offset:512
  s_add_u32 s8, s4, 0x500000
  s_addc_u32 s9, s5, 0
  s_mov_b32 s10, 0x400000
  s_mov_b32 s11, 0x20000
  buffer_load_dwordx4 v[108:111], v222, s[8:11], 0 offen offset:0
  buffer_load_dwordx4 v[112:115], v222, s[8:11], 0 offen offset:1024
  buffer_load_dwordx4 v[116:119], v222, s[8:11], 0 offen offset:2048
  buffer_load_dwordx4 v[120:123], v222, s[8:11], 0 offen offset:3072
  v_lshlrev_b32 v223, 4, v0
  v_cvt_f32_u32 v8, v5
  v_lshlrev_b32 v2, 4, v1
  v_mul_f32 v8, 0x3a000000, v8
  v_mov_b32 v9, 0x3c800000
  v_mov_b32 v10, v8
  v_fmamk_f32 v11, v9, 0x3f800000, v8
  v_cos_f32 v212, v10
  v_sin_f32 v216, v10
  v_fmamk_f32 v10, v9, 0x40000000, v8
  v_cos_f32 v213, v11
  v_sin_f32 v217, v11
  v_fmamk_f32 v11, v9, 0x40400000, v8
  v_cos_f32 v214, v10
  v_sin_f32 v218, v10
  v_cos_f32 v215, v11
  v_sin_f32 v219, v11
  s_waitcnt vmcnt(12)
  s_barrier
  ds_read_b128 v[12:15], v2 offset:16384
  ds_read_b128 v[16:19], v2 offset:17408
  ds_read_b128 v[20:23], v2 offset:18432
  ds_read_b128 v[24:27], v2 offset:19456
  ds_read_b128 v[28:31], v2 offset:20480
  ds_read_b128 v[32:35], v2 offset:21504
  ds_read_b128 v[36:39], v2 offset:22528
  ds_read_b128 v[40:43], v2 offset:23552
  ds_read_b128 v[44:47], v2 offset:24576
  ds_read_b128 v[48:51], v2 offset:25600
  ds_read_b128 v[52:55], v2 offset:26624
  ds_read_b128 v[56:59], v2 offset:27648
  ds_read_b128 v[60:63], v2 offset:28672
  ds_read_b128 v[64:67], v2 offset:29696
  ds_read_b128 v[68:71], v2 offset:30720
  ds_read_b128 v[72:75], v2 offset:31744
  s_waitcnt vmcnt(10)
  v_lshlrev_b32 v172, 16, v156
  v_and_b32 v176, 0xffff0000, v156
  v_lshlrev_b32 v180, 16, v157
  v_and_b32 v184, 0xffff0000, v157
  v_lshlrev_b32 v188, 16, v164
  v_and_b32 v192, 0xffff0000, v164
  v_lshlrev_b32 v196, 16, v165
  v_and_b32 v200, 0xffff0000, v165
  v_lshlrev_b32 v173, 16, v158
  v_and_b32 v177, 0xffff0000, v158
  v_lshlrev_b32 v181, 16, v159
  v_and_b32 v185, 0xffff0000, v159
  v_lshlrev_b32 v189, 16, v166
  v_and_b32 v193, 0xffff0000, v166
  v_lshlrev_b32 v197, 16, v167
  v_and_b32 v201, 0xffff0000, v167
  s_waitcnt vmcnt(8)
  v_lshlrev_b32 v174, 16, v160
  v_and_b32 v178, 0xffff0000, v160
  v_lshlrev_b32 v182, 16, v161
  v_and_b32 v186, 0xffff0000, v161
  v_lshlrev_b32 v190, 16, v168
  v_and_b32 v194, 0xffff0000, v168
  v_lshlrev_b32 v198, 16, v169
  v_and_b32 v202, 0xffff0000, v169
  v_lshlrev_b32 v175, 16, v162
  v_and_b32 v179, 0xffff0000, v162
  v_lshlrev_b32 v183, 16, v163
  v_and_b32 v187, 0xffff0000, v163
  v_lshlrev_b32 v191, 16, v170
  v_and_b32 v195, 0xffff0000, v170
  v_lshlrev_b32 v199, 16, v171
  v_and_b32 v203, 0xffff0000, v171
  s_waitcnt vmcnt(4)
  v_pk_mul_f32 v[140:141], v[172:173], v[204:205]
  v_pk_mul_f32 v[142:143], v[174:175], v[206:207]
  v_pk_mul_f32 v[144:145], v[176:177], v[204:205]
  v_pk_mul_f32 v[146:147], v[178:179], v[206:207]
  v_pk_fma_f32 v[124:125], v[188:189], v[208:209], v[140:141]
  v_pk_fma_f32 v[140:141], v[188:189], v[208:209], v[140:141] neg_lo:[1,0,0] neg_hi:[1,0,0]
  v_pk_fma_f32 v[126:127], v[190:191], v[210:211], v[142:143]
  v_pk_fma_f32 v[142:143], v[190:191], v[210:211], v[142:143] neg_lo:[1,0,0] neg_hi:[1,0,0]
  v_pk_fma_f32 v[128:129], v[192:193], v[208:209], v[144:145]
  v_pk_fma_f32 v[144:145], v[192:193], v[208:209], v[144:145] neg_lo:[1,0,0] neg_hi:[1,0,0]
  v_pk_fma_f32 v[130:131], v[194:195], v[210:211], v[146:147]
  v_pk_fma_f32 v[146:147], v[194:195], v[210:211], v[146:147] neg_lo:[1,0,0] neg_hi:[1,0,0]
  v_cvt_pk_bf16_f32 v228, v124, v128
  v_cvt_pk_bf16_f32 v229, v125, v129
  v_cvt_pk_bf16_f32 v230, v126, v130
  v_cvt_pk_bf16_f32 v231, v127, v131
  ds_write_b128 v223, v[228:231] offset:0
  v_pk_mul_f32 v[2:3], v[140:141], v[212:213]
  v_pk_mul_f32 v[4:5], v[144:145], v[212:213]
  v_pk_mul_f32 v[6:7], v[142:143], v[214:215]
  v_pk_mul_f32 v[8:9], v[146:147], v[214:215]
  v_pk_fma_f32 v[2:3], v[144:145], v[216:217], v[2:3]
  v_pk_fma_f32 v[4:5], v[140:141], v[216:217], v[4:5] neg_lo:[1,0,0] neg_hi:[1,0,0]
  v_pk_fma_f32 v[6:7], v[146:147], v[218:219], v[6:7]
  v_pk_fma_f32 v[8:9], v[142:143], v[218:219], v[8:9] neg_lo:[1,0,0] neg_hi:[1,0,0]
  v_cvt_pk_bf16_f32 v232, v2, v4
  v_cvt_pk_bf16_f32 v233, v3, v5
  v_cvt_pk_bf16_f32 v234, v6, v8
  v_cvt_pk_bf16_f32 v235, v7, v9
  ds_write_b128 v223, v[232:235] offset:4096
  v_pk_mul_f32 v[148:149], v[180:181], v[204:205]
  v_pk_mul_f32 v[150:151], v[182:183], v[206:207]
  v_pk_mul_f32 v[152:153], v[184:185], v[204:205]
  v_pk_mul_f32 v[154:155], v[186:187], v[206:207]
  v_pk_fma_f32 v[132:133], v[196:197], v[208:209], v[148:149]
  v_pk_fma_f32 v[148:149], v[196:197], v[208:209], v[148:149] neg_lo:[1,0,0] neg_hi:[1,0,0]
  v_pk_fma_f32 v[134:135], v[198:199], v[210:211], v[150:151]
  v_pk_fma_f32 v[150:151], v[198:199], v[210:211], v[150:151] neg_lo:[1,0,0] neg_hi:[1,0,0]
  v_pk_fma_f32 v[136:137], v[200:201], v[208:209], v[152:153]
  v_pk_fma_f32 v[152:153], v[200:201], v[208:209], v[152:153] neg_lo:[1,0,0] neg_hi:[1,0,0]
  v_pk_fma_f32 v[138:139], v[202:203], v[210:211], v[154:155]
  v_pk_fma_f32 v[154:155], v[202:203], v[210:211], v[154:155] neg_lo:[1,0,0] neg_hi:[1,0,0]
  v_cvt_pk_bf16_f32 v236, v132, v136
  v_cvt_pk_bf16_f32 v237, v133, v137
  v_cvt_pk_bf16_f32 v238, v134, v138
  v_cvt_pk_bf16_f32 v239, v135, v139
  ds_write_b128 v223, v[236:239] offset:8192
  v_pk_mul_f32 v[2:3], v[148:149], v[212:213]
  v_pk_mul_f32 v[4:5], v[152:153], v[212:213]
  v_pk_mul_f32 v[6:7], v[150:151], v[214:215]
  v_pk_mul_f32 v[8:9], v[154:155], v[214:215]
  v_pk_fma_f32 v[2:3], v[152:153], v[216:217], v[2:3]
  v_pk_fma_f32 v[4:5], v[148:149], v[216:217], v[4:5] neg_lo:[1,0,0] neg_hi:[1,0,0]
  v_pk_fma_f32 v[6:7], v[154:155], v[218:219], v[6:7]
  v_pk_fma_f32 v[8:9], v[150:151], v[218:219], v[8:9] neg_lo:[1,0,0] neg_hi:[1,0,0]
  v_cvt_pk_bf16_f32 v240, v2, v4
  v_cvt_pk_bf16_f32 v241, v3, v5
  v_cvt_pk_bf16_f32 v242, v6, v8
  v_cvt_pk_bf16_f32 v243, v7, v9
  ds_write_b128 v223, v[240:243] offset:12288
  s_waitcnt lgkmcnt(0)
  s_barrier
  ds_read_b128 v[156:159], v224 offset:0
  ds_read_b128 v[160:163], v224 offset:1024
  ds_read_b128 v[164:167], v224 offset:2048
  ds_read_b128 v[168:171], v224 offset:3072
  s_waitcnt vmcnt(0)
  v_lshlrev_b32 v76, 16, v108
  v_and_b32 v92, 0xffff0000, v108
  v_lshlrev_b32 v77, 16, v109
  v_and_b32 v93, 0xffff0000, v109
  v_lshlrev_b32 v78, 16, v110
  v_and_b32 v94, 0xffff0000, v110
  v_lshlrev_b32 v79, 16, v111
  v_and_b32 v95, 0xffff0000, v111
  s_waitcnt lgkmcnt(3)
  v_mfma_f32_32x32x16_bf16 v[124:139], v[156:159], v[12:15], 0
  v_mfma_f32_32x32x16_bf16 v[140:155], v[156:159], v[28:31], 0
  v_lshlrev_b32 v80, 16, v112
  v_and_b32 v96, 0xffff0000, v112
  v_lshlrev_b32 v81, 16, v113
  v_and_b32 v97, 0xffff0000, v113
  v_lshlrev_b32 v82, 16, v114
  v_and_b32 v98, 0xffff0000, v114
  v_lshlrev_b32 v83, 16, v115
  v_and_b32 v99, 0xffff0000, v115
  s_waitcnt lgkmcnt(2)
  v_mfma_f32_32x32x16_bf16 v[124:139], v[160:163], v[16:19], v[124:139]
  v_mfma_f32_32x32x16_bf16 v[140:155], v[160:163], v[32:35], v[140:155]
  v_lshlrev_b32 v84, 16, v116
  v_and_b32 v100, 0xffff0000, v116
  v_lshlrev_b32 v85, 16, v117
  v_and_b32 v101, 0xffff0000, v117
  v_lshlrev_b32 v86, 16, v118
  v_and_b32 v102, 0xffff0000, v118
  v_lshlrev_b32 v87, 16, v119
  v_and_b32 v103, 0xffff0000, v119
  s_waitcnt lgkmcnt(1)
  v_mfma_f32_32x32x16_bf16 v[124:139], v[164:167], v[20:23], v[124:139]
  v_mfma_f32_32x32x16_bf16 v[140:155], v[164:167], v[36:39], v[140:155]
  v_lshlrev_b32 v88, 16, v120
  v_and_b32 v104, 0xffff0000, v120
  v_lshlrev_b32 v89, 16, v121
  v_and_b32 v105, 0xffff0000, v121
  v_lshlrev_b32 v90, 16, v122
  v_and_b32 v106, 0xffff0000, v122
  v_lshlrev_b32 v91, 16, v123
  v_and_b32 v107, 0xffff0000, v123
  s_waitcnt lgkmcnt(0)
  v_mfma_f32_32x32x16_bf16 v[124:139], v[168:171], v[24:27], v[124:139]
  v_mfma_f32_32x32x16_bf16 v[140:155], v[168:171], v[40:43], v[140:155]
  s_nop 10
  v_pk_mul_f32 v[2:3], v[124:125], v[44:45]
  v_pk_mul_f32 v[4:5], v[140:141], v[44:45]
  v_pk_mul_f32 v[6:7], v[126:127], v[46:47]
  v_pk_mul_f32 v[8:9], v[142:143], v[46:47]
  v_pk_fma_f32 v[2:3], v[140:141], v[60:61], v[2:3]
  v_pk_fma_f32 v[4:5], v[124:125], v[60:61], v[4:5] neg_lo:[1,0,0] neg_hi:[1,0,0]
  v_pk_fma_f32 v[6:7], v[142:143], v[62:63], v[6:7]
  v_pk_fma_f32 v[8:9], v[126:127], v[62:63], v[8:9] neg_lo:[1,0,0] neg_hi:[1,0,0]
  v_cvt_pk_bf16_f32 v108, v2, v4
  v_cvt_pk_bf16_f32 v109, v3, v5
  v_cvt_pk_bf16_f32 v110, v6, v8
  v_cvt_pk_bf16_f32 v111, v7, v9
  v_pk_mul_f32 v[2:3], v[128:129], v[48:49]
  v_pk_mul_f32 v[4:5], v[144:145], v[48:49]
  v_pk_mul_f32 v[6:7], v[130:131], v[50:51]
  v_pk_mul_f32 v[8:9], v[146:147], v[50:51]
  v_pk_fma_f32 v[2:3], v[144:145], v[64:65], v[2:3]
  v_pk_fma_f32 v[4:5], v[128:129], v[64:65], v[4:5] neg_lo:[1,0,0] neg_hi:[1,0,0]
  v_pk_fma_f32 v[6:7], v[146:147], v[66:67], v[6:7]
  v_pk_fma_f32 v[8:9], v[130:131], v[66:67], v[8:9] neg_lo:[1,0,0] neg_hi:[1,0,0]
  v_cvt_pk_bf16_f32 v112, v2, v4
  v_cvt_pk_bf16_f32 v113, v3, v5
  v_cvt_pk_bf16_f32 v114, v6, v8
  v_cvt_pk_bf16_f32 v115, v7, v9
  v_pk_mul_f32 v[2:3], v[132:133], v[52:53]
  v_pk_mul_f32 v[4:5], v[148:149], v[52:53]
  v_pk_mul_f32 v[6:7], v[134:135], v[54:55]
  v_pk_mul_f32 v[8:9], v[150:151], v[54:55]
  v_pk_fma_f32 v[2:3], v[148:149], v[68:69], v[2:3]
  v_pk_fma_f32 v[4:5], v[132:133], v[68:69], v[4:5] neg_lo:[1,0,0] neg_hi:[1,0,0]
  v_pk_fma_f32 v[6:7], v[150:151], v[70:71], v[6:7]
  v_pk_fma_f32 v[8:9], v[134:135], v[70:71], v[8:9] neg_lo:[1,0,0] neg_hi:[1,0,0]
  v_cvt_pk_bf16_f32 v116, v2, v4
  v_cvt_pk_bf16_f32 v117, v3, v5
  v_cvt_pk_bf16_f32 v118, v6, v8
  v_cvt_pk_bf16_f32 v119, v7, v9
  v_pk_mul_f32 v[2:3], v[136:137], v[56:57]
  v_pk_mul_f32 v[4:5], v[152:153], v[56:57]
  v_pk_mul_f32 v[6:7], v[138:139], v[58:59]
  v_pk_mul_f32 v[8:9], v[154:155], v[58:59]
  v_pk_fma_f32 v[2:3], v[152:153], v[72:73], v[2:3]
  v_pk_fma_f32 v[4:5], v[136:137], v[72:73], v[4:5] neg_lo:[1,0,0] neg_hi:[1,0,0]
  v_pk_fma_f32 v[6:7], v[154:155], v[74:75], v[6:7]
  v_pk_fma_f32 v[8:9], v[138:139], v[74:75], v[8:9] neg_lo:[1,0,0] neg_hi:[1,0,0]
  v_cvt_pk_bf16_f32 v120, v2, v4
  v_cvt_pk_bf16_f32 v121, v3, v5
  v_cvt_pk_bf16_f32 v122, v6, v8
  v_cvt_pk_bf16_f32 v123, v7, v9
  v_mfma_f32_32x32x16_bf16 v[228:243], v[12:15], v[108:111], 0
  v_mfma_f32_32x32x16_bf16 v[156:171], v[28:31], v[108:111], 0
  v_mfma_f32_32x32x16_bf16 v[228:243], v[16:19], v[112:115], v[228:243]
  v_mfma_f32_32x32x16_bf16 v[156:171], v[32:35], v[112:115], v[156:171]
  v_mfma_f32_32x32x16_bf16 v[228:243], v[20:23], v[116:119], v[228:243]
  v_mfma_f32_32x32x16_bf16 v[156:171], v[36:39], v[116:119], v[156:171]
  v_mfma_f32_32x32x16_bf16 v[228:243], v[24:27], v[120:123], v[228:243]
  v_mfma_f32_32x32x16_bf16 v[156:171], v[40:43], v[120:123], v[156:171]
  s_nop 10
  v_pk_mul_f32 v[2:3], v[228:229], v[76:77]
  v_pk_mul_f32 v[4:5], v[156:157], v[76:77]
  v_pk_mul_f32 v[6:7], v[230:231], v[78:79]
  v_pk_mul_f32 v[8:9], v[158:159], v[78:79]
  v_pk_fma_f32 v[2:3], v[156:157], v[92:93], v[2:3] neg_lo:[1,0,0] neg_hi:[1,0,0]
  v_pk_fma_f32 v[4:5], v[228:229], v[92:93], v[4:5]
  v_pk_fma_f32 v[6:7], v[158:159], v[94:95], v[6:7] neg_lo:[1,0,0] neg_hi:[1,0,0]
  v_pk_fma_f32 v[8:9], v[230:231], v[94:95], v[8:9]
  v_cvt_pk_bf16_f32 v108, v4, v2
  v_cvt_pk_bf16_f32 v109, v5, v3
  v_cvt_pk_bf16_f32 v110, v8, v6
  v_cvt_pk_bf16_f32 v111, v9, v7
  v_pk_mul_f32 v[2:3], v[232:233], v[80:81]
  v_pk_mul_f32 v[4:5], v[160:161], v[80:81]
  v_pk_mul_f32 v[6:7], v[234:235], v[82:83]
  v_pk_mul_f32 v[8:9], v[162:163], v[82:83]
  v_pk_fma_f32 v[2:3], v[160:161], v[96:97], v[2:3] neg_lo:[1,0,0] neg_hi:[1,0,0]
  v_pk_fma_f32 v[4:5], v[232:233], v[96:97], v[4:5]
  v_pk_fma_f32 v[6:7], v[162:163], v[98:99], v[6:7] neg_lo:[1,0,0] neg_hi:[1,0,0]
  v_pk_fma_f32 v[8:9], v[234:235], v[98:99], v[8:9]
  v_cvt_pk_bf16_f32 v112, v4, v2
  v_cvt_pk_bf16_f32 v113, v5, v3
  v_cvt_pk_bf16_f32 v114, v8, v6
  v_cvt_pk_bf16_f32 v115, v9, v7
  v_pk_mul_f32 v[2:3], v[236:237], v[84:85]
  v_pk_mul_f32 v[4:5], v[164:165], v[84:85]
  v_pk_mul_f32 v[6:7], v[238:239], v[86:87]
  v_pk_mul_f32 v[8:9], v[166:167], v[86:87]
  v_pk_fma_f32 v[2:3], v[164:165], v[100:101], v[2:3] neg_lo:[1,0,0] neg_hi:[1,0,0]
  v_pk_fma_f32 v[4:5], v[236:237], v[100:101], v[4:5]
  v_pk_fma_f32 v[6:7], v[166:167], v[102:103], v[6:7] neg_lo:[1,0,0] neg_hi:[1,0,0]
  v_pk_fma_f32 v[8:9], v[238:239], v[102:103], v[8:9]
  v_cvt_pk_bf16_f32 v116, v4, v2
  v_cvt_pk_bf16_f32 v117, v5, v3
  v_cvt_pk_bf16_f32 v118, v8, v6
  v_cvt_pk_bf16_f32 v119, v9, v7
  v_pk_mul_f32 v[2:3], v[240:241], v[88:89]
  v_pk_mul_f32 v[4:5], v[168:169], v[88:89]
  v_pk_mul_f32 v[6:7], v[242:243], v[90:91]
  v_pk_mul_f32 v[8:9], v[170:171], v[90:91]
  v_pk_fma_f32 v[2:3], v[168:169], v[104:105], v[2:3] neg_lo:[1,0,0] neg_hi:[1,0,0]
  v_pk_fma_f32 v[4:5], v[240:241], v[104:105], v[4:5]
  v_pk_fma_f32 v[6:7], v[170:171], v[106:107], v[6:7] neg_lo:[1,0,0] neg_hi:[1,0,0]
  v_pk_fma_f32 v[8:9], v[242:243], v[106:107], v[8:9]
  v_cvt_pk_bf16_f32 v120, v4, v2
  v_cvt_pk_bf16_f32 v121, v5, v3
  v_cvt_pk_bf16_f32 v122, v8, v6
  v_cvt_pk_bf16_f32 v123, v9, v7
  v_mfma_f32_32x32x16_bf16 v[140:155], v[108:111], v[12:15], 0
  v_mfma_f32_32x32x16_bf16 v[124:139], v[108:111], v[28:31], 0
  v_mfma_f32_32x32x16_bf16 v[140:155], v[112:115], v[16:19], v[140:155]
  v_mfma_f32_32x32x16_bf16 v[124:139], v[112:115], v[32:35], v[124:139]
  v_mfma_f32_32x32x16_bf16 v[140:155], v[116:119], v[20:23], v[140:155]
  v_mfma_f32_32x32x16_bf16 v[124:139], v[116:119], v[36:39], v[124:139]
  v_mfma_f32_32x32x16_bf16 v[140:155], v[120:123], v[24:27], v[140:155]
  v_mfma_f32_32x32x16_bf16 v[124:139], v[120:123], v[40:43], v[124:139]
  s_nop 11
  v_pk_mul_f32 v[2:3], v[124:125], v[44:45]
  v_pk_mul_f32 v[4:5], v[140:141], v[44:45]
  v_pk_mul_f32 v[6:7], v[126:127], v[46:47]
  v_pk_mul_f32 v[8:9], v[142:143], v[46:47]
  v_pk_fma_f32 v[2:3], v[140:141], v[60:61], v[2:3] neg_lo:[1,0,0] neg_hi:[1,0,0]
  v_pk_fma_f32 v[4:5], v[124:125], v[60:61], v[4:5]
  v_pk_fma_f32 v[6:7], v[142:143], v[62:63], v[6:7] neg_lo:[1,0,0] neg_hi:[1,0,0]
  v_pk_fma_f32 v[8:9], v[126:127], v[62:63], v[8:9]
  v_cvt_pk_bf16_f32 v108, v4, v2
  v_cvt_pk_bf16_f32 v109, v5, v3
  v_cvt_pk_bf16_f32 v110, v8, v6
  v_cvt_pk_bf16_f32 v111, v9, v7
  v_pk_mul_f32 v[2:3], v[128:129], v[48:49]
  v_pk_mul_f32 v[4:5], v[144:145], v[48:49]
  v_pk_mul_f32 v[6:7], v[130:131], v[50:51]
  v_pk_mul_f32 v[8:9], v[146:147], v[50:51]
  v_pk_fma_f32 v[2:3], v[144:145], v[64:65], v[2:3] neg_lo:[1,0,0] neg_hi:[1,0,0]
  v_pk_fma_f32 v[4:5], v[128:129], v[64:65], v[4:5]
  v_pk_fma_f32 v[6:7], v[146:147], v[66:67], v[6:7] neg_lo:[1,0,0] neg_hi:[1,0,0]
  v_pk_fma_f32 v[8:9], v[130:131], v[66:67], v[8:9]
  v_cvt_pk_bf16_f32 v112, v4, v2
  v_cvt_pk_bf16_f32 v113, v5, v3
  v_cvt_pk_bf16_f32 v114, v8, v6
  v_cvt_pk_bf16_f32 v115, v9, v7
  v_pk_mul_f32 v[2:3], v[132:133], v[52:53]
  v_pk_mul_f32 v[4:5], v[148:149], v[52:53]
  v_pk_mul_f32 v[6:7], v[134:135], v[54:55]
  v_pk_mul_f32 v[8:9], v[150:151], v[54:55]
  v_pk_fma_f32 v[2:3], v[148:149], v[68:69], v[2:3] neg_lo:[1,0,0] neg_hi:[1,0,0]
  v_pk_fma_f32 v[4:5], v[132:133], v[68:69], v[4:5]
  v_pk_fma_f32 v[6:7], v[150:151], v[70:71], v[6:7] neg_lo:[1,0,0] neg_hi:[1,0,0]
  v_pk_fma_f32 v[8:9], v[134:135], v[70:71], v[8:9]
  v_cvt_pk_bf16_f32 v116, v4, v2
  v_cvt_pk_bf16_f32 v117, v5, v3
  v_cvt_pk_bf16_f32 v118, v8, v6
  v_cvt_pk_bf16_f32 v119, v9, v7
  v_pk_mul_f32 v[2:3], v[136:137], v[56:57]
  v_pk_mul_f32 v[4:5], v[152:153], v[56:57]
  v_pk_mul_f32 v[6:7], v[138:139], v[58:59]
  v_pk_mul_f32 v[8:9], v[154:155], v[58:59]
  v_pk_fma_f32 v[2:3], v[152:153], v[72:73], v[2:3] neg_lo:[1,0,0] neg_hi:[1,0,0]
  v_pk_fma_f32 v[4:5], v[136:137], v[72:73], v[4:5]
  v_pk_fma_f32 v[6:7], v[154:155], v[74:75], v[6:7] neg_lo:[1,0,0] neg_hi:[1,0,0]
  v_pk_fma_f32 v[8:9], v[138:139], v[74:75], v[8:9]
  v_cvt_pk_bf16_f32 v120, v4, v2
  v_cvt_pk_bf16_f32 v121, v5, v3
  v_cvt_pk_bf16_f32 v122, v8, v6
  v_cvt_pk_bf16_f32 v123, v9, v7
  v_mfma_f32_32x32x16_bf16 v[156:171], v[12:15], v[108:111], 0
  v_mfma_f32_32x32x16_bf16 v[228:243], v[28:31], v[108:111], 0
  v_mfma_f32_32x32x16_bf16 v[156:171], v[16:19], v[112:115], v[156:171]
  v_mfma_f32_32x32x16_bf16 v[228:243], v[32:35], v[112:115], v[228:243]
  v_mfma_f32_32x32x16_bf16 v[156:171], v[20:23], v[116:119], v[156:171]
  v_mfma_f32_32x32x16_bf16 v[228:243], v[36:39], v[116:119], v[228:243]
  v_mfma_f32_32x32x16_bf16 v[156:171], v[24:27], v[120:123], v[156:171]
  v_mfma_f32_32x32x16_bf16 v[228:243], v[40:43], v[120:123], v[228:243]
  v_add_u32 v224, s24, v224
  s_mov_b32 s36, 0x3a000000
  s_mov_b32 s37, 0x3a000000
  s_cmp_eq_u32 s3, 0
  s_cselect_b32 s38, 0, s36
  s_mov_b32 s39, s38
  s_nop 4
  ds_write_b128 v224, v[156:159] offset:20480
  ds_write_b128 v224, v[160:163] offset:21504
  ds_write_b128 v224, v[164:167] offset:22528
  ds_write_b128 v224, v[168:171] offset:23552
  ds_write_b128 v224, v[228:231] offset:16384
  ds_write_b128 v224, v[232:235] offset:17408
  ds_write_b128 v224, v[236:239] offset:18432
  ds_write_b128 v224, v[240:243] offset:19456
  s_waitcnt lgkmcnt(0)
  s_barrier
  ds_read_b128 v[84:87], v223 offset:24576
  ds_read_b128 v[88:91], v223 offset:28672
  ds_read_b128 v[100:103], v223 offset:40960
  ds_read_b128 v[104:107], v223 offset:45056
  ds_read_b128 v[76:79], v223 offset:16384
  ds_read_b128 v[80:83], v223 offset:20480
  ds_read_b128 v[92:95], v223 offset:32768
  ds_read_b128 v[96:99], v223 offset:36864
  s_waitcnt lgkmcnt(6)
  v_pk_mul_f32 v[124:125], v[84:85], v[212:213]
  v_pk_mul_f32 v[128:129], v[88:89], v[212:213]
  v_pk_mul_f32 v[126:127], v[86:87], v[214:215]
  v_pk_mul_f32 v[130:131], v[90:91], v[214:215]
  v_pk_fma_f32 v[124:125], v[88:89], v[216:217], v[124:125] neg_lo:[1,0,0] neg_hi:[1,0,0]
  v_pk_fma_f32 v[128:129], v[84:85], v[216:217], v[128:129]
  v_pk_fma_f32 v[126:127], v[90:91], v[218:219], v[126:127] neg_lo:[1,0,0] neg_hi:[1,0,0]
  v_pk_fma_f32 v[130:131], v[86:87], v[218:219], v[130:131]
  s_waitcnt lgkmcnt(4)
  v_pk_mul_f32 v[132:133], v[100:101], v[212:213]
  v_pk_mul_f32 v[136:137], v[104:105], v[212:213]
  v_pk_mul_f32 v[134:135], v[102:103], v[214:215]
  v_pk_mul_f32 v[138:139], v[106:107], v[214:215]
  v_pk_fma_f32 v[132:133], v[104:105], v[216:217], v[132:133] neg_lo:[1,0,0] neg_hi:[1,0,0]
  v_pk_fma_f32 v[136:137], v[100:101], v[216:217], v[136:137]
  v_pk_fma_f32 v[134:135], v[106:107], v[218:219], v[134:135] neg_lo:[1,0,0] neg_hi:[1,0,0]
  v_pk_fma_f32 v[138:139], v[102:103], v[218:219], v[138:139]
  s_waitcnt lgkmcnt(2)
  v_pk_fma_f32 v[172:173], v[76:77], s[36:37], v[172:173]
  v_pk_fma_f32 v[188:189], v[76:77], s[36:37], v[188:189]
  v_pk_fma_f32 v[174:175], v[78:79], s[36:37], v[174:175]
  v_pk_fma_f32 v[190:191], v[78:79], s[36:37], v[190:191]
  v_pk_fma_f32 v[172:173], v[124:125], s[36:37], v[172:173]
  v_pk_fma_f32 v[188:189], v[124:125], s[36:37], v[188:189] neg_lo:[1,0,0] neg_hi:[1,0,0]
  v_pk_fma_f32 v[174:175], v[126:127], s[36:37], v[174:175]
  v_pk_fma_f32 v[190:191], v[126:127], s[36:37], v[190:191] neg_lo:[1,0,0] neg_hi:[1,0,0]
  v_pk_fma_f32 v[176:177], v[80:81], s[38:39], v[176:177]
  v_pk_fma_f32 v[192:193], v[80:81], s[38:39], v[192:193]
  v_pk_fma_f32 v[178:179], v[82:83], s[38:39], v[178:179]
  v_pk_fma_f32 v[194:195], v[82:83], s[38:39], v[194:195]
  v_pk_fma_f32 v[176:177], v[128:129], s[38:39], v[176:177]
  v_pk_fma_f32 v[192:193], v[128:129], s[38:39], v[192:193] neg_lo:[1,0,0] neg_hi:[1,0,0]
  v_pk_fma_f32 v[178:179], v[130:131], s[38:39], v[178:179]
  v_pk_fma_f32 v[194:195], v[130:131], s[38:39], v[194:195] neg_lo:[1,0,0] neg_hi:[1,0,0]
  v_cvt_pk_bf16_f32 v156, v172, v176
  v_cvt_pk_bf16_f32 v158, v173, v177
  v_cvt_pk_bf16_f32 v160, v174, v178
  v_cvt_pk_bf16_f32 v162, v175, v179
  v_cvt_pk_bf16_f32 v164, v188, v192
  v_cvt_pk_bf16_f32 v166, v189, v193
  v_cvt_pk_bf16_f32 v168, v190, v194
  v_cvt_pk_bf16_f32 v170, v191, v195
  s_waitcnt lgkmcnt(0)
  v_pk_fma_f32 v[180:181], v[92:93], s[36:37], v[180:181]
  v_pk_fma_f32 v[196:197], v[92:93], s[36:37], v[196:197]
  v_pk_fma_f32 v[182:183], v[94:95], s[36:37], v[182:183]
  v_pk_fma_f32 v[198:199], v[94:95], s[36:37], v[198:199]
  v_pk_fma_f32 v[180:181], v[132:133], s[36:37], v[180:181]
  v_pk_fma_f32 v[196:197], v[132:133], s[36:37], v[196:197] neg_lo:[1,0,0] neg_hi:[1,0,0]
  v_pk_fma_f32 v[182:183], v[134:135], s[36:37], v[182:183]
  v_pk_fma_f32 v[198:199], v[134:135], s[36:37], v[198:199] neg_lo:[1,0,0] neg_hi:[1,0,0]
  v_pk_fma_f32 v[184:185], v[96:97], s[36:37], v[184:185]
  v_pk_fma_f32 v[200:201], v[96:97], s[36:37], v[200:201]
  v_pk_fma_f32 v[186:187], v[98:99], s[36:37], v[186:187]
  v_pk_fma_f32 v[202:203], v[98:99], s[36:37], v[202:203]
  v_pk_fma_f32 v[184:185], v[136:137], s[36:37], v[184:185]
  v_pk_fma_f32 v[200:201], v[136:137], s[36:37], v[200:201] neg_lo:[1,0,0] neg_hi:[1,0,0]
  v_pk_fma_f32 v[186:187], v[138:139], s[36:37], v[186:187]
  v_pk_fma_f32 v[202:203], v[138:139], s[36:37], v[202:203] neg_lo:[1,0,0] neg_hi:[1,0,0]
  v_cvt_pk_bf16_f32 v157, v180, v184
  v_cvt_pk_bf16_f32 v159, v181, v185
  buffer_store_dwordx4 v[156:159], v220, s[12:15], 0 offen offset:0 sc0 sc1
  v_cvt_pk_bf16_f32 v161, v182, v186
  v_cvt_pk_bf16_f32 v163, v183, v187
  buffer_store_dwordx4 v[160:163], v220, s[12:15], 0 offen offset:1024 sc0 sc1
  v_cvt_pk_bf16_f32 v165, v196, v200
  v_cvt_pk_bf16_f32 v167, v197, v201
  buffer_store_dwordx4 v[164:167], v220, s[12:15], s26 offen offset:0 sc0 sc1
  v_cvt_pk_bf16_f32 v169, v198, v202
  v_cvt_pk_bf16_f32 v171, v199, v203
  buffer_store_dwordx4 v[168:171], v220, s[12:15], s26 offen offset:1024 sc0 sc1
  s_endpgm
L_col_kernel_r2:
  s_cmp_ge_u32 s2, 504
  s_cbranch_scc1 L_col_kernel_end
  s_sub_u32 s3, s2, 280
  s_load_dwordx2 s[4:5], s[0:1], 80
  s_load_dwordx2 s[6:7], s[0:1], 32
  v_readfirstlane_b32 s22, v0
  v_and_b32 v1, 63, v0
  s_and_b32 s20, s3, 7
  s_lshr_b32 s21, s3, 3
  s_mul_i32 s20, s20, 28
  s_add_u32 s20, s20, s21
  s_lshr_b32 s22, s22, 6
  v_lshrrev_b32 v2, 1, v1
  v_mul_u32_u24 v2, 7168, v2
  v_and_b32 v3, 1, v1
  v_lshl_add_u32 v2, v3, 4, v2
  s_lshl_b32 s23, s20, 5
  s_mul_i32 s24, s22, 1835008
  s_add_u32 s23, s23, s24
  v_add_u32 v2, s23, v2
  s_mul_i32 s24, s22, 8320
  s_getpc_b64 s[48:49]
L_col_kernel_pc_6:
  s_sub_u32 s48, s48, L_col_kernel_pc_6-tab_f2
  s_subb_u32 s49, s49, 0
  s_lshl_b32 s50, s22, 12
  v_and_b32 v5, 63, v0
  v_lshl_add_u32 v5, v5, 4, s50
  s_add_u32 m0, s50, 33792
  s_nop 0
  global_load_lds_dwordx4 v5, s[48:49] offset:0
  global_load_lds_dwordx4 v5, s[48:49] offset:1024
  global_load_lds_dwordx4 v5, s[48:49] offset:2048
  global_load_lds_dwordx4 v5, s[48:49] offset:3072
  s_waitcnt lgkmcnt(0)
  s_mov_b32 s8, s6
  s_mov_b32 s9, s7
  s_mov_b32 s10, 0x700000
  s_mov_b32 s11, 0x20000
  s_add_u32 m0, s24, 0
  s_mov_b32 s25, 0
  buffer_load_dwordx4 v2, s[8:11], s25 offen  lds
  s_add_u32 m0, s24, 1040
  s_mov_b32 s25, 229376
  buffer_load_dwordx4 v2, s[8:11], s25 offen  lds
  s_add_u32 m0, s24, 2080
  s_mov_b32 s25, 458752
  buffer_load_dwordx4 v2, s[8:11], s25 offen  lds
  s_add_u32 m0, s24, 3120
  s_mov_b32 s25, 688128
  buffer_load_dwordx4 v2, s[8:11], s25 offen  lds
  s_add_u32 m0, s24, 4160
  s_mov_b32 s25, 917504
  buffer_load_dwordx4 v2, s[8:11], s25 offen  lds
  s_add_u32 m0, s24, 5200
  s_mov_b32 s25, 1146880
  buffer_load_dwordx4 v2, s[8:11], s25 offen  lds
  s_add_u32 m0, s24, 6240
  s_mov_b32 s25, 1376256
  buffer_load_dwordx4 v2, s[8:11], s25 offen  lds
  s_add_u32 m0, s24, 7280
  s_mov_b32 s25, 1605632
  buffer_load_dwordx4 v2, s[8:11], s25 offen  lds
  s_add_u32 s12, s4, 0x900000
  s_addc_u32 s13, s5, 0
  s_mov_b32 s14, 0x700000
  s_mov_b32 s15, 0x20000
  s_mul_i32 s21, s20, 0x124a
  s_lshr_b32 s21, s21, 16
  s_mul_i32 s23, s21, 14
  s_sub_u32 s23, s20, s23
  s_sub_u32 s24, s23, 1
  s_cmp_eq_u32 s23, 7
  s_cselect_b32 s24, 13, s24
  s_cmp_le_u32 s23, 6
  s_cselect_b32 s23, s23, s24
  s_lshl_b32 s23, s23, 2
  s_add_u32 s23, s23, s22
  s_lshl_b32 s23, s23, 2
  v_lshrrev_b32 v226, 3, v1
  v_mul_u32_u24 v226, 28672, v226
  v_and_b32 v225, 7, v1
  s_mul_i32 s25, s21, 458752
  s_lshl_b32 s26, s23, 7
  s_add_u32 s25, s25, s26
  s_and_b32 s27, s23, 7
  s_mov_b64 s[32:33], 1
  v_lshrrev_b32 v2, 5, v1
  v_bfe_u32 v3, v1, 2, 2
  v_lshl_add_u32 v2, v2, 3, v3
  v_mul_u32_u24 v227, 1040, v2
  v_and_b32 v2, 1, v1
  v_lshl_add_u32 v227, v2, 7, v227
  v_bfe_u32 v2, v1, 4, 1
  v_lshl_add_u32 v227, v2, 6, v227
  v_bfe_u32 v2, v1, 1, 1
  v_lshl_add_u32 v227, v2, 5, v227
  s_lshl_b32 s28, s22, 3
  v_add_u32 v227, s28, v227
  v_lshlrev_b32 v5, 4, v1
  s_waitcnt vmcnt(8)
  s_barrier
  ds_read_b128 v[12:15], v5 offset:33792
  ds_read_b128 v[16:19], v5 offset:34816
  ds_read_b128 v[20:23], v5 offset:35840
  ds_read_b128 v[24:27], v5 offset:36864
  ds_read_b128 v[28:31], v5 offset:37888
  ds_read_b128 v[32:35], v5 offset:38912
  ds_read_b128 v[36:39], v5 offset:39936
  ds_read_b128 v[40:43], v5 offset:40960
  ds_read_b128 v[44:47], v5 offset:41984
  ds_read_b128 v[48:51], v5 offset:43008
  ds_read_b128 v[52:55], v5 offset:44032
  ds_read_b128 v[56:59], v5 offset:45056
  ds_read_b128 v[60:63], v5 offset:46080
  ds_read_b128 v[64:67], v5 offset:47104
  ds_read_b128 v[68:71], v5 offset:48128
  ds_read_b128 v[72:75], v5 offset:49152
  s_waitcnt vmcnt(0) lgkmcnt(0)
  s_barrier
  s_load_dwordx2 s[44:45], s[0:1], 48
  s_lshl_b32 s28, s3, 4
  v_lshrrev_b32 v228, 4, v0
  v_add_u32 v228, s28, v228
  v_bfe_u32 v229, v0, 3, 1
  v_and_b32 v230, 7, v0
  v_lshlrev_b32 v230, 4, v230
  v_lshl_add_u32 v231, v228, 8, v230
  v_lshl_add_u32 v228, v228, 11, v230
  v_lshl_add_u32 v228, v229, 10, v228
  v_mul_u32_u24 v229, 917504, v229
  v_add_u32 v231, v231, v229
  s_waitcnt lgkmcnt(0)
  s_mov_b32 s16, s44
  s_mov_b32 s17, s45
  s_mov_b32 s18, 0x700000
  s_mov_b32 s19, 0x20000
  s_add_u32 s44, s4, 0x1000000
  s_addc_u32 s45, s5, 0
  s_mov_b32 s46, 0x1c0000
  s_mov_b32 s47, 0x20000
  buffer_load_dwordx4 v[232:235], v228, s[16:19], 0 offen offset:384 nt
  ds_read_b64_tr_b16 v[76:77], v227 offset:0
  ds_read_b64_tr_b16 v[78:79], v227 offset:4160
  ds_read_b64_tr_b16 v[80:81], v227 offset:16640
  ds_read_b64_tr_b16 v[82:83], v227 offset:20800
  ds_read_b64_tr_b16 v[84:85], v227 offset:256
  ds_read_b64_tr_b16 v[86:87], v227 offset:4416
  ds_read_b64_tr_b16 v[88:89], v227 offset:16896
  ds_read_b64_tr_b16 v[90:91], v227 offset:21056
  s_waitcnt lgkmcnt(4)
  v_mfma_f32_32x32x16_bf16 v[92:107], v[76:79], v[12:15], 0
  v_mfma_f32_32x32x16_bf16 v[108:123], v[76:79], v[20:23], 0
  v_mfma_f32_32x32x16_bf16 v[92:107], v[80:83], v[16:19], v[92:107]
  v_mfma_f32_32x32x16_bf16 v[108:123], v[80:83], v[24:27], v[108:123]
  s_waitcnt lgkmcnt(0)
  v_mfma_f32_32x32x16_bf16 v[124:139], v[84:87], v[12:15], 0
  v_mfma_f32_32x32x16_bf16 v[140:155], v[84:87], v[20:23], 0
  v_mfma_f32_32x32x16_bf16 v[124:139], v[88:91], v[16:19], v[124:139]
  v_mfma_f32_32x32x16_bf16 v[140:155], v[88:91], v[24:27], v[140:155]
  ds_read_b64_tr_b16 v[76:77], v227 offset:512
  ds_read_b64_tr_b16 v[78:79], v227 offset:4672
  ds_read_b64_tr_b16 v[80:81], v227 offset:17152
  ds_read_b64_tr_b16 v[82:83], v227 offset:21312
  s_nop 1
  v_pk_add_f32 v[220:221], v[92:93], 0 op_sel_hi:[1,0]
  v_pk_add_f32 v[222:223], v[94:95], 0 op_sel_hi:[1,0]
  v_pk_add_f32 v[220:221], v[220:221], v[96:97] neg_lo:[0,1] neg_hi:[0,1]
  v_pk_add_f32 v[222:223], v[222:223], v[98:99] neg_lo:[0,1] neg_hi:[0,1]
  v_pk_add_f32 v[220:221], v[220:221], v[100:101]
  v_pk_add_f32 v[222:223], v[222:223], v[102:103]
  v_pk_add_f32 v[220:221], v[220:221], v[104:105] neg_lo:[0,1] neg_hi:[0,1]
  v_pk_add_f32 v[222:223], v[222:223], v[106:107] neg_lo:[0,1] neg_hi:[0,1]
  v_pk_mul_f32 v[2:3], v[92:93], v[28:29] op_sel_hi:[1,0]
  v_pk_mul_f32 v[4:5], v[108:109], v[28:29] op_sel_hi:[1,0]
  v_pk_mul_f32 v[6:7], v[94:95], v[28:29] op_sel_hi:[1,0]
  v_pk_mul_f32 v[8:9], v[110:111], v[28:29] op_sel_hi:[1,0]
  v_pk_fma_f32 v[2:3], v[108:109], v[44:45], v[2:3] op_sel_hi:[1,0,1]
  v_pk_fma_f32 v[4:5], v[92:93], v[44:45], v[4:5] op_sel_hi:[1,0,1] neg_lo:[1,0,0] neg_hi:[1,0,0]
  v_pk_fma_f32 v[6:7], v[110:111], v[44:45], v[6:7] op_sel_hi:[1,0,1]
  v_pk_fma_f32 v[8:9], v[94:95], v[44:45], v[8:9] op_sel_hi:[1,0,1] neg_lo:[1,0,0] neg_hi:[1,0,0]
  v_cvt_pk_bf16_f32 v156, v2, v4
  v_cvt_pk_bf16_f32 v172, v3, v5
  v_cvt_pk_bf16_f32 v188, v6, v8
  v_cvt_pk_bf16_f32 v204, v7, v9
  v_pk_mul_f32 v[2:3], v[96:97], v[28:29] op_sel:[0,1] op_sel_hi:[1,1]
  v_pk_mul_f32 v[4:5], v[112:113], v[28:29] op_sel:[0,1] op_sel_hi:[1,1]
  v_pk_mul_f32 v[6:7], v[98:99], v[28:29] op_sel:[0,1] op_sel_hi:[1,1]
  v_pk_mul_f32 v[8:9], v[114:115], v[28:29] op_sel:[0,1] op_sel_hi:[1,1]
  v_pk_fma_f32 v[2:3], v[112:113], v[44:45], v[2:3] op_sel:[0,1,0] op_sel_hi:[1,1,1]
  v_pk_fma_f32 v[4:5], v[96:97], v[44:45], v[4:5] op_sel:[0,1,0] op_sel_hi:[1,1,1] neg_lo:[1,0,0] neg_hi:[1,0,0]
  v_pk_fma_f32 v[6:7], v[114:115], v[44:45], v[6:7] op_sel:[0,1,0] op_sel_hi:[1,1,1]
  v_pk_fma_f32 v[8:9], v[98:99], v[44:45], v[8:9] op_sel:[0,1,0] op_sel_hi:[1,1,1] neg_lo:[1,0,0] neg_hi:[1,0,0]
  v_cvt_pk_bf16_f32 v157, v2, v4
  v_cvt_pk_bf16_f32 v173, v3, v5
  v_cvt_pk_bf16_f32 v189, v6, v8
  v_cvt_pk_bf16_f32 v205, v7, v9
  v_pk_mul_f32 v[2:3], v[100:101], v[30:31] op_sel_hi:[1,0]
  v_pk_mul_f32 v[4:5], v[116:117], v[30:31] op_sel_hi:[1,0]
  v_pk_mul_f32 v[6:7], v[102:103], v[30:31] op_sel_hi:[1,0]
  v_pk_mul_f32 v[8:9], v[118:119], v[30:31] op_sel_hi:[1,0]
  v_pk_fma_f32 v[2:3], v[116:117], v[46:47], v[2:3] op_sel_hi:[1,0,1]
  v_pk_fma_f32 v[4:5], v[100:101], v[46:47], v[4:5] op_sel_hi:[1,0,1] neg_lo:[1,0,0] neg_hi:[1,0,0]
  v_pk_fma_f32 v[6:7], v[118:119], v[46:47], v[6:7] op_sel_hi:[1,0,1]
  v_pk_fma_f32 v[8:9], v[102:103], v[46:47], v[8:9] op_sel_hi:[1,0,1] neg_lo:[1,0,0] neg_hi:[1,0,0]
  v_cvt_pk_bf16_f32 v158, v2, v4
  v_cvt_pk_bf16_f32 v174, v3, v5
  v_cvt_pk_bf16_f32 v190, v6, v8
  v_cvt_pk_bf16_f32 v206, v7, v9
  v_pk_mul_f32 v[2:3], v[104:105], v[30:31] op_sel:[0,1] op_sel_hi:[1,1]
  v_pk_mul_f32 v[4:5], v[120:121], v[30:31] op_sel:[0,1] op_sel_hi:[1,1]
  v_pk_mul_f32 v[6:7], v[106:107], v[30:31] op_sel:[0,1] op_sel_hi:[1,1]
  v_pk_mul_f32 v[8:9], v[122:123], v[30:31] op_sel:[0,1] op_sel_hi:[1,1]
  v_pk_fma_f32 v[2:3], v[120:121], v[46:47], v[2:3] op_sel:[0,1,0] op_sel_hi:[1,1,1]
  v_pk_fma_f32 v[4:5], v[104:105], v[46:47], v[4:5] op_sel:[0,1,0] op_sel_hi:[1,1,1] neg_lo:[1,0,0] neg_hi:[1,0,0]
  v_pk_fma_f32 v[6:7], v[122:123], v[46:47], v[6:7] op_sel:[0,1,0] op_sel_hi:[1,1,1]
  v_pk_fma_f32 v[8:9], v[106:107], v[46:47], v[8:9] op_sel:[0,1,0] op_sel_hi:[1,1,1] neg_lo:[1,0,0] neg_hi:[1,0,0]
  v_cvt_pk_bf16_f32 v159, v2, v4
  v_cvt_pk_bf16_f32 v175, v3, v5
  v_cvt_pk_bf16_f32 v191, v6, v8
  v_cvt_pk_bf16_f32 v207, v7, v9
  s_waitcnt lgkmcnt(0)
  v_mfma_f32_32x32x16_bf16 v[92:107], v[76:79], v[12:15], 0
  v_mfma_f32_32x32x16_bf16 v[108:123], v[76:79], v[20:23], 0
  v_mfma_f32_32x32x16_bf16 v[92:107], v[80:83], v[16:19], v[92:107]
  v_mfma_f32_32x32x16_bf16 v[108:123], v[80:83], v[24:27], v[108:123]
  ds_read_b64_tr_b16 v[84:85], v227 offset:768
  ds_read_b64_tr_b16 v[86:87], v227 offset:4928
  ds_read_b64_tr_b16 v[88:89], v227 offset:17408
  ds_read_b64_tr_b16 v[90:91], v227 offset:21568
  v_pk_add_f32 v[220:221], v[220:221], v[124:125]
  v_pk_add_f32 v[222:223], v[222:223], v[126:127]
  v_pk_add_f32 v[220:221], v[220:221], v[128:129] neg_lo:[0,1] neg_hi:[0,1]
  v_pk_add_f32 v[222:223], v[222:223], v[130:131] neg_lo:[0,1] neg_hi:[0,1]
  v_pk_add_f32 v[220:221], v[220:221], v[132:133]
  v_pk_add_f32 v[222:223], v[222:223], v[134:135]
  v_pk_add_f32 v[220:221], v[220:221], v[136:137] neg_lo:[0,1] neg_hi:[0,1]
  v_pk_add_f32 v[222:223], v[222:223], v[138:139] neg_lo:[0,1] neg_hi:[0,1]
  v_pk_mul_f32 v[2:3], v[124:125], v[32:33] op_sel_hi:[1,0]
  v_pk_mul_f32 v[4:5], v[140:141], v[32:33] op_sel_hi:[1,0]
  v_pk_mul_f32 v[6:7], v[126:127], v[32:33] op_sel_hi:[1,0]
  v_pk_mul_f32 v[8:9], v[142:143], v[32:33] op_sel_hi:[1,0]
  v_pk_fma_f32 v[2:3], v[140:141], v[48:49], v[2:3] op_sel_hi:[1,0,1]
  v_pk_fma_f32 v[4:5], v[124:125], v[48:49], v[4:5] op_sel_hi:[1,0,1] neg_lo:[1,0,0] neg_hi:[1,0,0]
  v_pk_fma_f32 v[6:7], v[142:143], v[48:49], v[6:7] op_sel_hi:[1,0,1]
  v_pk_fma_f32 v[8:9], v[126:127], v[48:49], v[8:9] op_sel_hi:[1,0,1] neg_lo:[1,0,0] neg_hi:[1,0,0]
  v_cvt_pk_bf16_f32 v160, v2, v4
  v_cvt_pk_bf16_f32 v176, v3, v5
  v_cvt_pk_bf16_f32 v192, v6, v8
  v_cvt_pk_bf16_f32 v208, v7, v9
  v_pk_mul_f32 v[2:3], v[128:129], v[32:33] op_sel:[0,1] op_sel_hi:[1,1]
  v_pk_mul_f32 v[4:5], v[144:145], v[32:33] op_sel:[0,1] op_sel_hi:[1,1]
  v_pk_mul_f32 v[6:7], v[130:131], v[32:33] op_sel:[0,1] op_sel_hi:[1,1]
  v_pk_mul_f32 v[8:9], v[146:147], v[32:33] op_sel:[0,1] op_sel_hi:[1,1]
  v_pk_fma_f32 v[2:3], v[144:145], v[48:49], v[2:3] op_sel:[0,1,0] op_sel_hi:[1,1,1]
  v_pk_fma_f32 v[4:5], v[128:129], v[48:49], v[4:5] op_sel:[0,1,0] op_sel_hi:[1,1,1] neg_lo:[1,0,0] neg_hi:[1,0,0]
  v_pk_fma_f32 v[6:7], v[146:147], v[48:49], v[6:7] op_sel:[0,1,0] op_sel_hi:[1,1,1]
  v_pk_fma_f32 v[8:9], v[130:131], v[48:49], v[8:9] op_sel:[0,1,0] op_sel_hi:[1,1,1] neg_lo:[1,0,0] neg_hi:[1,0,0]
  v_cvt_pk_bf16_f32 v161, v2, v4
  v_cvt_pk_bf16_f32 v177, v3, v5
  v_cvt_pk_bf16_f32 v193, v6, v8
  v_cvt_pk_bf16_f32 v209, v7, v9
  v_pk_mul_f32 v[2:3], v[132:133], v[34:35] op_sel_hi:[1,0]
  v_pk_mul_f32 v[4:5], v[148:149], v[34:35] op_sel_hi:[1,0]
  v_pk_mul_f32 v[6:7], v[134:135], v[34:35] op_sel_hi:[1,0]
  v_pk_mul_f32 v[8:9], v[150:151], v[34:35] op_sel_hi:[1,0]
  v_pk_fma_f32 v[2:3], v[148:149], v[50:51], v[2:3] op_sel_hi:[1,0,1]
  v_pk_fma_f32 v[4:5], v[132:133], v[50:51], v[4:5] op_sel_hi:[1,0,1] neg_lo:[1,0,0] neg_hi:[1,0,0]
  v_pk_fma_f32 v[6:7], v[150:151], v[50:51], v[6:7] op_sel_hi:[1,0,1]
  v_pk_fma_f32 v[8:9], v[134:135], v[50:51], v[8:9] op_sel_hi:[1,0,1] neg_lo:[1,0,0] neg_hi:[1,0,0]
  v_cvt_pk_bf16_f32 v162, v2, v4
  v_cvt_pk_bf16_f32 v178, v3, v5
  v_cvt_pk_bf16_f32 v194, v6, v8
  v_cvt_pk_bf16_f32 v210, v7, v9
  v_pk_mul_f32 v[2:3], v[136:137], v[34:35] op_sel:[0,1] op_sel_hi:[1,1]
  v_pk_mul_f32 v[4:5], v[152:153], v[34:35] op_sel:[0,1] op_sel_hi:[1,1]
  v_pk_mul_f32 v[6:7], v[138:139], v[34:35] op_sel:[0,1] op_sel_hi:[1,1]
  v_pk_mul_f32 v[8:9], v[154:155], v[34:35] op_sel:[0,1] op_sel_hi:[1,1]
  v_pk_fma_f32 v[2:3], v[152:153], v[50:51], v[2:3] op_sel:[0,1,0] op_sel_hi:[1,1,1]
  v_pk_fma_f32 v[4:5], v[136:137], v[50:51], v[4:5] op_sel:[0,1,0] op_sel_hi:[1,1,1] neg_lo:[1,0,0] neg_hi:[1,0,0]
  v_pk_fma_f32 v[6:7], v[154:155], v[50:51], v[6:7] op_sel:[0,1,0] op_sel_hi:[1,1,1]
  v_pk_fma_f32 v[8:9], v[138:139], v[50:51], v[8:9] op_sel:[0,1,0] op_sel_hi:[1,1,1] neg_lo:[1,0,0] neg_hi:[1,0,0]
  v_cvt_pk_bf16_f32 v163, v2, v4
  v_cvt_pk_bf16_f32 v179, v3, v5
  v_cvt_pk_bf16_f32 v195, v6, v8
  v_cvt_pk_bf16_f32 v211, v7, v9
  s_waitcnt lgkmcnt(0)
  v_mfma_f32_32x32x16_bf16 v[124:139], v[84:87], v[12:15], 0
  v_mfma_f32_32x32x16_bf16 v[140:155], v[84:87], v[20:23], 0
  v_mfma_f32_32x32x16_bf16 v[124:139], v[88:91], v[16:19], v[124:139]
  v_mfma_f32_32x32x16_bf16 v[140:155], v[88:91], v[24:27], v[140:155]
  v_pk_add_f32 v[220:221], v[220:221], v[92:93]
  v_pk_add_f32 v[222:223], v[222:223], v[94:95]
  v_pk_add_f32 v[220:221], v[220:221], v[96:97] neg_lo:[0,1] neg_hi:[0,1]
  v_pk_add_f32 v[222:223], v[222:223], v[98:99] neg_lo:[0,1] neg_hi:[0,1]
  v_pk_add_f32 v[220:221], v[220:221], v[100:101]
  v_pk_add_f32 v[222:223], v[222:223], v[102:103]
  v_pk_add_f32 v[220:221], v[220:221], v[104:105] neg_lo:[0,1] neg_hi:[0,1]
  v_pk_add_f32 v[222:223], v[222:223], v[106:107] neg_lo:[0,1] neg_hi:[0,1]
  v_pk_mul_f32 v[2:3], v[92:93], v[36:37] op_sel_hi:[1,0]
  v_pk_mul_f32 v[4:5], v[108:109], v[36:37] op_sel_hi:[1,0]
  v_pk_mul_f32 v[6:7], v[94:95], v[36:37] op_sel_hi:[1,0]
  v_pk_mul_f32 v[8:9], v[110:111], v[36:37] op_sel_hi:[1,0]
  v_pk_fma_f32 v[2:3], v[108:109], v[52:53], v[2:3] op_sel_hi:[1,0,1]
  v_pk_fma_f32 v[4:5], v[92:93], v[52:53], v[4:5] op_sel_hi:[1,0,1] neg_lo:[1,0,0] neg_hi:[1,0,0]
  v_pk_fma_f32 v[6:7], v[110:111], v[52:53], v[6:7] op_sel_hi:[1,0,1]
  v_pk_fma_f32 v[8:9], v[94:95], v[52:53], v[8:9] op_sel_hi:[1,0,1] neg_lo:[1,0,0] neg_hi:[1,0,0]
  v_cvt_pk_bf16_f32 v164, v2, v4
  v_cvt_pk_bf16_f32 v180, v3, v5
  v_cvt_pk_bf16_f32 v196, v6, v8
  v_cvt_pk_bf16_f32 v212, v7, v9
  v_pk_mul_f32 v[2:3], v[96:97], v[36:37] op_sel:[0,1] op_sel_hi:[1,1]
  v_pk_mul_f32 v[4:5], v[112:113], v[36:37] op_sel:[0,1] op_sel_hi:[1,1]
  v_pk_mul_f32 v[6:7], v[98:99], v[36:37] op_sel:[0,1] op_sel_hi:[1,1]
  v_pk_mul_f32 v[8:9], v[114:115], v[36:37] op_sel:[0,1] op_sel_hi:[1,1]
  v_pk_fma_f32 v[2:3], v[112:113], v[52:53], v[2:3] op_sel:[0,1,0] op_sel_hi:[1,1,1]
  v_pk_fma_f32 v[4:5], v[96:97], v[52:53], v[4:5] op_sel:[0,1,0] op_sel_hi:[1,1,1] neg_lo:[1,0,0] neg_hi:[1,0,0]
  v_pk_fma_f32 v[6:7], v[114:115], v[52:53], v[6:7] op_sel:[0,1,0] op_sel_hi:[1,1,1]
  v_pk_fma_f32 v[8:9], v[98:99], v[52:53], v[8:9] op_sel:[0,1,0] op_sel_hi:[1,1,1] neg_lo:[1,0,0] neg_hi:[1,0,0]
  v_cvt_pk_bf16_f32 v165, v2, v4
  v_cvt_pk_bf16_f32 v181, v3, v5
  v_cvt_pk_bf16_f32 v197, v6, v8
  v_cvt_pk_bf16_f32 v213, v7, v9
  v_pk_mul_f32 v[2:3], v[100:101], v[38:39] op_sel_hi:[1,0]
  v_pk_mul_f32 v[4:5], v[116:117], v[38:39] op_sel_hi:[1,0]
  v_pk_mul_f32 v[6:7], v[102:103], v[38:39] op_sel_hi:[1,0]
  v_pk_mul_f32 v[8:9], v[118:119], v[38:39] op_sel_hi:[1,0]
  v_pk_fma_f32 v[2:3], v[116:117], v[54:55], v[2:3] op_sel_hi:[1,0,1]
  v_pk_fma_f32 v[4:5], v[100:101], v[54:55], v[4:5] op_sel_hi:[1,0,1] neg_lo:[1,0,0] neg_hi:[1,0,0]
  v_pk_fma_f32 v[6:7], v[118:119], v[54:55], v[6:7] op_sel_hi:[1,0,1]
  v_pk_fma_f32 v[8:9], v[102:103], v[54:55], v[8:9] op_sel_hi:[1,0,1] neg_lo:[1,0,0] neg_hi:[1,0,0]
  v_cvt_pk_bf16_f32 v166, v2, v4
  v_cvt_pk_bf16_f32 v182, v3, v5
  v_cvt_pk_bf16_f32 v198, v6, v8
  v_cvt_pk_bf16_f32 v214, v7, v9
  v_pk_mul_f32 v[2:3], v[104:105], v[38:39] op_sel:[0,1] op_sel_hi:[1,1]
  v_pk_mul_f32 v[4:5], v[120:121], v[38:39] op_sel:[0,1] op_sel_hi:[1,1]
  v_pk_mul_f32 v[6:7], v[106:107], v[38:39] op_sel:[0,1] op_sel_hi:[1,1]
  v_pk_mul_f32 v[8:9], v[122:123], v[38:39] op_sel:[0,1] op_sel_hi:[1,1]
  v_pk_fma_f32 v[2:3], v[120:121], v[54:55], v[2:3] op_sel:[0,1,0] op_sel_hi:[1,1,1]
  v_pk_fma_f32 v[4:5], v[104:105], v[54:55], v[4:5] op_sel:[0,1,0] op_sel_hi:[1,1,1] neg_lo:[1,0,0] neg_hi:[1,0,0]
  v_pk_fma_f32 v[6:7], v[122:123], v[54:55], v[6:7] op_sel:[0,1,0] op_sel_hi:[1,1,1]
  v_pk_fma_f32 v[8:9], v[106:107], v[54:55], v[8:9] op_sel:[0,1,0] op_sel_hi:[1,1,1] neg_lo:[1,0,0] neg_hi:[1,0,0]
  v_cvt_pk_bf16_f32 v167, v2, v4
  v_cvt_pk_bf16_f32 v183, v3, v5
  v_cvt_pk_bf16_f32 v199, v6, v8
  v_cvt_pk_bf16_f32 v215, v7, v9
  v_pk_add_f32 v[220:221], v[220:221], v[124:125]
  v_pk_add_f32 v[222:223], v[222:223], v[126:127]
  v_pk_add_f32 v[220:221], v[220:221], v[128:129] neg_lo:[0,1] neg_hi:[0,1]
  v_pk_add_f32 v[222:223], v[222:223], v[130:131] neg_lo:[0,1] neg_hi:[0,1]
  v_pk_add_f32 v[220:221], v[220:221], v[132:133]
  v_pk_add_f32 v[222:223], v[222:223], v[134:135]
  v_pk_add_f32 v[220:221], v[220:221], v[136:137] neg_lo:[0,1] neg_hi:[0,1]
  v_pk_add_f32 v[222:223], v[222:223], v[138:139] neg_lo:[0,1] neg_hi:[0,1]
  v_pk_mul_f32 v[2:3], v[124:125], v[40:41] op_sel_hi:[1,0]
  v_pk_mul_f32 v[4:5], v[140:141], v[40:41] op_sel_hi:[1,0]
  v_pk_mul_f32 v[6:7], v[126:127], v[40:41] op_sel_hi:[1,0]
  v_pk_mul_f32 v[8:9], v[142:143], v[40:41] op_sel_hi:[1,0]
  v_pk_fma_f32 v[2:3], v[140:141], v[56:57], v[2:3] op_sel_hi:[1,0,1]
  v_pk_fma_f32 v[4:5], v[124:125], v[56:57], v[4:5] op_sel_hi:[1,0,1] neg_lo:[1,0,0] neg_hi:[1,0,0]
  v_pk_fma_f32 v[6:7], v[142:143], v[56:57], v[6:7] op_sel_hi:[1,0,1]
  v_pk_fma_f32 v[8:9], v[126:127], v[56:57], v[8:9] op_sel_hi:[1,0,1] neg_lo:[1,0,0] neg_hi:[1,0,0]
  v_cvt_pk_bf16_f32 v168, v2, v4
  v_cvt_pk_bf16_f32 v184, v3, v5
  v_cvt_pk_bf16_f32 v200, v6, v8
  v_cvt_pk_bf16_f32 v216, v7, v9
  v_pk_mul_f32 v[2:3], v[128:129], v[40:41] op_sel:[0,1] op_sel_hi:[1,1]
  v_pk_mul_f32 v[4:5], v[144:145], v[40:41] op_sel:[0,1] op_sel_hi:[1,1]
  v_pk_mul_f32 v[6:7], v[130:131], v[40:41] op_sel:[0,1] op_sel_hi:[1,1]
  v_pk_mul_f32 v[8:9], v[146:147], v[40:41] op_sel:[0,1] op_sel_hi:[1,1]
  v_pk_fma_f32 v[2:3], v[144:145], v[56:57], v[2:3] op_sel:[0,1,0] op_sel_hi:[1,1,1]
  v_pk_fma_f32 v[4:5], v[128:129], v[56:57], v[4:5] op_sel:[0,1,0] op_sel_hi:[1,1,1] neg_lo:[1,0,0] neg_hi:[1,0,0]
  v_pk_fma_f32 v[6:7], v[146:147], v[56:57], v[6:7] op_sel:[0,1,0] op_sel_hi:[1,1,1]
  v_pk_fma_f32 v[8:9], v[130:131], v[56:57], v[8:9] op_sel:[0,1,0] op_sel_hi:[1,1,1] neg_lo:[1,0,0] neg_hi:[1,0,0]
  v_cvt_pk_bf16_f32 v169, v2, v4
  v_cvt_pk_bf16_f32 v185, v3, v5
  v_cvt_pk_bf16_f32 v201, v6, v8
  v_cvt_pk_bf16_f32 v217, v7, v9
  v_pk_mul_f32 v[2:3], v[132:133], v[42:43] op_sel_hi:[1,0]
  v_pk_mul_f32 v[4:5], v[148:149], v[42:43] op_sel_hi:[1,0]
  v_pk_mul_f32 v[6:7], v[134:135], v[42:43] op_sel_hi:[1,0]
  v_pk_mul_f32 v[8:9], v[150:151], v[42:43] op_sel_hi:[1,0]
  v_pk_fma_f32 v[2:3], v[148:149], v[58:59], v[2:3] op_sel_hi:[1,0,1]
  v_pk_fma_f32 v[4:5], v[132:133], v[58:59], v[4:5] op_sel_hi:[1,0,1] neg_lo:[1,0,0] neg_hi:[1,0,0]
  v_pk_fma_f32 v[6:7], v[150:151], v[58:59], v[6:7] op_sel_hi:[1,0,1]
  v_pk_fma_f32 v[8:9], v[134:135], v[58:59], v[8:9] op_sel_hi:[1,0,1] neg_lo:[1,0,0] neg_hi:[1,0,0]
  v_cvt_pk_bf16_f32 v170, v2, v4
  v_cvt_pk_bf16_f32 v186, v3, v5
  v_cvt_pk_bf16_f32 v202, v6, v8
  v_cvt_pk_bf16_f32 v218, v7, v9
  v_pk_mul_f32 v[2:3], v[136:137], v[42:43] op_sel:[0,1] op_sel_hi:[1,1]
  v_pk_mul_f32 v[4:5], v[152:153], v[42:43] op_sel:[0,1] op_sel_hi:[1,1]
  v_pk_mul_f32 v[6:7], v[138:139], v[42:43] op_sel:[0,1] op_sel_hi:[1,1]
  v_pk_mul_f32 v[8:9], v[154:155], v[42:43] op_sel:[0,1] op_sel_hi:[1,1]
  v_pk_fma_f32 v[2:3], v[152:153], v[58:59], v[2:3] op_sel:[0,1,0] op_sel_hi:[1,1,1]
  v_pk_fma_f32 v[4:5], v[136:137], v[58:59], v[4:5] op_sel:[0,1,0] op_sel_hi:[1,1,1] neg_lo:[1,0,0] neg_hi:[1,0,0]
  v_pk_fma_f32 v[6:7], v[154:155], v[58:59], v[6:7] op_sel:[0,1,0] op_sel_hi:[1,1,1]
  v_pk_fma_f32 v[8:9], v[138:139], v[58:59], v[8:9] op_sel:[0,1,0] op_sel_hi:[1,1,1] neg_lo:[1,0,0] neg_hi:[1,0,0]
  v_cvt_pk_bf16_f32 v171, v2, v4
  v_cvt_pk_bf16_f32 v187, v3, v5
  v_cvt_pk_bf16_f32 v203, v6, v8
  v_cvt_pk_bf16_f32 v219, v7, v9
  v_readlane_b32 s34, v220, 0
  v_readlane_b32 s35, v220, 32
  v_readlane_b32 s36, v221, 0
  v_readlane_b32 s37, v221, 32
  v_readlane_b32 s38, v222, 0
  v_readlane_b32 s39, v222, 32
  v_readlane_b32 s40, v223, 0
  v_readlane_b32 s41, v223, 32
  v_mfma_f32_32x32x16_bf16 v[92:107], v[60:63], v[156:159], 0
  v_mfma_f32_32x32x16_bf16 v[92:107], v[64:67], v[160:163], v[92:107]
  v_mfma_f32_32x32x16_bf16 v[92:107], v[68:71], v[164:167], v[92:107]
  v_mfma_f32_32x32x16_bf16 v[92:107], v[72:75], v[168:171], v[92:107]
  v_mfma_f32_32x32x16_bf16 v[108:123], v[60:63], v[172:175], 0
  v_mfma_f32_32x32x16_bf16 v[108:123], v[64:67], v[176:179], v[108:123]
  v_mfma_f32_32x32x16_bf16 v[108:123], v[68:71], v[180:183], v[108:123]
  v_mfma_f32_32x32x16_bf16 v[108:123], v[72:75], v[184:187], v[108:123]
  v_mfma_f32_32x32x16_bf16 v[124:139], v[60:63], v[188:191], 0
  v_mfma_f32_32x32x16_bf16 v[124:139], v[64:67], v[192:195], v[124:139]
  v_mfma_f32_32x32x16_bf16 v[124:139], v[68:71], v[196:199], v[124:139]
  v_mfma_f32_32x32x16_bf16 v[124:139], v[72:75], v[200:203], v[124:139]
  v_mfma_f32_32x32x16_bf16 v[140:155], v[60:63], v[204:207], 0
  v_mfma_f32_32x32x16_bf16 v[140:155], v[64:67], v[208:211], v[140:155]
  v_mfma_f32_32x32x16_bf16 v[140:155], v[68:71], v[212:215], v[140:155]
  v_mfma_f32_32x32x16_bf16 v[140:155], v[72:75], v[216:219], v[140:155]
  v_mov_b32 v2, s34
  v_add_f32 v2, s35, v2
  v_mul_f32 v2, 0x3f3504f3, v2
  v_cndmask_b32 v92, v92, v2, s[32:33]
  v_cndmask_b32 v93, v93, 0, s[32:33]
  v_cvt_pk_bf16_f32 v28, v92, v93
  v_cvt_pk_bf16_f32 v29, v94, v95
  v_cvt_pk_bf16_f32 v30, v96, v97
  v_cvt_pk_bf16_f32 v31, v98, v99
  v_cvt_pk_bf16_f32 v32, v100, v101
  v_cvt_pk_bf16_f32 v33, v102, v103
  v_cvt_pk_bf16_f32 v34, v104, v105
  v_cvt_pk_bf16_f32 v35, v106, v107
  s_add_u32 s30, s27, 0
  v_xor_b32 v224, s30, v225
  v_lshl_add_u32 v224, v224, 4, v226
  s_add_u32 s30, s25, 0
  s_add_u32 s31, s25, 229376
  buffer_store_dwordx4 v[28:31], v224, s[12:15], s30 offen sc0 sc1
  buffer_store_dwordx4 v[32:35], v224, s[12:15], s31 offen sc0 sc1
  v_mov_b32 v2, s36
  v_add_f32 v2, s37, v2
  v_mul_f32 v2, 0x3f3504f3, v2
  v_cndmask_b32 v108, v108, v2, s[32:33]
  v_cndmask_b32 v109, v109, 0, s[32:33]
  v_cvt_pk_bf16_f32 v36, v108, v109
  v_cvt_pk_bf16_f32 v37, v110, v111
  v_cvt_pk_bf16_f32 v38, v112, v113
  v_cvt_pk_bf16_f32 v39, v114, v115
  v_cvt_pk_bf16_f32 v40, v116, v117
  v_cvt_pk_bf16_f32 v41, v118, v119
  v_cvt_pk_bf16_f32 v42, v120, v121
  v_cvt_pk_bf16_f32 v43, v122, v123
  s_add_u32 s30, s27, 1
  v_xor_b32 v224, s30, v225
  v_lshl_add_u32 v224, v224, 4, v226
  s_add_u32 s30, s25, 128
  s_add_u32 s31, s25, 229504
  buffer_store_dwordx4 v[36:39], v224, s[12:15], s30 offen sc0 sc1
  buffer_store_dwordx4 v[40:43], v224, s[12:15], s31 offen sc0 sc1
  v_mov_b32 v2, s38
  v_add_f32 v2, s39, v2
  v_mul_f32 v2, 0x3f3504f3, v2
  v_cndmask_b32 v124, v124, v2, s[32:33]
  v_cndmask_b32 v125, v125, 0, s[32:33]
  v_cvt_pk_bf16_f32 v44, v124, v125
  v_cvt_pk_bf16_f32 v45, v126, v127
  v_cvt_pk_bf16_f32 v46, v128, v129
  v_cvt_pk_bf16_f32 v47, v130, v131
  v_cvt_pk_bf16_f32 v48, v132, v133
  v_cvt_pk_bf16_f32 v49, v134, v135
  v_cvt_pk_bf16_f32 v50, v136, v137
  v_cvt_pk_bf16_f32 v51, v138, v139
  s_add_u32 s30, s27, 2
  v_xor_b32 v224, s30, v225
  v_lshl_add_u32 v224, v224, 4, v226
  s_add_u32 s30, s25, 256
  s_add_u32 s31, s25, 229632
  buffer_store_dwordx4 v[44:47], v224, s[12:15], s30 offen sc0 sc1
  buffer_store_dwordx4 v[48:51], v224, s[12:15], s31 offen sc0 sc1
  v_mov_b32 v2, s40
  v_add_f32 v2, s41, v2
  v_mul_f32 v2, 0x3f3504f3, v2
  v_cndmask_b32 v140, v140, v2, s[32:33]
  v_cndmask_b32 v141, v141, 0, s[32:33]
  v_cvt_pk_bf16_f32 v52, v140, v141
  v_cvt_pk_bf16_f32 v53, v142, v143
  v_cvt_pk_bf16_f32 v54, v144, v145
  v_cvt_pk_bf16_f32 v55, v146, v147
  v_cvt_pk_bf16_f32 v56, v148, v149
  v_cvt_pk_bf16_f32 v57, v150, v151
  v_cvt_pk_bf16_f32 v58, v152, v153
  v_cvt_pk_bf16_f32 v59, v154, v155
  s_add_u32 s30, s27, 3
  v_xor_b32 v224, s30, v225
  v_lshl_add_u32 v224, v224, 4, v226
  s_add_u32 s30, s25, 384
  s_add_u32 s31, s25, 229760
  buffer_store_dwordx4 v[52:55], v224, s[12:15], s30 offen sc0 sc1
  buffer_store_dwordx4 v[56:59], v224, s[12:15], s31 offen sc0 sc1
  s_waitcnt vmcnt(8)
  buffer_store_dwordx4 v[232:235], v231, s[44:47], 0 offen sc0 sc1
  s_endpgm
L_col_kernel_end:
  s_endpgm
.p2align 8
.type tab_col,@object
tab_col:
.long 0x3f80,0x3f80,0x3f80,0x3f80,0x3f80,0x3e483f7b,0x3ec43f6d,0x3f0e3f55
.long 0x3f80,0x3ec43f6d,0x3f353f35,0x3f6d3ec4,0x3f80,0x3f0e3f55,0x3f6d3ec4,0x3f7bbe48
.long 0x3f80,0x3f353f35,0x3f800000,0x3f35bf35,0x3f80,0x3f553f0e,0x3f6dbec4,0x3e48bf7b
.long 0x3f80,0x3f6d3ec4,0x3f35bf35,0xbec4bf6d,0x3f80,0x3f7b3e48,0x3ec4bf6d,0xbf55bf0e
.long 0x3f80,0x3f800000,0xbf80,0xbf800000,0x3f80,0x3f7bbe48,0xbec4bf6d,0xbf553f0e
.long 0x3f80,0x3f6dbec4,0xbf35bf35,0xbec43f6d,0x3f80,0x3f55bf0e,0xbf6dbec4,0x3e483f7b
.long 0x3f80,0x3f35bf35,0xbf800000,0x3f353f35,0x3f80,0x3f0ebf55,0xbf6d3ec4,0x3f7b3e48
.long 0x3f80,0x3ec4bf6d,0xbf353f35,0x3f6dbec4,0x3f80,0x3e48bf7b,0xbec43f6d,0x3f0ebf55
.long 0x3f80,0xbf80,0x3f80,0xbf80,0x3f80,0xbe48bf7b,0x3ec43f6d,0xbf0ebf55
.long 0x3f80,0xbec4bf6d,0x3f353f35,0xbf6dbec4,0x3f80,0xbf0ebf55,0x3f6d3ec4,0xbf7b3e48
.long 0x3f80,0xbf35bf35,0x3f800000,0xbf353f35,0x3f80,0xbf55bf0e,0x3f6dbec4,0xbe483f7b
.long 0x3f80,0xbf6dbec4,0x3f35bf35,0x3ec43f6d,0x3f80,0xbf7bbe48,0x3ec4bf6d,0x3f553f0e
.long 0x3f80,0xbf800000,0xbf80,0x3f800000,0x3f80,0xbf7b3e48,0xbec4bf6d,0x3f55bf0e
.long 0x3f80,0xbf6d3ec4,0xbf35bf35,0x3ec4bf6d,0x3f80,0xbf553f0e,0xbf6dbec4,0xbe48bf7b
.long 0x3f80,0xbf353f35,0xbf800000,0xbf35bf35,0x3f80,0xbf0e3f55,0xbf6d3ec4,0xbf7bbe48
.long 0x3f80,0xbec43f6d,0xbf353f35,0xbf6d3ec4,0x3f80,0xbe483f7b,0xbec43f6d,0xbf0e3f55
.long 0x3f80,0x3f80,0x3f80,0x3f80,0x3f353f35,0x3f553f0e,0x3f6d3ec4,0x3f7b3e48
.long 0x3f800000,0x3f6dbec4,0x3f35bf35,0x3ec4bf6d,0x3f35bf35,0x3e48bf7b,0xbec4bf6d,0xbf55bf0e
.long 0xbf80,0xbf35bf35,0xbf800000,0xbf353f35,0xbf35bf35,0xbf7b3e48,0xbec43f6d,0x3f0e3f55
.long 0xbf800000,0xbec43f6d,0x3f353f35,0x3f6dbec4,0xbf353f35,0x3f0e3f55,0x3f6dbec4,0xbe48bf7b
.long 0x3f80,0x3f800000,0xbf80,0xbf800000,0x3f353f35,0x3f0ebf55,0xbf6dbec4,0xbe483f7b
.long 0x3f800000,0xbec4bf6d,0xbf353f35,0x3f6d3ec4,0x3f35bf35,0xbf7bbe48,0x3ec43f6d,0x3f0ebf55
.long 0xbf80,0xbf353f35,0x3f800000,0xbf35bf35,0xbf35bf35,0x3e483f7b,0x3ec4bf6d,0xbf553f0e
.long 0xbf800000,0x3f6d3ec4,0xbf35bf35,0x3ec43f6d,0xbf353f35,0x3f55bf0e,0xbf6d3ec4,0x3f7bbe48
.long 0x3f80,0xbf80,0x3f80,0xbf80,0x3f353f35,0xbf55bf0e,0x3f6d3ec4,0xbf7bbe48
.long 0x3f800000,0xbf6d3ec4,0x3f35bf35,0xbec43f6d,0x3f35bf35,0xbe483f7b,0xbec4bf6d,0x3f553f0e
.long 0xbf80,0x3f353f35,0xbf800000,0x3f35bf35,0xbf35bf35,0x3f7bbe48,0xbec43f6d,0xbf0ebf55
.long 0xbf800000,0x3ec4bf6d,0x3f353f35,0xbf6d3ec4,0xbf353f35,0xbf0ebf55,0x3f6dbec4,0x3e483f7b
.long 0x3f80,0xbf800000,0xbf80,0x3f800000,0x3f353f35,0xbf0e3f55,0xbf6dbec4,0x3e48bf7b
.long 0x3f800000,0x3ec43f6d,0xbf353f35,0xbf6dbec4,0x3f35bf35,0x3f7b3e48,0x3ec43f6d,0xbf0e3f55
.long 0xbf80,0x3f35bf35,0x3f800000,0x3f353f35,0xbf35bf35,0xbe48bf7b,0x3ec4bf6d,0x3f55bf0e
.long 0xbf800000,0xbf6dbec4,0xbf35bf35,0xbec4bf6d,0xbf353f35,0xbf553f0e,0xbf6d3ec4,0xbf7b3e48
.long 0x3f80,0x3f80,0x3f80,0x3f80,0x3f800000,0x3f7bbe48,0x3f6dbec4,0x3f55bf0e
.long 0xbf80,0xbec4bf6d,0xbf35bf35,0xbf6dbec4,0xbf800000,0xbf553f0e,0xbec43f6d,0x3e483f7b
.long 0x3f80,0x3f353f35,0x3f800000,0x3f35bf35,0x3f800000,0x3f0ebf55,0xbec4bf6d,0xbf7bbe48
.long 0xbf80,0xbf6dbec4,0xbf353f35,0x3ec43f6d,0xbf800000,0xbe483f7b,0x3f6d3ec4,0x3f0ebf55
.long 0x3f80,0x3f800000,0xbf80,0xbf800000,0x3f800000,0xbe48bf7b,0xbf6d3ec4,0x3f0e3f55
.long 0xbf80,0xbf6d3ec4,0x3f353f35,0x3ec4bf6d,0xbf800000,0x3f0e3f55,0x3ec4bf6d,0xbf7b3e48
.long 0x3f80,0x3f35bf35,0xbf800000,0x3f353f35,0x3f800000,0xbf55bf0e,0x3ec43f6d,0x3e48bf7b
.long 0xbf80,0xbec43f6d,0x3f35bf35,0xbf6d3ec4,0xbf800000,0x3f7b3e48,0xbf6dbec4,0x3f553f0e
.long 0x3f80,0xbf80,0x3f80,0xbf80,0x3f800000,0xbf7b3e48,0x3f6dbec4,0xbf553f0e
.long 0xbf80,0x3ec43f6d,0xbf35bf35,0x3f6d3ec4,0xbf800000,0x3f55bf0e,0xbec43f6d,0xbe48bf7b
.long 0x3f80,0xbf35bf35,0x3f800000,0xbf353f35,0x3f800000,0xbf0e3f55,0xbec4bf6d,0x3f7b3e48
.long 0xbf80,0x3f6d3ec4,0xbf353f35,0xbec4bf6d,0xbf800000,0x3e48bf7b,0x3f6d3ec4,0xbf0e3f55
.long 0x3f80,0xbf800000,0xbf80,0x3f800000,0x3f800000,0x3e483f7b,0xbf6d3ec4,0xbf0ebf55
.long 0xbf80,0x3f6dbec4,0x3f353f35,0xbec43f6d,0xbf800000,0xbf0ebf55,0x3ec4bf6d,0x3f7bbe48
.long 0x3f80,0xbf353f35,0xbf800000,0xbf35bf35,0x3f800000,0x3f553f0e,0x3ec43f6d,0xbe483f7b
.long 0xbf80,0x3ec4bf6d,0x3f35bf35,0x3f6dbec4,0xbf800000,0xbf7bbe48,0xbf6dbec4,0xbf55bf0e
.long 0x3f80,0x3f80,0x3f80,0x3f80,0x3f35bf35,0x3f0ebf55,0x3ec4bf6d,0x3e48bf7b
.long 0xbf800000,0xbf6d3ec4,0xbf353f35,0xbec43f6d,0x3f353f35,0x3f7b3e48,0x3f6dbec4,0x3f0ebf55
.long 0xbf80,0xbf35bf35,0xbf800000,0xbf353f35,0xbf353f35,0x3e483f7b,0x3f6d3ec4,0x3f55bf0e
.long 0x3f800000,0x3ec4bf6d,0xbf35bf35,0xbf6d3ec4,0xbf35bf35,0xbf553f0e,0x3ec43f6d,0x3f7bbe48
.long 0x3f80,0x3f800000,0xbf80,0xbf800000,0x3f35bf35,0xbf55bf0e,0xbec43f6d,0x3f7b3e48
.long 0xbf800000,0x3ec43f6d,0x3f35bf35,0xbf6dbec4,0x3f353f35,0x3e48bf7b,0xbf6d3ec4,0x3f553f0e
.long 0xbf80,0xbf353f35,0x3f800000,0xbf35bf35,0xbf353f35,0x3f7bbe48,0xbf6dbec4,0x3f0e3f55
.long 0x3f800000,0xbf6dbec4,0x3f353f35,0xbec4bf6d,0xbf35bf35,0x3f0e3f55,0xbec4bf6d,0x3e483f7b
.long 0x3f80,0xbf80,0x3f80,0xbf80,0x3f35bf35,0xbf0e3f55,0x3ec4bf6d,0xbe483f7b
.long 0xbf800000,0x3f6dbec4,0xbf353f35,0x3ec4bf6d,0x3f353f35,0xbf7bbe48,0x3f6dbec4,0xbf0e3f55
.long 0xbf80,0x3f353f35,0xbf800000,0x3f35bf35,0xbf353f35,0xbe48bf7b,0x3f6d3ec4,0xbf553f0e
.long 0x3f800000,0xbec43f6d,0xbf35bf35,0x3f6dbec4,0xbf35bf35,0x3f55bf0e,0x3ec43f6d,0xbf7b3e48
.long 0x3f80,0xbf800000,0xbf80,0x3f800000,0x3f35bf35,0x3f553f0e,0xbec43f6d,0xbf7bbe48
.long 0xbf800000,0xbec4bf6d,0x3f35bf35,0x3f6d3ec4,0x3f353f35,0xbe483f7b,0xbf6d3ec4,0xbf55bf0e
.long 0xbf80,0x3f35bf35,0x3f800000,0x3f353f35,0xbf353f35,0xbf7b3e48,0xbf6dbec4,0xbf0ebf55
.long 0x3f800000,0x3f6d3ec4,0x3f353f35,0x3ec43f6d,0xbf35bf35,0xbf0ebf55,0xbec4bf6d,0xbe48bf7b
.long 0x3f80,0x3f80,0x3f80,0x3f80,0xbf80,0xbe48bf7b,0xbec4bf6d,0xbf0ebf55
.long 0x3f80,0x3ec43f6d,0x3f353f35,0x3f6d3ec4,0xbf80,0xbf0ebf55,0xbf6dbec4,0xbf7b3e48
.long 0x3f80,0x3f353f35,0x3f800000,0x3f35bf35,0xbf80,0xbf55bf0e,0xbf6d3ec4,0xbe483f7b
.long 0x3f80,0x3f6d3ec4,0x3f35bf35,0xbec4bf6d,0xbf80,0xbf7bbe48,0xbec43f6d,0x3f553f0e
.long 0x3f80,0x3f800000,0xbf80,0xbf800000,0xbf80,0xbf7b3e48,0x3ec43f6d,0x3f55bf0e
.long 0x3f80,0x3f6dbec4,0xbf35bf35,0xbec43f6d,0xbf80,0xbf553f0e,0x3f6d3ec4,0xbe48bf7b
.long 0x3f80,0x3f35bf35,0xbf800000,0x3f353f35,0xbf80,0xbf0e3f55,0x3f6dbec4,0xbf7bbe48
.long 0x3f80,0x3ec4bf6d,0xbf353f35,0x3f6dbec4,0xbf80,0xbe483f7b,0x3ec4bf6d,0xbf0e3f55
.long 0x3f80,0xbf80,0x3f80,0xbf80,0xbf80,0x3e483f7b,0xbec4bf6d,0x3f0e3f55
.long 0x3f80,0xbec4bf6d,0x3f353f35,0xbf6dbec4,0xbf80,0x3f0e3f55,0xbf6dbec4,0x3f7bbe48
.long 0x3f80,0xbf35bf35,0x3f800000,0xbf353f35,0xbf80,0x3f553f0e,0xbf6d3ec4,0x3e48bf7b
.long 0x3f80,0xbf6dbec4,0x3f35bf35,0x3ec43f6d,0xbf80,0x3f7b3e48,0xbec43f6d,0xbf55bf0e
.long 0x3f80,0xbf800000,0xbf80,0x3f800000,0xbf80,0x3f7bbe48,0x3ec43f6d,0xbf553f0e
.long 0x3f80,0xbf6d3ec4,0xbf35bf35,0x3ec4bf6d,0xbf80,0x3f55bf0e,0x3f6d3ec4,0x3e483f7b
.long 0x3f80,0xbf353f35,0xbf800000,0xbf35bf35,0xbf80,0x3f0ebf55,0x3f6dbec4,0x3f7b3e48
.long 0x3f80,0xbec43f6d,0xbf353f35,0xbf6d3ec4,0xbf80,0x3e48bf7b,0x3ec4bf6d,0x3f0ebf55
.long 0x3f80,0x3f80,0x3f80,0x3f80,0xbf35bf35,0xbf55bf0e,0xbf6dbec4,0xbf7bbe48
.long 0x3f800000,0x3f6dbec4,0x3f35bf35,0x3ec4bf6d,0xbf353f35,0xbe483f7b,0x3ec43f6d,0x3f553f0e
.long 0xbf80,0xbf35bf35,0xbf800000,0xbf353f35,0x3f353f35,0x3f7bbe48,0x3ec4bf6d,0xbf0ebf55
.long 0xbf800000,0xbec43f6d,0x3f353f35,0x3f6dbec4,0x3f35bf35,0xbf0ebf55,0xbf6d3ec4,0x3e483f7b
.long 0x3f80,0x3f800000,0xbf80,0xbf800000,0xbf35bf35,0xbf0e3f55,0x3f6d3ec4,0x3e48bf7b
.long 0x3f800000,0xbec4bf6d,0xbf353f35,0x3f6d3ec4,0xbf353f35,0x3f7b3e48,0xbec4bf6d,0xbf0e3f55
.long 0xbf80,0xbf353f35,0x3f800000,0xbf35bf35,0x3f353f35,0xbe48bf7b,0xbec43f6d,0x3f55bf0e
.long 0xbf800000,0x3f6d3ec4,0xbf35bf35,0x3ec43f6d,0x3f35bf35,0xbf553f0e,0x3f6dbec4,0xbf7b3e48
.long 0x3f80,0xbf80,0x3f80,0xbf80,0xbf35bf35,0x3f553f0e,0xbf6dbec4,0x3f7b3e48
.long 0x3f800000,0xbf6d3ec4,0x3f35bf35,0xbec43f6d,0xbf353f35,0x3e48bf7b,0x3ec43f6d,0xbf55bf0e
.long 0xbf80,0x3f353f35,0xbf800000,0x3f35bf35,0x3f353f35,0xbf7b3e48,0x3ec4bf6d,0x3f0e3f55
.long 0xbf800000,0x3ec4bf6d,0x3f353f35,0xbf6d3ec4,0x3f35bf35,0x3f0e3f55,0xbf6d3ec4,0xbe48bf7b
.long 0x3f80,0xbf800000,0xbf80,0x3f800000,0xbf35bf35,0x3f0ebf55,0x3f6d3ec4,0xbe483f7b
.long 0x3f800000,0x3ec43f6d,0xbf353f35,0xbf6dbec4,0xbf353f35,0xbf7bbe48,0xbec4bf6d,0x3f0ebf55
.long 0xbf80,0x3f35bf35,0x3f800000,0x3f353f35,0x3f353f35,0x3e483f7b,0xbec43f6d,0xbf553f0e
.long 0xbf800000,0xbf6dbec4,0xbf35bf35,0xbec4bf6d,0x3f35bf35,0x3f55bf0e,0x3f6dbec4,0x3f7bbe48
.long 0x3f80,0x3f80,0x3f80,0x3f80,0xbf800000,0xbf7b3e48,0xbf6d3ec4,0xbf553f0e
.long 0xbf80,0xbec4bf6d,0xbf35bf35,0xbf6dbec4,0x3f800000,0x3f55bf0e,0x3ec4bf6d,0xbe48bf7b
.long 0x3f80,0x3f353f35,0x3f800000,0x3f35bf35,0xbf800000,0xbf0e3f55,0x3ec43f6d,0x3f7b3e48
.long 0xbf80,0xbf6dbec4,0xbf353f35,0x3ec43f6d,0x3f800000,0x3e48bf7b,0xbf6dbec4,0xbf0e3f55
.long 0x3f80,0x3f800000,0xbf80,0xbf800000,0xbf800000,0x3e483f7b,0x3f6dbec4,0xbf0ebf55
.long 0xbf80,0xbf6d3ec4,0x3f353f35,0x3ec4bf6d,0x3f800000,0xbf0ebf55,0xbec43f6d,0x3f7bbe48
.long 0x3f80,0x3f35bf35,0xbf800000,0x3f353f35,0xbf800000,0x3f553f0e,0xbec4bf6d,0xbe483f7b
.long 0xbf80,0xbec43f6d,0x3f35bf35,0xbf6d3ec4,0x3f800000,0xbf7bbe48,0x3f6d3ec4,0xbf55bf0e
.long 0x3f80,0xbf80,0x3f80,0xbf80,0xbf800000,0x3f7bbe48,0xbf6d3ec4,0x3f55bf0e
.long 0xbf80,0x3ec43f6d,0xbf35bf35,0x3f6d3ec4,0x3f800000,0xbf553f0e,0x3ec4bf6d,0x3e483f7b
.long 0x3f80,0xbf35bf35,0x3f800000,0xbf353f35,0xbf800000,0x3f0ebf55,0x3ec43f6d,0xbf7bbe48
.long 0xbf80,0x3f6d3ec4,0xbf353f35,0xbec4bf6d,0x3f800000,0xbe483f7b,0xbf6dbec4,0x3f0ebf55
.long 0x3f80,0xbf800000,0xbf80,0x3f800000,0xbf800000,0xbe48bf7b,0x3f6dbec4,0x3f0e3f55
.long 0xbf80,0x3f6dbec4,0x3f353f35,0xbec43f6d,0x3f800000,0x3f0e3f55,0xbec43f6d,0xbf7b3e48
.long 0x3f80,0xbf353f35,0xbf800000,0xbf35bf35,0xbf800000,0xbf55bf0e,0xbec4bf6d,0x3e48bf7b
.long 0xbf80,0x3ec4bf6d,0x3f35bf35,0x3f6dbec4,0x3f800000,0x3f7b3e48,0x3f6d3ec4,0x3f553f0e
.long 0x3f80,0x3f80,0x3f80,0x3f80,0xbf353f35,0xbf0e3f55,0xbec43f6d,0xbe483f7b
.long 0xbf800000,0xbf6d3ec4,0xbf353f35,0xbec43f6d,0xbf35bf35,0xbf7bbe48,0xbf6d3ec4,0xbf0e3f55
.long 0xbf80,0xbf35bf35,0xbf800000,0xbf353f35,0x3f35bf35,0xbe48bf7b,0xbf6dbec4,0xbf553f0e
.long 0x3f800000,0x3ec4bf6d,0xbf35bf35,0xbf6d3ec4,0x3f353f35,0x3f55bf0e,0xbec4bf6d,0xbf7b3e48
.long 0x3f80,0x3f800000,0xbf80,0xbf800000,0xbf353f35,0x3f553f0e,0x3ec4bf6d,0xbf7bbe48
.long 0xbf800000,0x3ec43f6d,0x3f35bf35,0xbf6dbec4,0xbf35bf35,0xbe483f7b,0x3f6dbec4,0xbf55bf0e
.long 0xbf80,0xbf353f35,0x3f800000,0xbf35bf35,0x3f35bf35,0xbf7b3e48,0x3f6d3ec4,0xbf0ebf55
.long 0x3f800000,0xbf6dbec4,0x3f353f35,0xbec4bf6d,0x3f353f35,0xbf0ebf55,0x3ec43f6d,0xbe48bf7b
.long 0x3f80,0xbf80,0x3f80,0xbf80,0xbf353f35,0x3f0ebf55,0xbec43f6d,0x3e48bf7b
.long 0xbf800000,0x3f6dbec4,0xbf353f35,0x3ec4bf6d,0xbf35bf35,0x3f7b3e48,0xbf6d3ec4,0x3f0ebf55
.long 0xbf80,0x3f353f35,0xbf800000,0x3f35bf35,0x3f35bf35,0x3e483f7b,0xbf6dbec4,0x3f55bf0e
.long 0x3f800000,0xbec43f6d,0xbf35bf35,0x3f6dbec4,0x3f353f35,0xbf553f0e,0xbec4bf6d,0x3f7bbe48
.long 0x3f80,0xbf800000,0xbf80,0x3f800000,0xbf353f35,0xbf55bf0e,0x3ec4bf6d,0x3f7b3e48
.long 0xbf800000,0xbec4bf6d,0x3f35bf35,0x3f6d3ec4,0xbf35bf35,0x3e48bf7b,0x3f6dbec4,0x3f553f0e
.long 0xbf80,0x3f35bf35,0x3f800000,0x3f353f35,0x3f35bf35,0x3f7bbe48,0x3f6d3ec4,0x3f0e3f55
.long 0x3f800000,0x3f6d3ec4,0x3f353f35,0x3ec43f6d,0x3f353f35,0x3f0e3f55,0x3ec43f6d,0x3e483f7b
.long 0x3f808000,0x3f808000,0x3f808000,0x3f808000,0x3f808000,0x3f7bbe48,0x3f6dbec4,0x3f55bf0e
.long 0x3f808000,0x3f6dbec4,0x3f35bf35,0x3ec4bf6d,0x3f808000,0x3f55bf0e,0x3ec4bf6d,0xbe48bf7b
.long 0x3f808000,0x3f35bf35,0xbf80,0xbf35bf35,0x3f808000,0x3f0ebf55,0xbec4bf6d,0xbf7bbe48
.long 0x3f808000,0x3ec4bf6d,0xbf35bf35,0xbf6d3ec4,0x3f808000,0x3e48bf7b,0xbf6dbec4,0xbf0e3f55
.long 0x3f808000,0xbf80,0xbf808000,0x3f80,0x3f808000,0xbe48bf7b,0xbf6d3ec4,0x3f0e3f55
.long 0x3f808000,0xbec4bf6d,0xbf353f35,0x3f6d3ec4,0x3f808000,0xbf0ebf55,0xbec43f6d,0x3f7bbe48
.long 0x3f808000,0xbf35bf35,0x3f80,0x3f35bf35,0x3f808000,0xbf55bf0e,0x3ec43f6d,0x3e48bf7b
.long 0x3f808000,0xbf6dbec4,0x3f353f35,0xbec4bf6d,0x3f808000,0xbf7bbe48,0x3f6d3ec4,0xbf55bf0e
.long 0x3f808000,0xbf808000,0x3f808000,0xbf808000,0x3f808000,0xbf7b3e48,0x3f6dbec4,0xbf553f0e
.long 0x3f808000,0xbf6d3ec4,0x3f35bf35,0xbec43f6d,0x3f808000,0xbf553f0e,0x3ec4bf6d,0x3e483f7b
.long 0x3f808000,0xbf353f35,0xbf80,0x3f353f35,0x3f808000,0xbf0e3f55,0xbec4bf6d,0x3f7b3e48
.long 0x3f808000,0xbec43f6d,0xbf35bf35,0x3f6dbec4,0x3f808000,0xbe483f7b,0xbf6dbec4,0x3f0ebf55
.long 0x3f808000,0x3f80,0xbf808000,0xbf80,0x3f808000,0x3e483f7b,0xbf6d3ec4,0xbf0ebf55
.long 0x3f808000,0x3ec43f6d,0xbf353f35,0xbf6dbec4,0x3f808000,0x3f0e3f55,0xbec43f6d,0xbf7b3e48
.long 0x3f808000,0x3f353f35,0x3f80,0xbf353f35,0x3f808000,0x3f553f0e,0x3ec43f6d,0xbe483f7b
.long 0x3f808000,0x3f6d3ec4,0x3f353f35,0x3ec43f6d,0x3f808000,0x3f7b3e48,0x3f6d3ec4,0x3f553f0e
.long 0x3f808000,0x3f808000,0x3f808000,0x3f808000,0x3f35bf35,0x3f0ebf55,0x3ec4bf6d,0x3e48bf7b
.long 0xbf80,0xbec4bf6d,0xbf35bf35,0xbf6dbec4,0xbf35bf35,0xbf7bbe48,0xbf6d3ec4,0xbf0e3f55
.long 0xbf808000,0xbf353f35,0x3f80,0x3f353f35,0xbf353f35,0x3e483f7b,0x3f6d3ec4,0x3f55bf0e
.long 0x3f80,0x3f6d3ec4,0x3f35bf35,0xbec4bf6d,0x3f353f35,0x3f55bf0e,0xbec4bf6d,0xbf7b3e48
.long 0x3f808000,0xbf80,0xbf808000,0x3f80,0x3f35bf35,0xbf55bf0e,0xbec43f6d,0x3f7b3e48
.long 0xbf80,0xbf6d3ec4,0x3f353f35,0x3ec4bf6d,0xbf35bf35,0xbe483f7b,0x3f6dbec4,0xbf55bf0e
.long 0xbf808000,0x3f353f35,0xbf80,0xbf353f35,0xbf353f35,0x3f7bbe48,0xbf6dbec4,0x3f0e3f55
.long 0x3f80,0x3ec4bf6d,0xbf353f35,0x3f6dbec4,0x3f353f35,0xbf0ebf55,0x3ec43f6d,0xbe48bf7b
.long 0x3f808000,0xbf808000,0x3f808000,0xbf808000,0x3f35bf35,0xbf0e3f55,0x3ec4bf6d,0xbe483f7b
.long 0xbf80,0x3ec43f6d,0xbf35bf35,0x3f6d3ec4,0xbf35bf35,0x3f7b3e48,0xbf6d3ec4,0x3f0ebf55
.long 0xbf808000,0x3f35bf35,0x3f80,0xbf35bf35,0xbf353f35,0xbe48bf7b,0x3f6d3ec4,0xbf553f0e
.long 0x3f80,0xbf6dbec4,0x3f35bf35,0x3ec43f6d,0x3f353f35,0xbf553f0e,0xbec4bf6d,0x3f7bbe48
.long 0x3f808000,0x3f80,0xbf808000,0xbf80,0x3f35bf35,0x3f553f0e,0xbec43f6d,0xbf7bbe48
.long 0xbf80,0x3f6dbec4,0x3f353f35,0xbec43f6d,0xbf35bf35,0x3e48bf7b,0x3f6dbec4,0x3f553f0e
.long 0xbf808000,0xbf35bf35,0xbf80,0x3f35bf35,0xbf353f35,0xbf7b3e48,0xbf6dbec4,0xbf0ebf55
.long 0x3f80,0xbec43f6d,0xbf353f35,0xbf6d3ec4,0x3f353f35,0x3f0e3f55,0x3ec43f6d,0x3e483f7b
.long 0x3f808000,0x3f808000,0x3f808000,0x3f808000,0xbf80,0xbe48bf7b,0xbec4bf6d,0xbf0ebf55
.long 0xbf808000,0xbf6d3ec4,0xbf353f35,0xbec43f6d,0x3f80,0x3f0e3f55,0x3f6d3ec4,0x3f7bbe48
.long 0x3f808000,0x3f35bf35,0xbf80,0xbf35bf35,0xbf80,0xbf55bf0e,0xbf6d3ec4,0xbe483f7b
.long 0xbf808000,0xbec43f6d,0x3f353f35,0x3f6dbec4,0x3f80,0x3f7b3e48,0x3ec4bf6d,0xbf55bf0e
.long 0x3f808000,0xbf80,0xbf808000,0x3f80,0xbf80,0xbf7b3e48,0x3ec43f6d,0x3f55bf0e
.long 0xbf808000,0x3ec43f6d,0x3f35bf35,0xbf6dbec4,0x3f80,0x3f55bf0e,0xbf6dbec4,0x3e483f7b
.long 0x3f808000,0xbf35bf35,0x3f80,0x3f35bf35,0xbf80,0xbf0e3f55,0x3f6dbec4,0xbf7bbe48
.long 0xbf808000,0x3f6d3ec4,0xbf35bf35,0x3ec43f6d,0x3f80,0x3e48bf7b,0xbec43f6d,0x3f0ebf55
.long 0x3f808000,0xbf808000,0x3f808000,0xbf808000,0xbf80,0x3e483f7b,0xbec4bf6d,0x3f0e3f55
.long 0xbf808000,0x3f6dbec4,0xbf353f35,0x3ec4bf6d,0x3f80,0xbf0ebf55,0x3f6d3ec4,0xbf7b3e48
.long 0x3f808000,0xbf353f35,0xbf80,0x3f353f35,0xbf80,0x3f553f0e,0xbf6d3ec4,0x3e48bf7b
.long 0xbf808000,0x3ec4bf6d,0x3f353f35,0xbf6d3ec4,0x3f80,0xbf7bbe48,0x3ec4bf6d,0x3f553f0e
.long 0x3f808000,0x3f80,0xbf808000,0xbf80,0xbf80,0x3f7bbe48,0x3ec43f6d,0xbf553f0e
.long 0xbf808000,0xbec4bf6d,0x3f35bf35,0x3f6d3ec4,0x3f80,0xbf553f0e,0xbf6dbec4,0xbe48bf7b
.long 0x3f808000,0x3f353f35,0x3f80,0xbf353f35,0xbf80,0x3f0ebf55,0x3f6dbec4,0x3f7b3e48
.long 0xbf808000,0xbf6dbec4,0xbf35bf35,0xbec4bf6d,0x3f80,0xbe483f7b,0xbec43f6d,0xbf0e3f55
.long 0x3f808000,0x3f808000,0x3f808000,0x3f808000,0xbf35bf35,0xbf55bf0e,0xbf6dbec4,0xbf7bbe48
.long 0x3f80,0x3ec43f6d,0x3f353f35,0x3f6d3ec4,0x3f35bf35,0x3e48bf7b,0xbec4bf6d,0xbf55bf0e
.long 0xbf808000,0xbf353f35,0x3f80,0x3f353f35,0x3f353f35,0x3f7bbe48,0x3ec4bf6d,0xbf0ebf55
.long 0xbf80,0xbf6dbec4,0xbf353f35,0x3ec43f6d,0xbf353f35,0x3f0e3f55,0x3f6dbec4,0xbe48bf7b
.long 0x3f808000,0xbf80,0xbf808000,0x3f80,0xbf35bf35,0xbf0e3f55,0x3f6d3ec4,0x3e48bf7b
.long 0x3f80,0x3f6dbec4,0xbf35bf35,0xbec43f6d,0x3f35bf35,0xbf7bbe48,0x3ec43f6d,0x3f0ebf55
.long 0xbf808000,0x3f353f35,0xbf80,0xbf353f35,0x3f353f35,0xbe48bf7b,0xbec43f6d,0x3f55bf0e
.long 0xbf80,0xbec43f6d,0x3f35bf35,0xbf6d3ec4,0xbf353f35,0x3f55bf0e,0xbf6d3ec4,0x3f7bbe48
.long 0x3f808000,0xbf808000,0x3f808000,0xbf808000,0xbf35bf35,0x3f553f0e,0xbf6dbec4,0x3f7b3e48
.long 0x3f80,0xbec4bf6d,0x3f353f35,0xbf6dbec4,0x3f35bf35,0xbe483f7b,0xbec4bf6d,0x3f553f0e
.long 0xbf808000,0x3f35bf35,0x3f80,0xbf35bf35,0x3f353f35,0xbf7b3e48,0x3ec4bf6d,0x3f0e3f55
.long 0xbf80,0x3f6d3ec4,0xbf353f35,0xbec4bf6d,0xbf353f35,0xbf0ebf55,0x3f6dbec4,0x3e483f7b
.long 0x3f808000,0x3f80,0xbf808000,0xbf80,0xbf35bf35,0x3f0ebf55,0x3f6d3ec4,0xbe483f7b
.long 0x3f80,0xbf6d3ec4,0xbf35bf35,0x3ec4bf6d,0x3f35bf35,0x3f7b3e48,0x3ec43f6d,0xbf0e3f55
.long 0xbf808000,0xbf35bf35,0xbf80,0x3f35bf35,0x3f353f35,0x3e483f7b,0xbec43f6d,0xbf553f0e
.long 0xbf80,0x3ec4bf6d,0x3f35bf35,0x3f6dbec4,0xbf353f35,0xbf553f0e,0xbf6d3ec4,0xbf7b3e48
.long 0x3f808000,0x3f808000,0x3f808000,0x3f808000,0xbf808000,0xbf7b3e48,0xbf6d3ec4,0xbf553f0e
.long 0x3f808000,0x3f6dbec4,0x3f35bf35,0x3ec4bf6d,0xbf808000,0xbf553f0e,0xbec43f6d,0x3e483f7b
.long 0x3f808000,0x3f35bf35,0xbf80,0xbf35bf35,0xbf808000,0xbf0e3f55,0x3ec43f6d,0x3f7b3e48
.long 0x3f808000,0x3ec4bf6d,0xbf35bf35,0xbf6d3ec4,0xbf808000,0xbe483f7b,0x3f6d3ec4,0x3f0ebf55
.long 0x3f808000,0xbf80,0xbf808000,0x3f80,0xbf808000,0x3e483f7b,0x3f6dbec4,0xbf0ebf55
.long 0x3f808000,0xbec4bf6d,0xbf353f35,0x3f6d3ec4,0xbf808000,0x3f0e3f55,0x3ec4bf6d,0xbf7b3e48
.long 0x3f808000,0xbf35bf35,0x3f80,0x3f35bf35,0xbf808000,0x3f553f0e,0xbec4bf6d,0xbe483f7b
.long 0x3f808000,0xbf6dbec4,0x3f353f35,0xbec4bf6d,0xbf808000,0x3f7b3e48,0xbf6dbec4,0x3f553f0e
.long 0x3f808000,0xbf808000,0x3f808000,0xbf808000,0xbf808000,0x3f7bbe48,0xbf6d3ec4,0x3f55bf0e
.long 0x3f808000,0xbf6d3ec4,0x3f35bf35,0xbec43f6d,0xbf808000,0x3f55bf0e,0xbec43f6d,0xbe48bf7b
.long 0x3f808000,0xbf353f35,0xbf80,0x3f353f35,0xbf808000,0x3f0ebf55,0x3ec43f6d,0xbf7bbe48
.long 0x3f808000,0xbec43f6d,0xbf35bf35,0x3f6dbec4,0xbf808000,0x3e48bf7b,0x3f6d3ec4,0xbf0e3f55
.long 0x3f808000,0x3f80,0xbf808000,0xbf80,0xbf808000,0xbe48bf7b,0x3f6dbec4,0x3f0e3f55
.long 0x3f808000,0x3ec43f6d,0xbf353f35,0xbf6dbec4,0xbf808000,0xbf0ebf55,0x3ec4bf6d,0x3f7bbe48
.long 0x3f808000,0x3f353f35,0x3f80,0xbf353f35,0xbf808000,0xbf55bf0e,0xbec4bf6d,0x3e48bf7b
.long 0x3f808000,0x3f6d3ec4,0x3f353f35,0x3ec43f6d,0xbf808000,0xbf7bbe48,0xbf6dbec4,0xbf55bf0e
.long 0x3f808000,0x3f808000,0x3f808000,0x3f808000,0xbf353f35,0xbf0e3f55,0xbec43f6d,0xbe483f7b
.long 0xbf80,0xbec4bf6d,0xbf35bf35,0xbf6dbec4,0x3f353f35,0x3f7b3e48,0x3f6dbec4,0x3f0ebf55
.long 0xbf808000,0xbf353f35,0x3f80,0x3f353f35,0x3f35bf35,0xbe48bf7b,0xbf6dbec4,0xbf553f0e
.long 0x3f80,0x3f6d3ec4,0x3f35bf35,0xbec4bf6d,0xbf35bf35,0xbf553f0e,0x3ec43f6d,0x3f7bbe48
.long 0x3f808000,0xbf80,0xbf808000,0x3f80,0xbf353f35,0x3f553f0e,0x3ec4bf6d,0xbf7bbe48
.long 0xbf80,0xbf6d3ec4,0x3f353f35,0x3ec4bf6d,0x3f353f35,0x3e48bf7b,0xbf6d3ec4,0x3f553f0e
.long 0xbf808000,0x3f353f35,0xbf80,0xbf353f35,0x3f35bf35,0xbf7b3e48,0x3f6d3ec4,0xbf0ebf55
.long 0x3f80,0x3ec4bf6d,0xbf353f35,0x3f6dbec4,0xbf35bf35,0x3f0e3f55,0xbec4bf6d,0x3e483f7b
.long 0x3f808000,0xbf808000,0x3f808000,0xbf808000,0xbf353f35,0x3f0ebf55,0xbec43f6d,0x3e48bf7b
.long 0xbf80,0x3ec43f6d,0xbf35bf35,0x3f6d3ec4,0x3f353f35,0xbf7bbe48,0x3f6dbec4,0xbf0e3f55
.long 0xbf808000,0x3f35bf35,0x3f80,0xbf35bf35,0x3f35bf35,0x3e483f7b,0xbf6dbec4,0x3f55bf0e
.long 0x3f80,0xbf6dbec4,0x3f35bf35,0x3ec43f6d,0xbf35bf35,0x3f55bf0e,0x3ec43f6d,0xbf7b3e48
.long 0x3f808000,0x3f80,0xbf808000,0xbf80,0xbf353f35,0xbf55bf0e,0x3ec4bf6d,0x3f7b3e48
.long 0xbf80,0x3f6dbec4,0x3f353f35,0xbec43f6d,0x3f353f35,0xbe483f7b,0xbf6d3ec4,0xbf55bf0e
.long 0xbf808000,0xbf35bf35,0xbf80,0x3f35bf35,0x3f35bf35,0x3f7bbe48,0x3f6d3ec4,0x3f0e3f55
.long 0x3f80,0xbec43f6d,0xbf353f35,0xbf6d3ec4,0xbf35bf35,0xbf0ebf55,0xbec4bf6d,0xbe48bf7b
.long 0x3f808000,0x3f808000,0x3f808000,0x3f808000,0x3f80,0x3e483f7b,0x3ec43f6d,0x3f0e3f55
.long 0xbf808000,0xbf6d3ec4,0xbf353f35,0xbec43f6d,0xbf80,0xbf0ebf55,0xbf6dbec4,0xbf7b3e48
.long 0x3f808000,0x3f35bf35,0xbf80,0xbf35bf35,0x3f80,0x3f553f0e,0x3f6dbec4,0x3e48bf7b
.long 0xbf808000,0xbec43f6d,0x3f353f35,0x3f6dbec4,0xbf80,0xbf7bbe48,0xbec43f6d,0x3f553f0e
.long 0x3f808000,0xbf80,0xbf808000,0x3f80,0x3f80,0x3f7bbe48,0xbec4bf6d,0xbf553f0e
.long 0xbf808000,0x3ec43f6d,0x3f35bf35,0xbf6dbec4,0xbf80,0xbf553f0e,0x3f6d3ec4,0xbe48bf7b
.long 0x3f808000,0xbf35bf35,0x3f80,0x3f35bf35,0x3f80,0x3f0ebf55,0xbf6d3ec4,0x3f7b3e48
.long 0xbf808000,0x3f6d3ec4,0xbf35bf35,0x3ec43f6d,0xbf80,0xbe483f7b,0x3ec4bf6d,0xbf0e3f55
.long 0x3f808000,0xbf808000,0x3f808000,0xbf808000,0x3f80,0xbe48bf7b,0x3ec43f6d,0xbf0ebf55
.long 0xbf808000,0x3f6dbec4,0xbf353f35,0x3ec4bf6d,0xbf80,0x3f0e3f55,0xbf6dbec4,0x3f7bbe48
.long 0x3f808000,0xbf353f35,0xbf80,0x3f353f35,0x3f80,0xbf55bf0e,0x3f6dbec4,0xbe483f7b
.long 0xbf808000,0x3ec4bf6d,0x3f353f35,0xbf6d3ec4,0xbf80,0x3f7b3e48,0xbec43f6d,0xbf55bf0e
.long 0x3f808000,0x3f80,0xbf808000,0xbf80,0x3f80,0xbf7b3e48,0xbec4bf6d,0x3f55bf0e
.long 0xbf808000,0xbec4bf6d,0x3f35bf35,0x3f6d3ec4,0xbf80,0x3f55bf0e,0x3f6d3ec4,0x3e483f7b
.long 0x3f808000,0x3f353f35,0x3f80,0xbf353f35,0x3f80,0xbf0e3f55,0xbf6d3ec4,0xbf7bbe48
.long 0xbf808000,0xbf6dbec4,0xbf35bf35,0xbec4bf6d,0xbf80,0x3e48bf7b,0x3ec4bf6d,0x3f0ebf55
.long 0x3f808000,0x3f808000,0x3f808000,0x3f808000,0x3f353f35,0x3f553f0e,0x3f6d3ec4,0x3f7b3e48
.long 0x3f80,0x3ec43f6d,0x3f353f35,0x3f6d3ec4,0xbf353f35,0xbe483f7b,0x3ec43f6d,0x3f553f0e
.long 0xbf808000,0xbf353f35,0x3f80,0x3f353f35,0xbf35bf35,0xbf7b3e48,0xbec43f6d,0x3f0e3f55
.long 0xbf80,0xbf6dbec4,0xbf353f35,0x3ec43f6d,0x3f35bf35,0xbf0ebf55,0xbf6d3ec4,0x3e483f7b
.long 0x3f808000,0xbf80,0xbf808000,0x3f80,0x3f353f35,0x3f0ebf55,0xbf6dbec4,0xbe483f7b
.long 0x3f80,0x3f6dbec4,0xbf35bf35,0xbec43f6d,0xbf353f35,0x3f7b3e48,0xbec4bf6d,0xbf0e3f55
.long 0xbf808000,0x3f353f35,0xbf80,0xbf353f35,0xbf35bf35,0x3e483f7b,0x3ec4bf6d,0xbf553f0e
.long 0xbf80,0xbec43f6d,0x3f35bf35,0xbf6d3ec4,0x3f35bf35,0xbf553f0e,0x3f6dbec4,0xbf7b3e48
.long 0x3f808000,0xbf808000,0x3f808000,0xbf808000,0x3f353f35,0xbf55bf0e,0x3f6d3ec4,0xbf7bbe48
.long 0x3f80,0xbec4bf6d,0x3f353f35,0xbf6dbec4,0xbf353f35,0x3e48bf7b,0x3ec43f6d,0xbf55bf0e
.long 0xbf808000,0x3f35bf35,0x3f80,0xbf35bf35,0xbf35bf35,0x3f7bbe48,0xbec43f6d,0xbf0ebf55
.long 0xbf80,0x3f6d3ec4,0xbf353f35,0xbec4bf6d,0x3f35bf35,0x3f0e3f55,0xbf6d3ec4,0xbe48bf7b
.long 0x3f808000,0x3f80,0xbf808000,0xbf80,0x3f353f35,0xbf0e3f55,0xbf6dbec4,0x3e48bf7b
.long 0x3f80,0xbf6d3ec4,0xbf35bf35,0x3ec4bf6d,0xbf353f35,0xbf7bbe48,0xbec4bf6d,0x3f0ebf55
.long 0xbf808000,0xbf35bf35,0xbf80,0x3f35bf35,0xbf35bf35,0xbe48bf7b,0x3ec4bf6d,0x3f55bf0e
.long 0xbf80,0x3ec4bf6d,0x3f35bf35,0x3f6dbec4,0x3f35bf35,0x3f55bf0e,0x3f6dbec4,0x3f7bbe48
.long 0x3f800000,0x3f800000,0x3f800000,0x3f800000,0x3f800000,0x3f7ffec4,0x3f7ffb11,0x3f7ff4e6
.long 0x3f800000,0x3f7ffb11,0x3f7fec43,0x3f7fd397,0x3f800000,0x3f7ff4e6,0x3f7fd397,0x3f7f9c18
.long 0x3f800000,0x3f7fec43,0x3f7fb10f,0x3f7f4e6d,0x3f800000,0x3f7fe129,0x3f7f84ab,0x3f7eea9d
.long 0x3f800000,0x3f7fd397,0x3f7f4e6d,0x3f7e70b0,0x3f800000,0x3f7fc38f,0x3f7f0e58,0x3f7de0b1
.long 0x3f800000,0x3f7fb10f,0x3f7ec46d,0x3f7d3aac,0x3f800000,0x3f7f9c18,0x3f7e70b0,0x3f7c7eb0
.long 0x3f800000,0x3f7f84ab,0x3f7e1324,0x3f7baccd,0x3f800000,0x3f7f6ac7,0x3f7dabcc,0x3f7ac516
.long 0x3f800000,0x3f7f4e6d,0x3f7d3aac,0x3f79c79d,0x3f800000,0x3f7f2f9d,0x3f7cbfc9,0x3f78b47b
.long 0x3f800000,0x3f7f0e58,0x3f7c3b28,0x3f778bc5,0x3f800000,0x3f7eea9d,0x3f7baccd,0x3f764d97
.long 0x3f800000,0x3f7ec46d,0x3f7b14be,0x3f74fa0b,0x3f800000,0x3f7e9bc9,0x3f7a7302,0x3f73913f
.long 0x3f800000,0x3f7e70b0,0x3f79c79d,0x3f721352,0x3f800000,0x3f7e4323,0x3f791298,0x3f708066
.long 0x3f800000,0x3f7e1324,0x3f7853f8,0x3f6ed89e,0x3f800000,0x3f7de0b1,0x3f778bc5,0x3f6d1c1d
.long 0x3f800000,0x3f7dabcc,0x3f76ba07,0x3f6b4b0c,0x3f800000,0x3f7d7474,0x3f75dec6,0x3f696591
.long 0x3f800000,0x3f7d3aac,0x3f74fa0b,0x3f676bd8,0x3f800000,0x3f7cfe73,0x3f740bdd,0x3f655e0b
.long 0x3f800000,0x3f7cbfc9,0x3f731447,0x3f633c5a,0x3f800000,0x3f7c7eb0,0x3f721352,0x3f6106f2
.long 0x3f800000,0x3f7c3b28,0x3f710908,0x3f5ebe05,0x3f800000,0x3f7bf531,0x3f6ff573,0x3f5c61c7
.long 0x3f800000,0x3f7baccd,0x3f6ed89e,0x3f59f26a,0x3f800000,0x3f7b61fc,0x3f6db293,0x3f577026
.long 0x3f800000,0x3f800000,0x3f800000,0x3f800000,0x3f7fec43,0x3f7fe129,0x3f7fd397,0x3f7fc38f
.long 0x3f7fb10f,0x3f7f84ab,0x3f7f4e6d,0x3f7f0e58,0x3f7f4e6d,0x3f7eea9d,0x3f7e70b0,0x3f7de0b1
.long 0x3f7ec46d,0x3f7e1324,0x3f7d3aac,0x3f7c3b28,0x3f7e1324,0x3f7cfe73,0x3f7baccd,0x3f7a1e84
.long 0x3f7d3aac,0x3f7baccd,0x3f79c79d,0x3f778bc5,0x3f7c3b28,0x3f7a1e84,0x3f778bc5,0x3f748422
.long 0x3f7b14be,0x3f7853f8,0x3f74fa0b,0x3f710908,0x3f79c79d,0x3f764d97,0x3f721352,0x3f6d1c1d
.long 0x3f7853f8,0x3f740bdd,0x3f6ed89e,0x3f68bf3c,0x3f76ba07,0x3f718f57,0x3f6b4b0c,0x3f63f473
.long 0x3f74fa0b,0x3f6ed89e,0x3f676bd8,0x3f5ebe05,0x3f731447,0x3f6be858,0x3f633c5a,0x3f591e6a
.long 0x3f710908,0x3f68bf3c,0x3f5ebe05,0x3f531849,0x3f6ed89e,0x3f655e0b,0x3f59f26a,0x3f4cae79
.long 0x3f6c835e,0x3f61c598,0x3f54db31,0x3f45e403,0x3f6a09a7,0x3f5df6be,0x3f4f7a1f,0x3f3ebc1b
.long 0x3f676bd8,0x3f59f26a,0x3f49d112,0x3f373a23,0x3f64aa59,0x3f55b993,0x3f43e200,0x3f2f61a5
.long 0x3f61c598,0x3f514d3d,0x3f3daef9,0x3f273656,0x3f5ebe05,0x3f4cae79,0x3f373a23,0x3f1ebc12
.long 0x3f5b941a,0x3f47de65,0x3f3085bb,0x3f15f6d9,0x3f584853,0x3f42de29,0x3f299415,0x3f0cead0
.long 0x3f54db31,0x3f3daef9,0x3f226799,0x3f039c3d,0x3f514d3d,0x3f385216,0x3f1b02c6,0x3ef41f07
.long 0x3f4d9f02,0x3f32c8c9,0x3f13682a,0x3ee0924f,0x3f49d112,0x3f2d1469,0x3f0b9a6b,0x3ecc9b8b
.long 0x3f45e403,0x3f273656,0x3f039c3d,0x3eb8442a,0x3f41d870,0x3f212ff9,0x3ef6e0cb,0x3ea395c5
.long 0x3f3daef9,0x3f1b02c6,0x3ee63375,0x3e8e9a22,0x3f396842,0x3f14b039,0x3ed53641,0x3e72b651
.long 0x3f800000,0x3f800000,0x3f800000,0x3f800000,0x3f7fb10f,0x3f7f9c18,0x3f7f84ab,0x3f7f6ac7
.long 0x3f7ec46d,0x3f7e70b0,0x3f7e1324,0x3f7dabcc,0x3f7d3aac,0x3f7c7eb0,0x3f7baccd,0x3f7ac516
.long 0x3f7b14be,0x3f79c79d,0x3f7853f8,0x3f76ba07,0x3f7853f8,0x3f764d97,0x3f740bdd,0x3f718f57
.long 0x3f74fa0b,0x3f721352,0x3f6ed89e,0x3f6b4b0c,0x3f710908,0x3f6d1c1d,0x3f68bf3c,0x3f63f473
.long 0x3f6c835e,0x3f676bd8,0x3f61c598,0x3f5b941a,0x3f676bd8,0x3f6106f2,0x3f59f26a,0x3f5233c6
.long 0x3f61c598,0x3f59f26a,0x3f514d3d,0x3f47de65,0x3f5b941a,0x3f5233c6,0x3f47de65,0x3f3ca003
.long 0x3f54db31,0x3f49d112,0x3f3daef9,0x3f3085bb,0x3f4d9f02,0x3f40d0da,0x3f32c8c9,0x3f239da9
.long 0x3f45e403,0x3f373a23,0x3f273656,0x3f15f6d9,0x3f3daef9,0x3f2d1469,0x3f1b02c6,0x3f07a136
.long 0x3f3504f3,0x3f226799,0x3f0e39da,0x3ef15aea,0x3f2beb4a,0x3f173c07,0x3f00e7e4,0x3ed25a09
.long 0x3f226799,0x3f0b9a6b,0x3ee63375,0x3eb263ef,0x3f187fc0,0x3eff17b2,0x3ec9b953,0x3e919ddd
.long 0x3f0e39da,0x3ee63375,0x3eac7cd4,0x3e605c13,0x3f039c3d,0x3ecc9b8b,0x3e8e9a22,0x3e1c76de
.long 0x3ef15aea,0x3eb263ef,0x3e605c13,0x3dafb680,0x3edae880,0x3e97a117,0x3e22abb6,0x3c96c9b6
.long 0x3ec3ef15,0x3e78cfcc,0x3dc8bd36,0xbd48fb30,0x3eac7cd4,0x3e419b37,0x3d16c32c,0xbdee3876
.long 0x3e94a031,0x3e09cf86,0xbcc90ab0,0xbe3b6ecf,0x3e78cfcc,0x3da3308c,0xbdafb680,0xbe7ee6e1
.long 0x3e47c5c2,0x3cc90ab0,0xbe164083,0xbea09ae5,0x3e164083,0xbcfb49ba,0xbe541501,0xbec1071e
.long 0x3dc8bd36,0xbdafb680,0xbe888e93,0xbee0924f,0x3d48fb30,0xbe1008b7,0xbea68f12,0xbeff17b2
.long 0x3f800000,0x3f800000,0x3f800000,0x3f800000,0x3f7f4e6d,0x3f7f2f9d,0x3f7f0e58,0x3f7eea9d
.long 0x3f7d3aac,0x3f7cbfc9,0x3f7c3b28,0x3f7baccd,0x3f79c79d,0x3f78b47b,0x3f778bc5,0x3f764d97
.long 0x3f74fa0b,0x3f731447,0x3f710908,0x3f6ed89e,0x3f6ed89e,0x3f6be858,0x3f68bf3c,0x3f655e0b
.long 0x3f676bd8,0x3f633c5a,0x3f5ebe05,0x3f59f26a,0x3f5ebe05,0x3f591e6a,0x3f531849,0x3f4cae79
.long 0x3f54db31,0x3f4d9f02,0x3f45e403,0x3f3daef9,0x3f49d112,0x3f40d0da,0x3f373a23,0x3f2d1469
.long 0x3f3daef9,0x3f32c8c9,0x3f273656,0x3f1b02c6,0x3f3085bb,0x3f239da9,0x3f15f6d9,0x3f07a136
.long 0x3f226799,0x3f13682a,0x3f039c3d,0x3ee63375,0x3f13682a,0x3f0242b1,0x3ee0924f,0x3ebb31a0
.long 0x3f039c3d,0x3ee0924f,0x3eb8442a,0x3e8e9a22,0x3ee63375,0x3ebb31a0,0x3e8e9a22,0x3e419b37
.long 0x3ec3ef15,0x3e94a031,0x3e47c5c2,0x3dc8bd36,0x3ea09ae5,0x3e5a3997,0x3de1bc2e,0x3bc90f88
.long 0x3e78cfcc,0x3e09cf86,0x3cc90ab0,0xbdafb680,0x3e2f10a2,0x3d621469,0xbd7b2b74,0xbe354098
.long 0x3dc8bd36,0xbcc90ab0,0xbe164083,0xbe888e93,0x3cc90ab0,0xbdd53db9,0xbe6c9a7f,0xbeb554ec
.long 0xbd48fb30,0xbe3b6ecf,0xbea09ae5,0xbee0924f,0xbdfab273,0xbe8586ce,0xbec9b953,0xbf04f484
.long 0xbe47c5c2,0xbeac7cd4,0xbef15aea,0xbf187fc0,0xbe888e93,0xbed25a09,0xbf0b9a6b,0xbf2ac082
.long 0xbeac7cd4,0xbef6e0cb,0xbf1d7fd1,0xbf3b8f3b,0xbecf7bca,0xbf0cead0,0xbf2e3bde,0xbf4ac77f
.long 0xbef15aea,0xbf1d7fd1,0xbf3daef9,0xbf584853,0xbf08f59b,0xbf2d1469,0xbf4bbbf8,0xbf63f473
.long 0xbf187fc0,0xbf3b8f3b,0xbf584853,0xbf6db293,0xbf273656,0xbf48d8b3,0xbf633c5a,0xbf756d97
.long 0x3f800000,0x3f800000,0x3f800000,0x3f800000,0x3f7ec46d,0x3f7e9bc9,0x3f7e70b0,0x3f7e4323
.long 0x3f7b14be,0x3f7a7302,0x3f79c79d,0x3f791298,0x3f74fa0b,0x3f73913f,0x3f721352,0x3f708066
.long 0x3f6c835e,0x3f6a09a7,0x3f676bd8,0x3f64aa59,0x3f61c598,0x3f5df6be,0x3f59f26a,0x3f55b993
.long 0x3f54db31,0x3f4f7a1f,0x3f49d112,0x3f43e200,0x3f45e403,0x3f3ebc1b,0x3f373a23,0x3f2f61a5
.long 0x3f3504f3,0x3f2beb4a,0x3f226799,0x3f187fc0,0x3f226799,0x3f173c07,0x3f0b9a6b,0x3eff17b2
.long 0x3f0e39da,0x3f00e7e4,0x3ee63375,0x3ec9b953,0x3ef15aea,0x3ed25a09,0x3eb263ef,0x3e919ddd
.long 0x3ec3ef15,0x3ea09ae5,0x3e78cfcc,0x3e2f10a2,0x3e94a031,0x3e5a3997,0x3e09cf86,0x3d621469
.long 0x3e47c5c2,0x3de1bc2e,0x3cc90ab0,0xbd7b2b74,0x3dc8bd36,0x3bc90f88,0xbdafb680,0xbe354098
.long 0x0,0xbdc8bd36,0xbe47c5c2,0xbe94a031,0xbdc8bd36,0xbe4dee60,0xbe9aa086,0xbecc9b8b
.long 0xbe47c5c2,0xbe9aa086,0xbecf7bca,0xbf00e7e4,0xbe94a031,0xbecc9b8b,0xbf00e7e4,0xbf19c200
.long 0xbec3ef15,0xbefc5d27,0xbf187fc0,0xbf3085bb,0xbef15aea,0xbf14b039,0xbf2e3bde,0xbf44e3f5
.long 0xbf0e39da,0xbf299415,0xbf41d870,0xbf5695e5,0xbf226799,0xbf3ca003,0xbf531849,0xbf655e0b
.long 0xbf3504f3,0xbf4d9f02,0xbf61c598,0xbf710908,0xbf45e403,0xbf5c61c7,0xbf6db293,0xbf796e4e
.long 0xbf54db31,0xbf68bf3c,0xbf76ba07,0xbf7e70b0,0xbf61c598,0xbf7294f8,0xbf7cbfc9,0xbf7ffec4
.long 0xbf6c835e,0xbf79c79d,0xbf7fb10f,0xbf7e1324,0xbf74fa0b,0xbf7e4323,0xbf7f84ab,0xbf78b47b
.long 0xbf7b14be,0xbf7ffb11,0xbf7c3b28,0xbf6ff573,0xbf7ec46d,0xbf7eea9d,0xbf75dec6,0xbf63f473
.long 0x3f800000,0x3f800000,0x3f800000,0x3f800000,0x3f7e1324,0x3f7de0b1,0x3f7dabcc,0x3f7d7474
.long 0x3f7853f8,0x3f778bc5,0x3f76ba07,0x3f75dec6,0x3f6ed89e,0x3f6d1c1d,0x3f6b4b0c,0x3f696591
.long 0x3f61c598,0x3f5ebe05,0x3f5b941a,0x3f584853,0x3f514d3d,0x3f4cae79,0x3f47de65,0x3f42de29
.long 0x3f3daef9,0x3f373a23,0x3f3085bb,0x3f299415,0x3f273656,0x3f1ebc12,0x3f15f6d9,0x3f0cead0
.long 0x3f0e39da,0x3f039c3d,0x3ef15aea,0x3edae880,0x3ee63375,0x3ecc9b8b,0x3eb263ef,0x3e97a117
.long 0x3eac7cd4,0x3e8e9a22,0x3e605c13,0x3e22abb6,0x3e605c13,0x3e1c76de,0x3dafb680,0x3c96c9b6
.long 0x3dc8bd36,0x3cc90ab0,0xbd48fb30,0xbdfab273,0xbcc90ab0,0xbdd53db9,0xbe3b6ecf,0xbe8586ce
.long 0xbe164083,0xbe6c9a7f,0xbea09ae5,0xbec9b953,0xbe888e93,0xbeb554ec,0xbee0924f,0xbf04f484
.long 0xbec3ef15,0xbef15aea,0xbf0e39da,0xbf226799,0xbefc5d27,0xbf14b039,0xbf299415,0xbf3ca003
.long 0xbf187fc0,0xbf2e3bde,0xbf41d870,0xbf531849,0xbf3085bb,0xbf44e3f5,0xbf5695e5,0xbf655e0b
.long 0xbf45e403,0xbf584853,0xbf676bd8,0xbf731447,0xbf584853,0xbf6816a8,0xbf740bdd,0xbf7bf531
.long 0xbf676bd8,0xbf740bdd,0xbf7c3b28,0xbf7fd397,0xbf731447,0xbf7bf531,0xbf7fd397,0xbf7e9bc9
.long 0xbf7b14be,0xbf7fb10f,0xbf7ec46d,0xbf7853f8,0xbf7f4e6d,0xbf7f2f9d,0xbf791298,0xbf6d1c1d
.long 0xbf7fb10f,0xbf7a7302,0xbf6ed89e,0xbf5d2d53,0xbf7c3b28,0xbf718f57,0xbf604621,0xbf48d8b3
.long 0xbf74fa0b,0xbf64aa59,0xbf4d9f02,0xbf3085bb,0xbf6a09a7,0xbf53fac3,0xbf373a23,0xbf14b039
.long 0xbf5b941a,0xbf3fc767,0xbf1d7fd1,0xbeebcbbb,0xbf49d112,0xbf286605,0xbf00e7e4,0xbea986c4
.long 0x3f800000,0x3f800000,0x3f800000,0x3f800000,0x3f7d3aac,0x3f7cfe73,0x3f7cbfc9,0x3f7c7eb0
.long 0x3f74fa0b,0x3f740bdd,0x3f731447,0x3f721352,0x3f676bd8,0x3f655e0b,0x3f633c5a,0x3f6106f2
.long 0x3f54db31,0x3f514d3d,0x3f4d9f02,0x3f49d112,0x3f3daef9,0x3f385216,0x3f32c8c9,0x3f2d1469
.long 0x3f226799,0x3f1b02c6,0x3f13682a,0x3f0b9a6b,0x3f039c3d,0x3ef41f07,0x3ee0924f,0x3ecc9b8b
.long 0x3ec3ef15,0x3eac7cd4,0x3e94a031,0x3e78cfcc,0x3e78cfcc,0x3e419b37,0x3e09cf86,0x3da3308c
.long 0x3dc8bd36,0x3d16c32c,0xbcc90ab0,0xbdafb680,0xbd48fb30,0xbdee3876,0xbe3b6ecf,0xbe7ee6e1
.long 0xbe47c5c2,0xbe888e93,0xbeac7cd4,0xbecf7bca,0xbeac7cd4,0xbed25a09,0xbef6e0cb,0xbf0cead0
.long 0xbef15aea,0xbf0b9a6b,0xbf1d7fd1,0xbf2e3bde,0xbf187fc0,0xbf2ac082,0xbf3b8f3b,0xbf4ac77f
.long 0xbf3504f3,0xbf45e403,0xbf54db31,0xbf61c598,0xbf4d9f02,0xbf5c61c7,0xbf68bf3c,0xbf7294f8
.long 0xbf61c598,0xbf6db293,0xbf76ba07,0xbf7cbfc9,0xbf710908,0xbf796e4e,0xbf7e70b0,0xbf7ffec4
.long 0xbf7b14be,0xbf7f4e6d,0xbf7fb10f,0xbf7c3b28,0xbf7fb10f,0xbf7f2f9d,0xbf7a7302,0xbf718f57
.long 0xbf7ec46d,0xbf791298,0xbf6ed89e,0xbf604621,0xbf7853f8,0xbf6d1c1d,0xbf5d2d53,0xbf48d8b3
.long 0xbf6c835e,0xbf5b941a,0xbf45e403,0xbf2beb4a,0xbf5b941a,0xbf44e3f5,0xbf299415,0xbf0a48ad
.long 0xbf45e403,0xbf299415,0xbf08f59b,0xbec9b953,0xbf2beb4a,0xbf0a48ad,0xbec9b953,0xbe72b651
.long 0xbf0e39da,0xbecf7bca,0xbe78cfcc,0xbd96a905,0xbedae880,0xbe8586ce,0xbdafb680,0x3dbc3ac3
.long 0xbe94a031,0xbde1bc2e,0x3d96a905,0x3e827dc0,0xbe164083,0x3d2fe007,0x3e6c9a7f,0x3ed25a09
.long 0x3f800000,0x3f800000,0x3f800000,0x3f800000,0x3f7c3b28,0x3f7bf531,0x3f7baccd,0x3f7b61fc
.long 0x3f710908,0x3f6ff573,0x3f6ed89e,0x3f6db293,0x3f5ebe05,0x3f5c61c7,0x3f59f26a,0x3f577026
.long 0x3f45e403,0x3f41d870,0x3f3daef9,0x3f396842,0x3f273656,0x3f212ff9,0x3f1b02c6,0x3f14b039
.long 0x3f039c3d,0x3ef6e0cb,0x3ee63375,0x3ed53641,0x3eb8442a,0x3ea395c5,0x3e8e9a22,0x3e72b651
.long 0x3e47c5c2,0x3e164083,0x3dc8bd36,0x3d48fb30,0x3cc90ab0,0xbcfb49ba,0xbdafb680,0xbe1008b7
.long 0xbe164083,0xbe541501,0xbe888e93,0xbea68f12,0xbea09ae5,0xbec1071e,0xbee0924f,0xbeff17b2
.long 0xbef15aea,0xbf08f59b,0xbf187fc0,0xbf273656,0xbf1d7fd1,0xbf2d1469,0xbf3b8f3b,0xbf48d8b3
.long 0xbf3daef9,0xbf4bbbf8,0xbf584853,0xbf633c5a,0xbf584853,0xbf63f473,0xbf6db293,0xbf756d97
.long 0xbf6c835e,0xbf74fa0b,0xbf7b14be,0xbf7ec46d,0xbf79c79d,0xbf7e4323,0xbf7ffb11,0xbf7eea9d
.long 0xbf7fb10f,0xbf7f84ab,0xbf7c3b28,0xbf75dec6,0xbf7e1324,0xbf78b47b,0xbf6ff573,0xbf63f473
.long 0xbf74fa0b,0xbf6a09a7,0xbf5b941a,0xbf49d112,0xbf64aa59,0xbf53fac3,0xbf3fc767,0xbf286605
.long 0xbf4d9f02,0xbf373a23,0xbf1d7fd1,0xbf00e7e4,0xbf3085bb,0xbf14b039,0xbeebcbbb,0xbea986c4
.long 0xbf0e39da,0xbedae880,0xbe94a031,0xbe164083,0xbecf7bca,0xbe8586ce,0xbde1bc2e,0x3d2fe007
.long 0xbe78cfcc,0xbdafb680,0x3d96a905,0x3e6c9a7f,0xbd96a905,0x3dbc3ac3,0x3e827dc0,0x3ed25a09
.long 0x3dc8bd36,0x3e888e93,0x3edae880,0x3f13682a,0x3e888e93,0x3eddbe79,0x3f15f6d9,0x3f385216
.long 0x3edae880,0x3f15f6d9,0x3f396842,0x3f5695e5,0x3f13682a,0x3f385216,0x3f5695e5,0x3f6d1c1d
.long 0x0,0x0,0x0,0x0,0x0,0x3bc90f88,0x3c490e90,0x3c96c9b6
.long 0x0,0x3c490e90,0x3cc90ab0,0x3d16c32c,0x0,0x3c96c9b6,0x3d16c32c,0x3d621469
.long 0x0,0x3cc90ab0,0x3d48fb30,0x3d96a905,0x0,0x3cfb49ba,0x3d7b2b74,0x3dbc3ac3
.long 0x0,0x3d16c32c,0x3d96a905,0x3de1bc2e,0x0,0x3d2fe007,0x3dafb680,0x3e039502
.long 0x0,0x3d48fb30,0x3dc8bd36,0x3e164083,0x0,0x3d621469,0x3de1bc2e,0x3e28defc
.long 0x0,0x3d7b2b74,0x3dfab273,0x3e3b6ecf,0x0,0x3d8a200a,0x3e09cf86,0x3e4dee60
.long 0x0,0x3d96a905,0x3e164083,0x3e605c13,0x0,0x3da3308c,0x3e22abb6,0x3e72b651
.long 0x0,0x3dafb680,0x3e2f10a2,0x3e827dc0,0x0,0x3dbc3ac3,0x3e3b6ecf,0x3e8b9507
.long 0x0,0x3dc8bd36,0x3e47c5c2,0x3e94a031,0x0,0x3dd53db9,0x3e541501,0x3e9d9e78
.long 0x0,0x3de1bc2e,0x3e605c13,0x3ea68f12,0x0,0x3dee3876,0x3e6c9a7f,0x3eaf713a
.long 0x0,0x3dfab273,0x3e78cfcc,0x3eb8442a,0x0,0x3e039502,0x3e827dc0,0x3ec1071e
.long 0x0,0x3e09cf86,0x3e888e93,0x3ec9b953,0x0,0x3e1008b7,0x3e8e9a22,0x3ed25a09
.long 0x0,0x3e164083,0x3e94a031,0x3edae880,0x0,0x3e1c76de,0x3e9aa086,0x3ee363fa
.long 0x0,0x3e22abb6,0x3ea09ae5,0x3eebcbbb,0x0,0x3e28defc,0x3ea68f12,0x3ef41f07
.long 0x0,0x3e2f10a2,0x3eac7cd4,0x3efc5d27,0x0,0x3e354098,0x3eb263ef,0x3f0242b1
.long 0x0,0x3e3b6ecf,0x3eb8442a,0x3f064b82,0x0,0x3e419b37,0x3ebe1d4a,0x3f0a48ad
.long 0x0,0x0,0x0,0x0,0x3cc90ab0,0x3cfb49ba,0x3d16c32c,0x3d2fe007
.long 0x3d48fb30,0x3d7b2b74,0x3d96a905,0x3dafb680,0x3d96a905,0x3dbc3ac3,0x3de1bc2e,0x3e039502
.long 0x3dc8bd36,0x3dfab273,0x3e164083,0x3e2f10a2,0x3dfab273,0x3e1c76de,0x3e3b6ecf,0x3e5a3997
.long 0x3e164083,0x3e3b6ecf,0x3e605c13,0x3e827dc0,0x3e2f10a2,0x3e5a3997,0x3e827dc0,0x3e97a117
.long 0x3e47c5c2,0x3e78cfcc,0x3e94a031,0x3eac7cd4,0x3e605c13,0x3e8b9507,0x3ea68f12,0x3ec1071e
.long 0x3e78cfcc,0x3e9aa086,0x3eb8442a,0x3ed53641,0x3e888e93,0x3ea986c4,0x3ec9b953,0x3ee900b7
.long 0x3e94a031,0x3eb8442a,0x3edae880,0x3efc5d27,0x3ea09ae5,0x3ec6d529,0x3eebcbbb,0x3f07a136
.long 0x3eac7cd4,0x3ed53641,0x3efc5d27,0x3f10d3cd,0x3eb8442a,0x3ee363fa,0x3f064b82,0x3f19c200
.long 0x3ec3ef15,0x3ef15aea,0x3f0e39da,0x3f226799,0x3ecf7bca,0x3eff17b2,0x3f15f6d9,0x3f2ac082
.long 0x3edae880,0x3f064b82,0x3f1d7fd1,0x3f32c8c9,0x3ee63375,0x3f0cead0,0x3f24d225,0x3f3a7ca4
.long 0x3ef15aea,0x3f13682a,0x3f2beb4a,0x3f41d870,0x3efc5d27,0x3f19c200,0x3f32c8c9,0x3f48d8b3
.long 0x3f039c3d,0x3f1ff6cb,0x3f396842,0x3f4f7a1f,0x3f08f59b,0x3f26050a,0x3f3fc767,0x3f55b993
.long 0x3f0e39da,0x3f2beb4a,0x3f45e403,0x3f5b941a,0x3f13682a,0x3f31a81d,0x3f4bbbf8,0x3f6106f2
.long 0x3f187fc0,0x3f373a23,0x3f514d3d,0x3f660f88,0x3f1d7fd1,0x3f3ca003,0x3f5695e5,0x3f6aab7b
.long 0x3f226799,0x3f41d870,0x3f5b941a,0x3f6ed89e,0x3f273656,0x3f46e22a,0x3f604621,0x3f7294f8
.long 0x3f2beb4a,0x3f4bbbf8,0x3f64aa59,0x3f75dec6,0x3f3085bb,0x3f5064af,0x3f68bf3c,0x3f78b47b
.long 0x0,0x0,0x0,0x0,0x3d48fb30,0x3d621469,0x3d7b2b74,0x3d8a200a
.long 0x3dc8bd36,0x3de1bc2e,0x3dfab273,0x3e09cf86,0x3e164083,0x3e28defc,0x3e3b6ecf,0x3e4dee60
.long 0x3e47c5c2,0x3e605c13,0x3e78cfcc,0x3e888e93,0x3e78cfcc,0x3e8b9507,0x3e9aa086,0x3ea986c4
.long 0x3e94a031,0x3ea68f12,0x3eb8442a,0x3ec9b953,0x3eac7cd4,0x3ec1071e,0x3ed53641,0x3ee900b7
.long 0x3ec3ef15,0x3edae880,0x3ef15aea,0x3f039c3d,0x3edae880,0x3ef41f07,0x3f064b82,0x3f121eb0
.long 0x3ef15aea,0x3f064b82,0x3f13682a,0x3f1ff6cb,0x3f039c3d,0x3f121eb0,0x3f1ff6cb,0x3f2d1469
.long 0x3f0e39da,0x3f1d7fd1,0x3f2beb4a,0x3f396842,0x3f187fc0,0x3f286605,0x3f373a23,0x3f44e3f5
.long 0x3f226799,0x3f32c8c9,0x3f41d870,0x3f4f7a1f,0x3f2beb4a,0x3f3ca003,0x3f4bbbf8,0x3f591e6a
.long 0x3f3504f3,0x3f45e403,0x3f54db31,0x3f61c598,0x3f3daef9,0x3f4e8d90,0x3f5d2d53,0x3f696591
.long 0x3f45e403,0x3f5695e5,0x3f64aa59,0x3f6ff573,0x3f4d9f02,0x3f5df6be,0x3f6b4b0c,0x3f756d97
.long 0x3f54db31,0x3f64aa59,0x3f710908,0x3f79c79d,0x3f5b941a,0x3f6aab7b,0x3f75dec6,0x3f7cfe73
.long 0x3f61c598,0x3f6ff573,0x3f79c79d,0x3f7f0e58,0x3f676bd8,0x3f748422,0x3f7cbfc9,0x3f7ff4e6
.long 0x3f6c835e,0x3f7853f8,0x3f7ec46d,0x3f7fb10f,0x3f710908,0x3f7b61fc,0x3f7fd397,0x3f7e4323
.long 0x3f74fa0b,0x3f7dabcc,0x3f7fec43,0x3f7baccd,0x3f7853f8,0x3f7f2f9d,0x3f7f0e58,0x3f77f110
.long 0x3f7b14be,0x3f7fec43,0x3f7d3aac,0x3f731447,0x3f7d3aac,0x3f7fe129,0x3f7a7302,0x3f6d1c1d
.long 0x3f7ec46d,0x3f7f0e58,0x3f76ba07,0x3f660f88,0x3f7fb10f,0x3f7d7474,0x3f721352,0x3f5df6be
.long 0x0,0x0,0x0,0x0,0x3d96a905,0x3da3308c,0x3dafb680,0x3dbc3ac3
.long 0x3e164083,0x3e22abb6,0x3e2f10a2,0x3e3b6ecf,0x3e605c13,0x3e72b651,0x3e827dc0,0x3e8b9507
.long 0x3e94a031,0x3ea09ae5,0x3eac7cd4,0x3eb8442a,0x3eb8442a,0x3ec6d529,0x3ed53641,0x3ee363fa
.long 0x3edae880,0x3eebcbbb,0x3efc5d27,0x3f064b82,0x3efc5d27,0x3f07a136,0x3f10d3cd,0x3f19c200
.long 0x3f0e39da,0x3f187fc0,0x3f226799,0x3f2beb4a,0x3f1d7fd1,0x3f286605,0x3f32c8c9,0x3f3ca003
.long 0x3f2beb4a,0x3f373a23,0x3f41d870,0x3f4bbbf8,0x3f396842,0x3f44e3f5,0x3f4f7a1f,0x3f591e6a
.long 0x3f45e403,0x3f514d3d,0x3f5b941a,0x3f64aa59,0x3f514d3d,0x3f5c61c7,0x3f660f88,0x3f6e46be
.long 0x3f5b941a,0x3f660f88,0x3f6ed89e,0x3f75dec6,0x3f64aa59,0x3f6e46be,0x3f75dec6,0x3f7b61fc
.long 0x3f6c835e,0x3f74fa0b,0x3f7b14be,0x3f7ec46d,0x3f731447,0x3f7a1e84,0x3f7e70b0,0x3f7ffec4
.long 0x3f7853f8,0x3f7dabcc,0x3f7fec43,0x3f7f0e58,0x3f7c3b28,0x3f7f9c18,0x3f7f84ab,0x3f7bf531
.long 0x3f7ec46d,0x3f7fec43,0x3f7d3aac,0x3f76ba07,0x3f7fec43,0x3f7e9bc9,0x3f791298,0x3f6f6830
.long 0x3f7fb10f,0x3f7baccd,0x3f731447,0x3f660f88,0x3f7e1324,0x3f772417,0x3f6b4b0c,0x3f5ac450
.long 0x3f7b14be,0x3f710908,0x3f61c598,0x3f4d9f02,0x3f76ba07,0x3f696591,0x3f5695e5,0x3f3ebc1b
.long 0x3f710908,0x3f604621,0x3f49d112,0x3f2e3bde,0x3f6a09a7,0x3f55b993,0x3f3b8f3b,0x3f1c420c
.long 0x3f61c598,0x3f49d112,0x3f2beb4a,0x3f08f59b,0x3f584853,0x3f3ca003,0x3f1b02c6,0x3ee900b7
.long 0x3f4d9f02,0x3f2e3bde,0x3f08f59b,0x3ebe1d4a,0x3f41d870,0x3f1ebc12,0x3eebcbbb,0x3e919ddd
.long 0x0,0x0,0x0,0x0,0x3dc8bd36,0x3dd53db9,0x3de1bc2e,0x3dee3876
.long 0x3e47c5c2,0x3e541501,0x3e605c13,0x3e6c9a7f,0x3e94a031,0x3e9d9e78,0x3ea68f12,0x3eaf713a
.long 0x3ec3ef15,0x3ecf7bca,0x3edae880,0x3ee63375,0x3ef15aea,0x3eff17b2,0x3f064b82,0x3f0cead0
.long 0x3f0e39da,0x3f15f6d9,0x3f1d7fd1,0x3f24d225,0x3f226799,0x3f2ac082,0x3f32c8c9,0x3f3a7ca4
.long 0x3f3504f3,0x3f3daef9,0x3f45e403,0x3f4d9f02,0x3f45e403,0x3f4e8d90,0x3f5695e5,0x3f5df6be
.long 0x3f54db31,0x3f5d2d53,0x3f64aa59,0x3f6b4b0c,0x3f61c598,0x3f696591,0x3f6ff573,0x3f756d97
.long 0x3f6c835e,0x3f731447,0x3f7853f8,0x3f7c3b28,0x3f74fa0b,0x3f7a1e84,0x3f7dabcc,0x3f7f9c18
.long 0x3f7b14be,0x3f7e70b0,0x3f7fec43,0x3f7f84ab,0x3f7ec46d,0x3f7ffec4,0x3f7f0e58,0x3f7bf531
.long 0x3f800000,0x3f7ec46d,0x3f7b14be,0x3f74fa0b,0x3f7ec46d,0x3f7ac516,0x3f740bdd,0x3f6aab7b
.long 0x3f7b14be,0x3f740bdd,0x3f6a09a7,0x3f5d2d53,0x3f74fa0b,0x3f6aab7b,0x3f5d2d53,0x3f4cae79
.long 0x3f6c835e,0x3f5ebe05,0x3f4d9f02,0x3f396842,0x3f61c598,0x3f5064af,0x3f3b8f3b,0x3f239da9
.long 0x3f54db31,0x3f3fc767,0x3f273656,0x3f0b9a6b,0x3f45e403,0x3f2d1469,0x3f10d3cd,0x3ee363fa
.long 0x3f3504f3,0x3f187fc0,0x3ef15aea,0x3eac7cd4,0x3f226799,0x3f0242b1,0x3ebe1d4a,0x3e667c66
.long 0x3f0e39da,0x3ed53641,0x3e888e93,0x3de1bc2e,0x3ef15aea,0x3ea395c5,0x3e22abb6,0xbbc90f88
.long 0x3ec3ef15,0x3e605c13,0x3d48fb30,0xbdfab273,0x3e94a031,0x3dee3876,0xbd7b2b74,0xbe72b651
.long 0x3e47c5c2,0x3c490e90,0xbe2f10a2,0xbeb263ef,0x3dc8bd36,0xbdbc3ac3,0xbe8e9a22,0xbee900b7
.long 0x0,0x0,0x0,0x0,0x3dfab273,0x3e039502,0x3e09cf86,0x3e1008b7
.long 0x3e78cfcc,0x3e827dc0,0x3e888e93,0x3e8e9a22,0x3eb8442a,0x3ec1071e,0x3ec9b953,0x3ed25a09
.long 0x3ef15aea,0x3efc5d27,0x3f039c3d,0x3f08f59b,0x3f13682a,0x3f19c200,0x3f1ff6cb,0x3f26050a
.long 0x3f2beb4a,0x3f32c8c9,0x3f396842,0x3f3fc767,0x3f41d870,0x3f48d8b3,0x3f4f7a1f,0x3f55b993
.long 0x3f54db31,0x3f5b941a,0x3f61c598,0x3f676bd8,0x3f64aa59,0x3f6aab7b,0x3f6ff573,0x3f748422
.long 0x3f710908,0x3f75dec6,0x3f79c79d,0x3f7cbfc9,0x3f79c79d,0x3f7cfe73,0x3f7f0e58,0x3f7ff4e6
.long 0x3f7ec46d,0x3f7fec43,0x3f7fb10f,0x3f7e1324,0x3f7fec43,0x3f7e9bc9,0x3f7baccd,0x3f772417
.long 0x3f7d3aac,0x3f791298,0x3f731447,0x3f6b4b0c,0x3f76ba07,0x3f6f6830,0x3f660f88,0x3f5ac450
.long 0x3f6c835e,0x3f61c598,0x3f54db31,0x3f45e403,0x3f5ebe05,0x3f5064af,0x3f3fc767,0x3f2d1469
.long 0x3f4d9f02,0x3f3b8f3b,0x3f273656,0x3f10d3cd,0x3f396842,0x3f239da9,0x3f0b9a6b,0x3ee363fa
.long 0x3f226799,0x3f08f59b,0x3edae880,0x3ea09ae5,0x3f08f59b,0x3ed8106b,0x3e9aa086,0x3e354098
.long 0x3edae880,0x3e9aa086,0x3e2f10a2,0x3d16c32c,0x3ea09ae5,0x3e354098,0x3d16c32c,0xbdd53db9
.long 0x3e47c5c2,0x3d48fb30,0xbdc8bd36,0xbe78cfcc,0x3d96a905,0xbda3308c,0xbe6c9a7f,0xbec1071e
.long 0xbd48fb30,0xbe541501,0xbeb8442a,0xbf00e7e4,0xbe2f10a2,0xbea986c4,0xbef6e0cb,0xbf1ebc12
.long 0xbe94a031,0xbee63375,0xbf187fc0,0xbf396842,0xbecf7bca,0xbf0f8784,0xbf32c8c9,0xbf5064af
.long 0xbf039c3d,0xbf299415,0xbf49d112,0xbf633c5a,0xbf1d7fd1,0xbf40d0da,0xbf5d2d53,0xbf718f57
.long 0x0,0x0,0x0,0x0,0x3e164083,0x3e1c76de,0x3e22abb6,0x3e28defc
.long 0x3e94a031,0x3e9aa086,0x3ea09ae5,0x3ea68f12,0x3edae880,0x3ee363fa,0x3eebcbbb,0x3ef41f07
.long 0x3f0e39da,0x3f13682a,0x3f187fc0,0x3f1d7fd1,0x3f2beb4a,0x3f31a81d,0x3f373a23,0x3f3ca003
.long 0x3f45e403,0x3f4bbbf8,0x3f514d3d,0x3f5695e5,0x3f5b941a,0x3f6106f2,0x3f660f88,0x3f6aab7b
.long 0x3f6c835e,0x3f710908,0x3f74fa0b,0x3f7853f8,0x3f7853f8,0x3f7b61fc,0x3f7dabcc,0x3f7f2f9d
.long 0x3f7ec46d,0x3f7fd397,0x3f7fec43,0x3f7f0e58,0x3f7fb10f,0x3f7e4323,0x3f7baccd,0x3f77f110
.long 0x3f7b14be,0x3f76ba07,0x3f710908,0x3f6a09a7,0x3f710908,0x3f696591,0x3f604621,0x3f55b993
.long 0x3f61c598,0x3f5695e5,0x3f49d112,0x3f3b8f3b,0x3f4d9f02,0x3f3ebc1b,0x3f2e3bde,0x3f1c420c
.long 0x3f3504f3,0x3f226799,0x3f0e39da,0x3ef15aea,0x3f187fc0,0x3f0242b1,0x3ed53641,0x3ea395c5
.long 0x3ef15aea,0x3ebe1d4a,0x3e888e93,0x3e22abb6,0x3eac7cd4,0x3e667c66,0x3de1bc2e,0xbbc90f88
.long 0x3e47c5c2,0x3d96a905,0xbd48fb30,0xbe2f10a2,0x3d48fb30,0xbda3308c,0xbe541501,0xbea986c4
.long 0xbdc8bd36,0xbe6c9a7f,0xbeb8442a,0xbef6e0cb,0xbe78cfcc,0xbec1071e,0xbf00e7e4,0xbf1ebc12
.long 0xbec3ef15,0xbf039c3d,0xbf226799,0xbf3daef9,0xbf039c3d,0xbf239da9,0xbf3fc767,0xbf577026
.long 0xbf226799,0xbf3fc767,0xbf584853,0xbf6b4b0c,0xbf3daef9,0xbf577026,0xbf6b4b0c,0xbf78b47b
.long 0xbf54db31,0xbf6a09a7,0xbf7853f8,0xbf7f4e6d,0xbf676bd8,0xbf772417,0xbf7f0e58,0xbf7eea9d
.long 0xbf74fa0b,0xbf7e70b0,0xbf7f4e6d,0xbf778bc5,0xbf7d3aac,0xbf7fc38f,0xbf791298,0xbf696591
.long 0x0,0x0,0x0,0x0,0x3e2f10a2,0x3e354098,0x3e3b6ecf,0x3e419b37
.long 0x3eac7cd4,0x3eb263ef,0x3eb8442a,0x3ebe1d4a,0x3efc5d27,0x3f0242b1,0x3f064b82,0x3f0a48ad
.long 0x3f226799,0x3f273656,0x3f2beb4a,0x3f3085bb,0x3f41d870,0x3f46e22a,0x3f4bbbf8,0x3f5064af
.long 0x3f5b941a,0x3f604621,0x3f64aa59,0x3f68bf3c,0x3f6ed89e,0x3f7294f8,0x3f75dec6,0x3f78b47b
.long 0x3f7b14be,0x3f7d3aac,0x3f7ec46d,0x3f7fb10f,0x3f7fec43,0x3f7fe129,0x3f7f0e58,0x3f7d7474
.long 0x3f7d3aac,0x3f7a7302,0x3f76ba07,0x3f721352,0x3f731447,0x3f6d1c1d,0x3f660f88,0x3f5df6be
.long 0x3f61c598,0x3f584853,0x3f4d9f02,0x3f41d870,0x3f49d112,0x3f3ca003,0x3f2e3bde,0x3f1ebc12
.long 0x3f2beb4a,0x3f1b02c6,0x3f08f59b,0x3eebcbbb,0x3f08f59b,0x3ee900b7,0x3ebe1d4a,0x3e919ddd
.long 0x3ec3ef15,0x3e94a031,0x3e47c5c2,0x3dc8bd36,0x3e605c13,0x3dee3876,0x3c490e90,0xbdbc3ac3
.long 0x3d48fb30,0xbd7b2b74,0xbe2f10a2,0xbe8e9a22,0xbdfab273,0xbe72b651,0xbeb263ef,0xbee900b7
.long 0xbe94a031,0xbecf7bca,0xbf039c3d,0xbf1d7fd1,0xbee63375,0xbf0f8784,0xbf299415,0xbf40d0da
.long 0xbf187fc0,0xbf32c8c9,0xbf49d112,0xbf5d2d53,0xbf396842,0xbf5064af,0xbf633c5a,0xbf718f57
.long 0xbf54db31,0xbf676bd8,0xbf74fa0b,0xbf7d3aac,0xbf6a09a7,0xbf772417,0xbf7e70b0,0xbf7fc38f
.long 0xbf7853f8,0xbf7f0e58,0xbf7f4e6d,0xbf791298,0xbf7f4e6d,0xbf7eea9d,0xbf778bc5,0xbf696591
.long 0xbf7ec46d,0xbf76ba07,0xbf676bd8,0xbf514d3d,0xbf76ba07,0xbf66becc,0xbf4f7a1f,0xbf31a81d
.long 0xbf676bd8,0xbf4f7a1f,0xbf3085bb,0xbf0b9a6b,0xbf514d3d,0xbf31a81d,0xbf0b9a6b,0xbec1071e
.size tab_col, 16384
.section .rodata,"a"
.p2align 6
.amdhsa_kernel prep_kernel
  .amdhsa_next_free_vgpr 164
  .amdhsa_next_free_sgpr 53
  .amdhsa_accum_offset 164
  .amdhsa_group_segment_fixed_size 0
  .amdhsa_kernarg_size 88
  .amdhsa_user_sgpr_count 2
  .amdhsa_user_sgpr_kernarg_segment_ptr 1
  .amdhsa_system_sgpr_workgroup_id_x 1
.end_amdhsa_kernel
.p2align 6
.amdhsa_kernel mlpi_kernel
  .amdhsa_next_free_vgpr 254
  .amdhsa_next_free_sgpr 66
  .amdhsa_accum_offset 256
  .amdhsa_group_segment_fixed_size 0
  .amdhsa_kernarg_size 88
  .amdhsa_user_sgpr_count 2
  .amdhsa_user_sgpr_kernarg_segment_ptr 1
  .amdhsa_system_sgpr_workgroup_id_x 1
.end_amdhsa_kernel
.p2align 6
.amdhsa_kernel mlp_kernel
  .amdhsa_next_free_vgpr 254
  .amdhsa_next_free_sgpr 66
  .amdhsa_accum_offset 256
  .amdhsa_group_segment_fixed_size 0
  .amdhsa_kernarg_size 88
  .amdhsa_user_sgpr_count 2
  .amdhsa_user_sgpr_kernarg_segment_ptr 1
  .amdhsa_system_sgpr_workgroup_id_x 1
.end_amdhsa_kernel
.p2align 6
.amdhsa_kernel colb_kernel
  .amdhsa_next_free_vgpr 244
  .amdhsa_next_free_sgpr 53
  .amdhsa_accum_offset 244
  .amdhsa_group_segment_fixed_size 0
  .amdhsa_kernarg_size 88
  .amdhsa_user_sgpr_count 2
  .amdhsa_user_sgpr_kernarg_segment_ptr 1
  .amdhsa_system_sgpr_workgroup_id_x 1
.end_amdhsa_kernel
.p2align 6
.amdhsa_kernel col_kernel
  .amdhsa_next_free_vgpr 244
  .amdhsa_next_free_sgpr 53
  .amdhsa_accum_offset 244
  .amdhsa_group_segment_fixed_size 0
  .amdhsa_kernarg_size 88
  .amdhsa_user_sgpr_count 2
  .amdhsa_user_sgpr_kernarg_segment_ptr 1
  .amdhsa_system_sgpr_workgroup_id_x 1
.end_amdhsa_kernel
```
